```python
import torch

def _softmax(x, axis=-1):
    return torch.softmax(x, dim=axis)
def _gelu(x):
    return torch.nn.functional.gelu(x, approximate="tanh")
def _silu(x):
    return torch.nn.functional.silu(x)
def _sigmoid(x):
    return torch.sigmoid(x)
def _layernorm(x, axis=-1, eps=1e-5):
    m = x.mean(dim=axis, keepdim=True)
    v = x.var(dim=axis, keepdim=True, unbiased=False)
    return (x - m) / torch.sqrt(v + eps)
def _scatter_add(tgt, idx, src, axis=0):
    return tgt.clone().index_add_(axis, idx, src)
def _segment_sum(src, seg, n):
    out = torch.zeros((n,) + src.shape[1:], dtype=src.dtype)
    return out.index_add_(0, seg, src)
def _pad(x, pw):
    flat = tuple(v for pair in reversed(pw) for v in pair)
    return torch.nn.functional.pad(x, flat)

kernel_name = 'sequential_preLN__softmax_full_mha__glu_gated_swiglu__prompt'

def setup_inputs():

    _w = (lambda a: (lambda t: t.to(torch.bfloat16) if t.is_floating_point() else t)(torch.as_tensor(a)))
    def _A_setup():
        B, S, D = 1, 2048, 512
        return {
            "x": _w((lambda *s: torch.randn(*s, dtype=torch.bfloat16) * 0.05)(B, S, D)),
            "wqkv": _w((lambda *s: torch.randn(*s, dtype=torch.bfloat16) * 0.05)(D, 3 * D)),
            "wo": _w((lambda *s: torch.randn(*s, dtype=torch.bfloat16) * 0.05)(D, D)),
        }
    _A_in = _A_setup()

    def _B_setup():
        B, S, D, F = 1, 2048, 512, 1376
        return {
            "x": _w((lambda *s: torch.randn(*s, dtype=torch.bfloat16) * 0.05)(B, S, D)),
            "w1": _w((lambda *s: torch.randn(*s, dtype=torch.bfloat16) * 0.4)(D, F) * (2.0 / D) ** 0.5),
            "w3": _w((lambda *s: torch.randn(*s, dtype=torch.bfloat16) * 0.4)(D, F) * (2.0 / D) ** 0.5),
            "w2": _w((lambda *s: torch.randn(*s, dtype=torch.bfloat16) * 0.4)(F, D) * (2.0 / F) ** 0.5),
        }
    _B_in = _B_setup()

    return {
        "A_x": _A_in["x"],
        "A_wqkv": _A_in["wqkv"],
        "A_wo": _A_in["wo"],
        "B_x": _B_in["x"],
        "B_w1": _B_in["w1"],
        "B_w3": _B_in["w3"],
        "B_w2": _B_in["w2"],
    }

def reference(A_x, A_wqkv, A_wo, B_x, B_w1, B_w3, B_w2):
    def _A_ref(x, wqkv, wo):
        B, S, D = x.shape
        H = 32; Dh = D // H
        qkv = (lambda x, *d: x.permute(*d))((x @ wqkv).reshape(B, S, 3, H, Dh), 2, 0, 3, 1, 4)
        q, k, v = qkv[0], qkv[1], qkv[2]
        scale = Dh ** -0.5
        scores = torch.einsum("bhqd,bhkd->bhqk", q, k) * scale
        p = _softmax(scores, axis=-1)
        o = torch.einsum("bhqk,bhkd->bhqd", p, v)
        return (lambda x, *d: x.permute(*d))(o, 0, 2, 1, 3).reshape(B, S, D) @ wo

    def _B_ref(x, w1, w3, w2):
        gate = torch.einsum("bsd,df->bsf", x, w1)
        up = torch.einsum("bsd,df->bsf", x, w3)
        h = _silu(gate) * up
        out = torch.einsum("bsf,fd->bsd", h, w2)
        return out

    x = A_x
    h = x + _A_ref(_layernorm(x, axis=-1), A_wqkv, A_wo)
    h2 = h + _B_ref(_layernorm(h, axis=-1), B_w1, B_w3, B_w2)
    return h2
```

```asm
; @launch grid=(256,1,1) block=(512,1,1) lds=163840
.amdgcn_target "amdgcn-amd-amdhsa--gfx950"
.text
.globl sequential_preLN__softmax_full_mha__glu_gated_swiglu__prompt_kernel
.p2align 8
.type sequential_preLN__softmax_full_mha__glu_gated_swiglu__prompt_kernel,@function
sequential_preLN__softmax_full_mha__glu_gated_swiglu__prompt_kernel:
    s_lshr_b32 s46, s2, 3
    s_cmp_ge_u32 s46, 32
    s_cbranch_scc1 L_end
    s_load_dwordx4 s[68:71], s[0:1], 0
    s_and_b32 s45, s2, 7
    s_lshl_b32 s62, s45, 7
    s_lshl_b32 s63, s46, 16
    s_add_u32 s63, s63, s62
    s_mul_i32 s61, s46, 49152
    s_add_u32 s62, s62, s61
    v_lshl_add_u32 v2, v0, 10, s63
    v_subrev_u32 v3, 64, v0
    v_cmp_gt_u32 vcc, 64, v0
    v_cmp_gt_u32 s[64:65], 48, v3
    v_lshl_add_u32 v3, v3, 10, s62
    s_or_b64 s[58:59], vcc, s[64:65]
    s_cbranch_scc0 L_et
    s_mov_b64 exec, vcc
    s_waitcnt lgkmcnt(0)
    global_load_dword v4, v2, s[68:69]
    s_mov_b64 exec, s[64:65]
    global_load_dword v5, v3, s[70:71]
    s_mov_b64 exec, -1
L_et:
    s_load_dwordx2 s[12:13], s[0:1], 0
    s_load_dwordx2 s[16:17], s[0:1], 8
    s_load_dwordx2 s[8:9], s[0:1], 72
    s_load_dwordx2 s[20:21], s[0:1], 16
    s_load_dwordx2 s[24:25], s[0:1], 32
    s_load_dwordx2 s[28:29], s[0:1], 40
    s_load_dwordx2 s[32:33], s[0:1], 48
    s_load_dwordx2 s[36:37], s[0:1], 56
    s_load_dwordx2 s[40:41], s[0:1], 64
    v_lshrrev_b32 v1, 6, v0
    v_and_b32 v0, 63, v0
    v_readfirstlane_b32 s44, v1
    v_lshlrev_b32 v1, 4, v0
    s_lshr_b32 s48, s46, 1
    s_and_b32 s49, s46, 1
    s_lshl1_add_u32 s49, s45, s49
    s_mov_b32 s66, 0
    s_mov_b32 s14, 0x200000
    s_mov_b32 s15, 0x00020000
    s_mov_b32 s18, 0x180000
    s_mov_b32 s19, 0x00020000
    s_mov_b32 s10, 0x1200000
    s_mov_b32 s11, 0x00020000
    s_mov_b32 s22, 0x80000
    s_mov_b32 s23, 0x00020000
    s_mov_b32 s26, 0x158000
    s_mov_b32 s27, 0x00020000
    s_mov_b32 s30, 0x158000
    s_mov_b32 s31, 0x00020000
    s_mov_b32 s34, 0x158000
    s_mov_b32 s35, 0x00020000
    s_mov_b32 s38, 0x200000
    s_mov_b32 s39, 0x00020000
    s_mov_b32 s42, 0x100
    s_mov_b32 s43, 0x00020000
    s_mov_b32 s47, 20000
    s_cmp_lt_u32 s44, 4
    s_cbranch_scc1 L_compute
    s_sub_u32 s50, s44, 4
    s_lshl_b32 s53, s48, 17
    s_lshl_b32 s54, s50, 15
    s_add_u32 s53, s53, s54
    v_lshrrev_b32 v2, 3, v0
    v_lshlrev_b32 v2, 10, v2
    v_add_u32 v2, s53, v2
    v_and_b32 v3, 7, v0
    v_lshrrev_b32 v4, 4, v0
    v_xor_b32 v3, v3, v4
    v_lshl_add_u32 v8, v3, 4, v2
    v_xor_b32 v9, 64, v8
    v_add_u32 v9, 0x2000, v9
    v_add_u32 v10, 0x4000, v8
    v_add_u32 v11, 0x4000, v9
    s_mul_i32 s53, s50, 49152
    s_lshl_b32 s54, s49, 6
    s_add_u32 s53, s53, s54
    v_add_u32 v2, 0, v0
    v_mul_u32_u24 v3, 171, v2
    v_lshrrev_b32 v3, 11, v3
    v_mul_u32_u24 v4, 12, v3
    v_sub_u32 v4, v2, v4
    v_mul_u32_u24 v3, 3072, v3
    v_and_b32 v2, 3, v4
    v_lshl_add_u32 v3, v2, 4, v3
    v_lshrrev_b32 v4, 2, v4
    v_lshl_add_u32 v3, v4, 10, v3
    v_add_u32 v12, s53, v3
    v_add_u32 v2, 64, v0
    v_mul_u32_u24 v3, 171, v2
    v_lshrrev_b32 v3, 11, v3
    v_mul_u32_u24 v4, 12, v3
    v_sub_u32 v4, v2, v4
    v_mul_u32_u24 v3, 3072, v3
    v_and_b32 v2, 3, v4
    v_lshl_add_u32 v3, v2, 4, v3
    v_lshrrev_b32 v4, 2, v4
    v_lshl_add_u32 v3, v4, 10, v3
    v_add_u32 v13, s53, v3
    v_add_u32 v2, 128, v0
    v_mul_u32_u24 v3, 171, v2
    v_lshrrev_b32 v3, 11, v3
    v_mul_u32_u24 v4, 12, v3
    v_sub_u32 v4, v2, v4
    v_mul_u32_u24 v3, 3072, v3
    v_and_b32 v2, 3, v4
    v_lshl_add_u32 v3, v2, 4, v3
    v_lshrrev_b32 v4, 2, v4
    v_lshl_add_u32 v3, v4, 10, v3
    v_add_u32 v14, s53, v3
    s_lshl_b32 s51, s50, 12
    s_mul_i32 s52, s50, 3072
    s_waitcnt lgkmcnt(0)
    s_load_dwordx2 s[6:7], s[8:9], 0
    s_movk_i32 s53, 0
    s_mov_b32 s54, 0
    s_add_u32 m0, s51, 61440
    s_nop 0
    buffer_load_dwordx4 v8, s[12:15], s53 offen lds
    s_add_u32 m0, s52, 0
    s_nop 0
    buffer_load_dwordx4 v12, s[16:19], s54 offen lds
    s_add_u32 m0, s51, 62464
    s_nop 0
    buffer_load_dwordx4 v9, s[12:15], s53 offen lds
    s_add_u32 m0, s52, 1024
    s_nop 0
    buffer_load_dwordx4 v13, s[16:19], s54 offen lds
    s_add_u32 m0, s51, 63488
    s_nop 0
    buffer_load_dwordx4 v10, s[12:15], s53 offen lds
    s_add_u32 m0, s52, 2048
    s_nop 0
    buffer_load_dwordx4 v14, s[16:19], s54 offen lds
    s_add_u32 m0, s51, 64512
    s_nop 0
    buffer_load_dwordx4 v11, s[12:15], s53 offen lds
    s_movk_i32 s53, 128
    s_mov_b32 s54, 196608
    s_add_u32 m0, s51, 77824
    s_nop 0
    buffer_load_dwordx4 v8, s[12:15], s53 offen lds
    s_add_u32 m0, s52, 12288
    s_nop 0
    buffer_load_dwordx4 v12, s[16:19], s54 offen lds
    s_add_u32 m0, s51, 78848
    s_nop 0
    buffer_load_dwordx4 v9, s[12:15], s53 offen lds
    s_add_u32 m0, s52, 13312
    s_nop 0
    buffer_load_dwordx4 v13, s[16:19], s54 offen lds
    s_add_u32 m0, s51, 79872
    s_nop 0
    buffer_load_dwordx4 v10, s[12:15], s53 offen lds
    s_add_u32 m0, s52, 14336
    s_nop 0
    buffer_load_dwordx4 v14, s[16:19], s54 offen lds
    s_add_u32 m0, s51, 80896
    s_nop 0
    buffer_load_dwordx4 v11, s[12:15], s53 offen lds
    v_lshrrev_b32 v2, 5, v0
    v_lshlrev_b32 v2, 3, v2
    v_bfe_u32 v3, v0, 2, 2
    v_add_u32 v2, v2, v3
    v_mul_u32_u24 v15, 192, v2
    v_bfe_u32 v3, v0, 4, 1
    v_lshl_add_u32 v15, v3, 5, v15
    v_and_b32 v3, 3, v0
    v_lshl_add_u32 v15, v3, 3, v15
    s_min_u32 s62, s50, 2
    s_lshl_b32 s62, s62, 6
    v_add_u32 v15, s62, v15
    s_mov_b32 vcc_lo, 0x00100001
    s_mov_b32 vcc_hi, 0x00100001
    v_mov_b32 v2, 0
    v_mov_b32 v3, 0x3f803f80
    v_cndmask_b32 v44, v2, v3, vcc
    v_cndmask_b32 v45, v2, v3, vcc
    v_cndmask_b32 v46, v2, v3, vcc
    v_cndmask_b32 v47, v2, v3, vcc
    s_lshl_b32 s62, s62, 1
    s_add_u32 s62, s62, 161280
    v_lshl_add_u32 v16, v0, 2, s62
    v_lshrrev_b32 v2, 4, v0
    v_min_u32 v2, 2, v2
    v_mul_u32_u24 v2, 16896, v2
    v_bfe_u32 v3, v0, 1, 3
    v_mul_u32_u24 v3, 2112, v3
    v_add_u32 v2, v2, v3
    v_and_b32 v3, 1, v0
    v_mul_u32_u24 v3, 544, v3
    v_add_u32 v17, v2, v3
    v_mov_b32 v24, 0x3f803f80
    v_mov_b32 v25, 0x3f803f80
    v_mov_b32 v26, 0x3f803f80
    v_mov_b32 v27, 0x3f803f80
    v_mov_b32 v28, 0
    v_mov_b32 v29, 0
    v_mov_b32 v30, 0
    v_mov_b32 v31, 0
    v_lshrrev_b32 v2, 2, v0
    v_mul_u32_u24 v2, 2752, v2
    v_and_b32 v3, 3, v0
    v_lshl_add_u32 v2, v3, 4, v2
    s_mul_i32 s56, s50, 44032
    v_add_u32 v40, s56, v2
    v_lshrrev_b32 v2, 3, v0
    v_lshlrev_b32 v2, 10, v2
    v_bfe_u32 v3, v0, 4, 1
    v_lshlrev_b32 v3, 2, v3
    v_and_b32 v41, 7, v0
    v_xor_b32 v3, v3, v41
    v_lshl_add_u32 v2, v3, 4, v2
    s_lshr_b32 s56, s46, 2
    s_lshl_b32 s56, s56, 7
    s_lshl_b32 s60, s50, 13
    s_add_u32 s56, s56, s60
    v_add_u32 v41, s56, v2
    s_lshl_b32 s60, s50, 10
    s_lshr_b32 s56, s46, 1
    s_add_u32 s57, s56, 0
    s_lshl_b32 s57, s57, 6
    s_add_u32 s58, s56, 16
    s_lshl_b32 s58, s58, 6
    s_add_u32 s59, s56, 32
    s_lshl_b32 s59, s59, 6
    s_cmp_gt_u32 s56, 10
    s_cselect_b32 s59, 0x40000000, s59
    v_and_b32 v2, 1, v0
    v_lshlrev_b32 v2, 4, v2
    v_mov_b32 v3, 0x3f80
    v_lshlrev_b32 v2, v2, v3
    v_mov_b32 v32, 0
    v_mov_b32 v33, 0
    v_mov_b32 v34, 0
    v_mov_b32 v35, 0
    v_mov_b32 v36, 0
    v_mov_b32 v37, 0
    v_mov_b32 v38, 0
    v_mov_b32 v39, 0
    s_mov_b32 exec_lo, 0x30003
    s_mov_b32 exec_hi, 0x30003
    v_mov_b32 v32, v2
    s_mov_b32 exec_lo, 0xc000c
    s_mov_b32 exec_hi, 0xc000c
    v_mov_b32 v33, v2
    s_mov_b32 exec_lo, 0x300030
    s_mov_b32 exec_hi, 0x300030
    v_mov_b32 v34, v2
    s_mov_b32 exec_lo, 0xc000c0
    s_mov_b32 exec_hi, 0xc000c0
    v_mov_b32 v35, v2
    s_mov_b32 exec_lo, 0x3000300
    s_mov_b32 exec_hi, 0x3000300
    v_mov_b32 v36, v2
    s_mov_b32 exec_lo, 0xc000c00
    s_mov_b32 exec_hi, 0xc000c00
    v_mov_b32 v37, v2
    s_mov_b32 exec_lo, 0x30003000
    s_mov_b32 exec_hi, 0x30003000
    v_mov_b32 v38, v2
    s_mov_b32 exec_lo, 0xc000c000
    s_mov_b32 exec_hi, 0xc000c000
    v_mov_b32 v39, v2
    s_mov_b64 exec, -1
    v_mov_b32 v4, -1
    v_mov_b32 v5, -1
    v_mov_b32 v6, -1
    v_mov_b32 v7, -1
    v_add_u32 v42, s60, v1
    v_add_u32 v43, 65536, v42
    s_waitcnt lgkmcnt(0)
    s_mul_i32 s4, s6, 0x9e3779b1
    s_add_u32 s4, s4, 0x7f4a7c15
    s_mul_i32 s5, s7, 0x85ebca6d
    s_add_u32 s5, s5, 0x165667b1
    s_getreg_b32 s7, hwreg(HW_REG_XCC_ID, 0, 4)
    s_mov_b32 s6, s4
    s_xor_b32 s7, s7, s5
    s_waitcnt vmcnt(7)
    s_barrier
    ds_read_b64_tr_b16 v[48:49], v15 offset:0
    ds_read_b64_tr_b16 v[50:51], v15 offset:768
    ds_read_b64_tr_b16 v[52:53], v15 offset:3072
    ds_read_b64_tr_b16 v[54:55], v15 offset:3840
    ds_read_b64_tr_b16 v[56:57], v15 offset:6144
    ds_read_b64_tr_b16 v[58:59], v15 offset:6912
    ds_read_b64_tr_b16 v[60:61], v15 offset:9216
    ds_read_b64_tr_b16 v[62:63], v15 offset:9984
    s_movk_i32 s53, 256
    s_mov_b32 s54, 393216
    s_add_u32 m0, s51, 94208
    s_nop 0
    buffer_load_dwordx4 v8, s[12:15], s53 offen lds
    s_add_u32 m0, s52, 24576
    s_nop 0
    buffer_load_dwordx4 v12, s[16:19], s54 offen lds
    s_add_u32 m0, s51, 95232
    s_nop 0
    buffer_load_dwordx4 v9, s[12:15], s53 offen lds
    s_add_u32 m0, s52, 25600
    s_nop 0
    buffer_load_dwordx4 v13, s[16:19], s54 offen lds
    s_add_u32 m0, s51, 96256
    s_nop 0
    buffer_load_dwordx4 v10, s[12:15], s53 offen lds
    s_add_u32 m0, s52, 26624
    s_nop 0
    buffer_load_dwordx4 v14, s[16:19], s54 offen lds
    s_add_u32 m0, s51, 97280
    s_nop 0
    buffer_load_dwordx4 v11, s[12:15], s53 offen lds
    s_movk_i32 s53, 384
    s_mov_b32 s54, 589824
    s_add_u32 m0, s51, 110592
    s_nop 0
    buffer_load_dwordx4 v8, s[12:15], s53 offen lds
    s_add_u32 m0, s52, 36864
    s_nop 0
    buffer_load_dwordx4 v12, s[16:19], s54 offen lds
    s_add_u32 m0, s51, 111616
    s_nop 0
    buffer_load_dwordx4 v9, s[12:15], s53 offen lds
    s_add_u32 m0, s52, 37888
    s_nop 0
    buffer_load_dwordx4 v13, s[16:19], s54 offen lds
    s_add_u32 m0, s51, 112640
    s_nop 0
    buffer_load_dwordx4 v10, s[12:15], s53 offen lds
    s_add_u32 m0, s52, 38912
    s_nop 0
    buffer_load_dwordx4 v14, s[16:19], s54 offen lds
    s_add_u32 m0, s51, 113664
    s_nop 0
    buffer_load_dwordx4 v11, s[12:15], s53 offen lds
    s_waitcnt lgkmcnt(0)
    v_mfma_f32_16x16x32_bf16 v[20:23], v[44:47], v[48:51], 0
    v_mfma_f32_16x16x32_bf16 v[20:23], v[44:47], v[52:55], v[20:23]
    v_mfma_f32_16x16x32_bf16 v[20:23], v[44:47], v[56:59], v[20:23]
    v_mfma_f32_16x16x32_bf16 v[20:23], v[44:47], v[60:63], v[20:23]
    s_waitcnt vmcnt(14)
    s_barrier
    ds_read_b64_tr_b16 v[48:49], v15 offset:12288
    ds_read_b64_tr_b16 v[50:51], v15 offset:13056
    ds_read_b64_tr_b16 v[52:53], v15 offset:15360
    ds_read_b64_tr_b16 v[54:55], v15 offset:16128
    ds_read_b64_tr_b16 v[56:57], v15 offset:18432
    ds_read_b64_tr_b16 v[58:59], v15 offset:19200
    ds_read_b64_tr_b16 v[60:61], v15 offset:21504
    ds_read_b64_tr_b16 v[62:63], v15 offset:22272
    s_movk_i32 s53, 512
    s_mov_b32 s54, 786432
    s_add_u32 m0, s51, 126976
    s_nop 0
    buffer_load_dwordx4 v8, s[12:15], s53 offen lds
    s_add_u32 m0, s52, 49152
    s_nop 0
    buffer_load_dwordx4 v12, s[16:19], s54 offen lds
    s_add_u32 m0, s51, 128000
    s_nop 0
    buffer_load_dwordx4 v9, s[12:15], s53 offen lds
    s_add_u32 m0, s52, 50176
    s_nop 0
    buffer_load_dwordx4 v13, s[16:19], s54 offen lds
    s_add_u32 m0, s51, 129024
    s_nop 0
    buffer_load_dwordx4 v10, s[12:15], s53 offen lds
    s_add_u32 m0, s52, 51200
    s_nop 0
    buffer_load_dwordx4 v14, s[16:19], s54 offen lds
    s_add_u32 m0, s51, 130048
    s_nop 0
    buffer_load_dwordx4 v11, s[12:15], s53 offen lds
    s_waitcnt lgkmcnt(0)
    v_mfma_f32_16x16x32_bf16 v[20:23], v[44:47], v[48:51], v[20:23]
    v_mfma_f32_16x16x32_bf16 v[20:23], v[44:47], v[52:55], v[20:23]
    v_mfma_f32_16x16x32_bf16 v[20:23], v[44:47], v[56:59], v[20:23]
    v_mfma_f32_16x16x32_bf16 v[20:23], v[44:47], v[60:63], v[20:23]
    s_waitcnt vmcnt(14)
    s_barrier
    ds_read_b64_tr_b16 v[48:49], v15 offset:24576
    ds_read_b64_tr_b16 v[50:51], v15 offset:25344
    ds_read_b64_tr_b16 v[52:53], v15 offset:27648
    ds_read_b64_tr_b16 v[54:55], v15 offset:28416
    ds_read_b64_tr_b16 v[56:57], v15 offset:30720
    ds_read_b64_tr_b16 v[58:59], v15 offset:31488
    ds_read_b64_tr_b16 v[60:61], v15 offset:33792
    ds_read_b64_tr_b16 v[62:63], v15 offset:34560
    s_movk_i32 s53, 640
    s_mov_b32 s54, 983040
    s_add_u32 m0, s51, 61440
    s_nop 0
    buffer_load_dwordx4 v8, s[12:15], s53 offen lds
    s_add_u32 m0, s52, 0
    s_nop 0
    buffer_load_dwordx4 v12, s[16:19], s54 offen lds
    s_add_u32 m0, s51, 62464
    s_nop 0
    buffer_load_dwordx4 v9, s[12:15], s53 offen lds
    s_add_u32 m0, s52, 1024
    s_nop 0
    buffer_load_dwordx4 v13, s[16:19], s54 offen lds
    s_add_u32 m0, s51, 63488
    s_nop 0
    buffer_load_dwordx4 v10, s[12:15], s53 offen lds
    s_add_u32 m0, s52, 2048
    s_nop 0
    buffer_load_dwordx4 v14, s[16:19], s54 offen lds
    s_add_u32 m0, s51, 64512
    s_nop 0
    buffer_load_dwordx4 v11, s[12:15], s53 offen lds
    s_waitcnt lgkmcnt(0)
    v_mfma_f32_16x16x32_bf16 v[20:23], v[44:47], v[48:51], v[20:23]
    v_mfma_f32_16x16x32_bf16 v[20:23], v[44:47], v[52:55], v[20:23]
    v_mfma_f32_16x16x32_bf16 v[20:23], v[44:47], v[56:59], v[20:23]
    v_mfma_f32_16x16x32_bf16 v[20:23], v[44:47], v[60:63], v[20:23]
    s_waitcnt vmcnt(14)
    s_barrier
    ds_read_b64_tr_b16 v[48:49], v15 offset:36864
    ds_read_b64_tr_b16 v[50:51], v15 offset:37632
    ds_read_b64_tr_b16 v[52:53], v15 offset:39936
    ds_read_b64_tr_b16 v[54:55], v15 offset:40704
    ds_read_b64_tr_b16 v[56:57], v15 offset:43008
    ds_read_b64_tr_b16 v[58:59], v15 offset:43776
    ds_read_b64_tr_b16 v[60:61], v15 offset:46080
    ds_read_b64_tr_b16 v[62:63], v15 offset:46848
    s_movk_i32 s53, 768
    s_mov_b32 s54, 1179648
    s_add_u32 m0, s51, 77824
    s_nop 0
    buffer_load_dwordx4 v8, s[12:15], s53 offen lds
    s_add_u32 m0, s52, 12288
    s_nop 0
    buffer_load_dwordx4 v12, s[16:19], s54 offen lds
    s_add_u32 m0, s51, 78848
    s_nop 0
    buffer_load_dwordx4 v9, s[12:15], s53 offen lds
    s_add_u32 m0, s52, 13312
    s_nop 0
    buffer_load_dwordx4 v13, s[16:19], s54 offen lds
    s_add_u32 m0, s51, 79872
    s_nop 0
    buffer_load_dwordx4 v10, s[12:15], s53 offen lds
    s_add_u32 m0, s52, 14336
    s_nop 0
    buffer_load_dwordx4 v14, s[16:19], s54 offen lds
    s_add_u32 m0, s51, 80896
    s_nop 0
    buffer_load_dwordx4 v11, s[12:15], s53 offen lds
    s_waitcnt lgkmcnt(0)
    v_mfma_f32_16x16x32_bf16 v[20:23], v[44:47], v[48:51], v[20:23]
    v_mfma_f32_16x16x32_bf16 v[20:23], v[44:47], v[52:55], v[20:23]
    v_mfma_f32_16x16x32_bf16 v[20:23], v[44:47], v[56:59], v[20:23]
    v_mfma_f32_16x16x32_bf16 v[20:23], v[44:47], v[60:63], v[20:23]
    s_waitcnt vmcnt(14)
    s_barrier
    ds_read_b64_tr_b16 v[48:49], v15 offset:49152
    ds_read_b64_tr_b16 v[50:51], v15 offset:49920
    ds_read_b64_tr_b16 v[52:53], v15 offset:52224
    ds_read_b64_tr_b16 v[54:55], v15 offset:52992
    ds_read_b64_tr_b16 v[56:57], v15 offset:55296
    ds_read_b64_tr_b16 v[58:59], v15 offset:56064
    ds_read_b64_tr_b16 v[60:61], v15 offset:58368
    ds_read_b64_tr_b16 v[62:63], v15 offset:59136
    s_movk_i32 s53, 896
    s_mov_b32 s54, 1376256
    s_add_u32 m0, s51, 94208
    s_nop 0
    buffer_load_dwordx4 v8, s[12:15], s53 offen lds
    s_add_u32 m0, s52, 24576
    s_nop 0
    buffer_load_dwordx4 v12, s[16:19], s54 offen lds
    s_add_u32 m0, s51, 95232
    s_nop 0
    buffer_load_dwordx4 v9, s[12:15], s53 offen lds
    s_add_u32 m0, s52, 25600
    s_nop 0
    buffer_load_dwordx4 v13, s[16:19], s54 offen lds
    s_add_u32 m0, s51, 96256
    s_nop 0
    buffer_load_dwordx4 v10, s[12:15], s53 offen lds
    s_add_u32 m0, s52, 26624
    s_nop 0
    buffer_load_dwordx4 v14, s[16:19], s54 offen lds
    s_add_u32 m0, s51, 97280
    s_nop 0
    buffer_load_dwordx4 v11, s[12:15], s53 offen lds
    s_waitcnt lgkmcnt(0)
    v_mfma_f32_16x16x32_bf16 v[20:23], v[44:47], v[48:51], v[20:23]
    v_mfma_f32_16x16x32_bf16 v[20:23], v[44:47], v[52:55], v[20:23]
    v_mfma_f32_16x16x32_bf16 v[20:23], v[44:47], v[56:59], v[20:23]
    v_mfma_f32_16x16x32_bf16 v[20:23], v[44:47], v[60:63], v[20:23]
    s_waitcnt vmcnt(14)
    s_barrier
    ds_read_b64_tr_b16 v[48:49], v15 offset:0
    ds_read_b64_tr_b16 v[50:51], v15 offset:768
    ds_read_b64_tr_b16 v[52:53], v15 offset:3072
    ds_read_b64_tr_b16 v[54:55], v15 offset:3840
    ds_read_b64_tr_b16 v[56:57], v15 offset:6144
    ds_read_b64_tr_b16 v[58:59], v15 offset:6912
    ds_read_b64_tr_b16 v[60:61], v15 offset:9216
    ds_read_b64_tr_b16 v[62:63], v15 offset:9984
    s_waitcnt lgkmcnt(0)
    v_mfma_f32_16x16x32_bf16 v[20:23], v[44:47], v[48:51], v[20:23]
    v_mfma_f32_16x16x32_bf16 v[20:23], v[44:47], v[52:55], v[20:23]
    v_mfma_f32_16x16x32_bf16 v[20:23], v[44:47], v[56:59], v[20:23]
    v_mfma_f32_16x16x32_bf16 v[20:23], v[44:47], v[60:63], v[20:23]
    s_waitcnt vmcnt(7)
    s_barrier
    ds_read_b64_tr_b16 v[48:49], v15 offset:12288
    ds_read_b64_tr_b16 v[50:51], v15 offset:13056
    ds_read_b64_tr_b16 v[52:53], v15 offset:15360
    ds_read_b64_tr_b16 v[54:55], v15 offset:16128
    ds_read_b64_tr_b16 v[56:57], v15 offset:18432
    ds_read_b64_tr_b16 v[58:59], v15 offset:19200
    ds_read_b64_tr_b16 v[60:61], v15 offset:21504
    ds_read_b64_tr_b16 v[62:63], v15 offset:22272
    s_waitcnt lgkmcnt(0)
    v_mfma_f32_16x16x32_bf16 v[20:23], v[44:47], v[48:51], v[20:23]
    v_mfma_f32_16x16x32_bf16 v[20:23], v[44:47], v[52:55], v[20:23]
    v_mfma_f32_16x16x32_bf16 v[20:23], v[44:47], v[56:59], v[20:23]
    v_mfma_f32_16x16x32_bf16 v[20:23], v[44:47], v[60:63], v[20:23]
    s_waitcnt vmcnt(0)
    s_barrier
    ds_read_b64_tr_b16 v[48:49], v15 offset:24576
    ds_read_b64_tr_b16 v[50:51], v15 offset:25344
    ds_read_b64_tr_b16 v[52:53], v15 offset:27648
    ds_read_b64_tr_b16 v[54:55], v15 offset:28416
    ds_read_b64_tr_b16 v[56:57], v15 offset:30720
    ds_read_b64_tr_b16 v[58:59], v15 offset:31488
    ds_read_b64_tr_b16 v[60:61], v15 offset:33792
    ds_read_b64_tr_b16 v[62:63], v15 offset:34560
    s_waitcnt lgkmcnt(0)
    v_mfma_f32_16x16x32_bf16 v[20:23], v[44:47], v[48:51], v[20:23]
    v_mfma_f32_16x16x32_bf16 v[20:23], v[44:47], v[52:55], v[20:23]
    v_mfma_f32_16x16x32_bf16 v[20:23], v[44:47], v[56:59], v[20:23]
    v_mfma_f32_16x16x32_bf16 v[20:23], v[44:47], v[60:63], v[20:23]
    s_and_b32 s53, s46, 1
    s_lshl1_add_u32 s53, s45, s53
    s_bfe_u32 s61, s46, 0x10001
    s_lshl1_add_u32 s53, s53, s61
    s_lshr_b32 s61, s46, 2
    v_and_b32 v8, 0x33, v0
    v_bfe_u32 v2, v0, 2, 1
    v_lshl_or_b32 v8, v2, 3, v8
    v_bfe_u32 v2, v0, 3, 1
    v_lshl_or_b32 v8, v2, 2, v8
    v_lshlrev_b32 v8, 4, v8
    v_add_u32 v9, 0x200000, v1
    s_mov_b32 exec_hi, 0
    ds_write_b32 v16, v20
    s_mov_b32 exec_hi, -1
    s_mul_i32 s61, s50, 2112
    s_add_u32 s62, s61, 33984
    v_add_u32 v10, s62, v1
    v_lshrrev_b32 v2, 5, v0
    v_lshlrev_b32 v2, 5, v2
    s_add_u32 s62, s61, 32896
    v_add3_u32 v11, v1, v2, s62
    s_lshl_b32 s54, s53, 16
    s_lshr_b32 s61, s46, 2
    s_lshl_b32 s61, s61, 13
    s_add_u32 s54, s54, s61
    s_lshl_b32 s61, s50, 10
    s_add_u32 s54, s54, s61
    s_add_u32 s54, s54, 3145728
    s_waitcnt lgkmcnt(0)
    s_barrier
    ds_write_b128 v17, v[24:27] offset:33408
    ds_write_b128 v17, v[28:31] offset:33424
    v_add_u32 v44, 131072, v42
    s_barrier
    buffer_load_dwordx4 v[128:131], v8, s[8:11], s54 offen sc1
    buffer_load_dwordx4 v[132:135], v9, s[8:11], s54 offen sc1
    s_xor_b32 s55, s54, 4096
    buffer_load_dwordx4 v[136:139], v8, s[8:11], s55 offen sc1
    buffer_load_dwordx4 v[140:143], v9, s[8:11], s55 offen sc1
    s_waitcnt vmcnt(0)
    v_max3_u32 v2, v131, v135, v139
    v_max_u32 v2, v2, v143
    v_cmp_eq_u32 vcc, -1, v2
    s_cbranch_vccnz L_slow_1
L_back_2:
    ds_write_b128 v10, v[128:131] offset:0
    ds_write_b128 v11, v[132:135] offset:0
    ds_write_b128 v10, v[136:139] offset:8448
    ds_write_b128 v11, v[140:143] offset:8448
    s_waitcnt lgkmcnt(0)
    s_barrier
    s_mul_i32 s3, s45, 512
    s_add_u32 s3, s3, 4096
    v_and_b32 v17, 31, v0
    v_mul_u32_u24 v17, 16, v17
    v_add_u32 v17, s3, v17
    buffer_load_dwordx2 v[18:19], v17, s[8:11], 0 offen sc1
    s_xor_b32 s55, s54, 8192
    buffer_load_dwordx4 v[144:147], v8, s[8:11], s55 offen sc1
    buffer_load_dwordx4 v[148:151], v9, s[8:11], s55 offen sc1
    s_xor_b32 s55, s54, 12288
    buffer_load_dwordx4 v[152:155], v8, s[8:11], s55 offen sc1
    buffer_load_dwordx4 v[156:159], v9, s[8:11], s55 offen sc1
    s_xor_b32 s55, s54, 16384
    buffer_load_dwordx4 v[160:163], v8, s[8:11], s55 offen sc1
    buffer_load_dwordx4 v[164:167], v9, s[8:11], s55 offen sc1
    s_xor_b32 s55, s54, 20480
    buffer_load_dwordx4 v[168:171], v8, s[8:11], s55 offen sc1
    buffer_load_dwordx4 v[172:175], v9, s[8:11], s55 offen sc1
    s_xor_b32 s55, s54, 24576
    buffer_load_dwordx4 v[176:179], v8, s[8:11], s55 offen sc1
    buffer_load_dwordx4 v[180:183], v9, s[8:11], s55 offen sc1
    s_xor_b32 s55, s54, 28672
    buffer_load_dwordx4 v[184:187], v8, s[8:11], s55 offen sc1
    buffer_load_dwordx4 v[188:191], v9, s[8:11], s55 offen sc1
    s_xor_b32 s55, s54, 32768
    buffer_load_dwordx4 v[192:195], v8, s[8:11], s55 offen sc1
    buffer_load_dwordx4 v[196:199], v9, s[8:11], s55 offen sc1
    s_xor_b32 s55, s54, 36864
    buffer_load_dwordx4 v[200:203], v8, s[8:11], s55 offen sc1
    buffer_load_dwordx4 v[204:207], v9, s[8:11], s55 offen sc1
    s_lshl_b32 s61, s2, 2
    s_add_u32 s61, s61, s50
    s_mul_i32 s61, s61, 1408
    v_lshlrev_b32 v2, 6, v0
    s_mov_b64 exec, 0x3fffff
    buffer_load_dword v28, v2, s[20:23], s61 offen
    buffer_load_dword v29, v2, s[24:27], s61 offen
    buffer_load_dword v30, v2, s[28:31], s61 offen
    buffer_load_dword v31, v2, s[32:35], s61 offen
    s_mov_b64 exec, -1
    s_waitcnt vmcnt(16)
    v_max3_u32 v2, v147, v151, v155
    v_max_u32 v2, v2, v159
    v_cmp_eq_u32 vcc, -1, v2
    s_cbranch_vccnz L_slow_5
L_back_6:
    ds_write_b128 v10, v[144:147] offset:16896
    ds_write_b128 v11, v[148:151] offset:16896
    ds_write_b128 v10, v[152:155] offset:25344
    ds_write_b128 v11, v[156:159] offset:25344
    s_waitcnt lgkmcnt(0)
    s_barrier
    s_xor_b32 s55, s54, 40960
    buffer_load_dwordx4 v[208:211], v8, s[8:11], s55 offen sc1
    buffer_load_dwordx4 v[212:215], v9, s[8:11], s55 offen sc1
    s_xor_b32 s55, s54, 45056
    buffer_load_dwordx4 v[216:219], v8, s[8:11], s55 offen sc1
    buffer_load_dwordx4 v[220:223], v9, s[8:11], s55 offen sc1
    s_xor_b32 s55, s54, 49152
    buffer_load_dwordx4 v[224:227], v8, s[8:11], s55 offen sc1
    buffer_load_dwordx4 v[228:231], v9, s[8:11], s55 offen sc1
    s_xor_b32 s55, s54, 53248
    buffer_load_dwordx4 v[232:235], v8, s[8:11], s55 offen sc1
    buffer_load_dwordx4 v[236:239], v9, s[8:11], s55 offen sc1
    s_xor_b32 s55, s54, 57344
    buffer_load_dwordx4 v[240:243], v8, s[8:11], s55 offen sc1
    buffer_load_dwordx4 v[244:247], v9, s[8:11], s55 offen sc1
    s_xor_b32 s55, s54, 61440
    buffer_load_dwordx4 v[248:251], v8, s[8:11], s55 offen sc1
    buffer_load_dwordx4 v[252:255], v9, s[8:11], s55 offen sc1
    s_waitcnt vmcnt(24)
    v_max3_u32 v2, v163, v167, v171
    v_max_u32 v2, v2, v175
    v_cmp_eq_u32 vcc, -1, v2
    s_cbranch_vccnz L_slow_9
L_back_10:
    ds_write_b128 v10, v[160:163] offset:33792
    ds_write_b128 v11, v[164:167] offset:33792
    ds_write_b128 v10, v[168:171] offset:42240
    ds_write_b128 v11, v[172:175] offset:42240
    v_cmp_ne_u64 vcc, s[6:7], v[18:19]
    s_cmp_lg_u64 vcc, 0
    s_cselect_b32 s66, 1, 0
    s_lshl_b32 s62, s45, 2
    s_and_b32 s65, s46, 3
    s_add_u32 s62, s62, s65
    s_lshl_b32 s62, s62, 1
    s_and_b32 s65, s50, 1
    s_add_u32 s62, s62, s65
    s_lshr_b32 s63, s50, 1
    s_lshr_b32 s64, s46, 2
    s_lshl_b32 s64, s64, 1
    s_add_u32 s64, s64, s63
    s_lshl_b32 s61, s62, 4
    s_add_u32 s61, s61, s64
    s_lshl_b32 s62, s61, 11
    s_add_u32 s62, s62, 9437184
    s_lshl_b32 s61, s61, 8
    s_add_u32 s61, s61, 17170432
    s_cmp_lg_u32 s66, 0
    s_cbranch_scc1 L_wt_13
    buffer_store_dwordx4 v[4:7], v1, s[8:11], s62 offen offset:0
    buffer_store_dwordx4 v[4:7], v1, s[8:11], s62 offen offset:1024
    s_mov_b64 exec, 0xffff
    buffer_store_dwordx4 v[4:7], v1, s[8:11], s61 offen offset:0
    s_mov_b64 exec, -1
L_wb_14:
    s_and_b32 s61, s46, 1
    s_lshl1_add_u32 s61, s45, s61
    s_lshl2_add_u32 s61, s61, s50
    s_lshr_b32 s62, s46, 1
    s_mul_i32 s67, s61, 88064
    s_lshl_b32 s68, s62, 11
    s_add_u32 s67, s67, s68
    s_add_u32 s63, s67, 11534336
    s_add_u32 s64, s67, 11567104
    s_add_u32 s65, s67, 11599872
    s_lshl_b32 s67, s62, 6
    s_add_u32 s67, s67, s61
    s_lshl_b32 s67, s67, 11
    s_add_u32 s67, s67, 4293787648
    s_cmp_gt_u32 s62, 10
    s_cselect_b32 s65, s67, s65
    s_cmp_lg_u32 s66, 0
    s_cbranch_scc1 L_wt_15
    buffer_store_dwordx4 v[4:7], v1, s[8:11], s63 offen offset:0
    buffer_store_dwordx4 v[4:7], v1, s[8:11], s63 offen offset:1024
    buffer_store_dwordx4 v[4:7], v1, s[8:11], s64 offen offset:0
    buffer_store_dwordx4 v[4:7], v1, s[8:11], s64 offen offset:1024
    buffer_store_dwordx4 v[4:7], v1, s[8:11], s65 offen offset:0
    buffer_store_dwordx4 v[4:7], v1, s[8:11], s65 offen offset:1024
L_wb_16:
    s_waitcnt lgkmcnt(0)
    s_barrier
    s_waitcnt vmcnt(29)
    v_max3_u32 v2, v179, v183, v187
    v_max_u32 v2, v2, v191
    v_cmp_eq_u32 vcc, -1, v2
    s_cbranch_vccnz L_slow_17
L_back_18:
    ds_write_b128 v10, v[176:179] offset:0
    ds_write_b128 v11, v[180:183] offset:0
    ds_write_b128 v10, v[184:187] offset:8448
    ds_write_b128 v11, v[188:191] offset:8448
    s_add_u32 s61, s57, 0
    buffer_load_dwordx4 v[128:131], v40, s[24:27], s61 offen
    buffer_load_dwordx4 v[132:135], v40, s[28:31], s61 offen
    s_add_u32 s61, s57, 176128
    buffer_load_dwordx4 v[136:139], v40, s[24:27], s61 offen
    buffer_load_dwordx4 v[140:143], v40, s[28:31], s61 offen
    s_add_u32 s61, s57, 352256
    buffer_load_dwordx4 v[144:147], v40, s[24:27], s61 offen
    buffer_load_dwordx4 v[148:151], v40, s[28:31], s61 offen
    s_add_u32 s61, s57, 528384
    buffer_load_dwordx4 v[152:155], v40, s[24:27], s61 offen
    buffer_load_dwordx4 v[156:159], v40, s[28:31], s61 offen
    s_lshl_b32 s61, s2, 2
    s_add_u32 s61, s61, s50
    s_lshl_b32 s61, s61, 11
    s_add_u32 s61, s61, 7340032
    buffer_store_dwordx4 v[4:7], v1, s[8:11], s61 offen offset:0 sc1
    buffer_store_dwordx4 v[4:7], v1, s[8:11], s61 offen offset:1024 sc1
    s_mov_b32 s61, 753664
    buffer_load_dwordx4 v[48:51], v41, s[32:35], s61 offen
    s_mov_b32 s61, 786432
    buffer_load_dwordx4 v[52:55], v41, s[32:35], s61 offen
    s_mov_b32 s61, 819200
    buffer_load_dwordx4 v[56:59], v41, s[32:35], s61 offen
    s_mov_b32 s61, 851968
    buffer_load_dwordx4 v[60:63], v41, s[32:35], s61 offen
    s_mov_b32 s61, 0
    s_add_u32 m0, s60, 95744
    s_nop 0
    buffer_load_dwordx4 v41, s[20:23], s61 offen lds
    s_mov_b32 s61, 32768
    s_add_u32 m0, s60, 99840
    s_nop 0
    buffer_load_dwordx4 v41, s[20:23], s61 offen lds
    s_waitcnt lgkmcnt(0)
    s_barrier
    s_waitcnt vmcnt(41)
    v_max3_u32 v2, v195, v199, v203
    v_max_u32 v2, v2, v207
    v_cmp_eq_u32 vcc, -1, v2
    s_cbranch_vccnz L_slow_21
L_back_22:
    ds_write_b128 v10, v[192:195] offset:16896
    ds_write_b128 v11, v[196:199] offset:16896
    ds_write_b128 v10, v[200:203] offset:25344
    ds_write_b128 v11, v[204:207] offset:25344
    s_waitcnt vmcnt(12)
    v_mfma_f32_16x16x32_bf16 v[20:23], v[128:131], v[32:35], 0
    v_mfma_f32_16x16x32_bf16 v[20:23], v[132:135], v[36:39], v[20:23]
    v_mfma_f32_16x16x32_bf16 v[20:23], v[136:139], v[32:35], v[20:23]
    v_mfma_f32_16x16x32_bf16 v[20:23], v[140:143], v[36:39], v[20:23]
    s_waitcnt vmcnt(8)
    v_mfma_f32_16x16x32_bf16 v[20:23], v[144:147], v[32:35], v[20:23]
    v_mfma_f32_16x16x32_bf16 v[20:23], v[148:151], v[36:39], v[20:23]
    v_mfma_f32_16x16x32_bf16 v[20:23], v[152:155], v[32:35], v[20:23]
    v_mfma_f32_16x16x32_bf16 v[20:23], v[156:159], v[36:39], v[20:23]
    ds_write_b128 v42, v[128:131] offset:0
    ds_write_b128 v42, v[132:135] offset:8224
    ds_write_b128 v42, v[136:139] offset:4096
    ds_write_b128 v42, v[140:143] offset:12320
    ds_write_b128 v42, v[144:147] offset:16448
    ds_write_b128 v42, v[148:151] offset:24672
    ds_write_b128 v42, v[152:155] offset:20544
    ds_write_b128 v42, v[156:159] offset:28768
    s_add_u32 s61, s57, 704512
    buffer_load_dwordx4 v[160:163], v40, s[24:27], s61 offen
    buffer_load_dwordx4 v[164:167], v40, s[28:31], s61 offen
    s_add_u32 s61, s57, 880640
    buffer_load_dwordx4 v[168:171], v40, s[24:27], s61 offen
    buffer_load_dwordx4 v[172:175], v40, s[28:31], s61 offen
    s_add_u32 s61, s59, 0
    buffer_load_dwordx4 v[176:179], v40, s[24:27], s61 offen
    buffer_load_dwordx4 v[180:183], v40, s[28:31], s61 offen
    s_add_u32 s61, s59, 176128
    buffer_load_dwordx4 v[184:187], v40, s[24:27], s61 offen
    buffer_load_dwordx4 v[188:191], v40, s[28:31], s61 offen
    s_mov_b32 s61, 884736
    buffer_load_dwordx4 v[64:67], v41, s[32:35], s61 offen
    s_mov_b32 s61, 917504
    buffer_load_dwordx4 v[68:71], v41, s[32:35], s61 offen
    s_mov_b32 s61, 950272
    buffer_load_dwordx4 v[72:75], v41, s[32:35], s61 offen
    s_mov_b32 s61, 983040
    buffer_load_dwordx4 v[76:79], v41, s[32:35], s61 offen
    s_mov_b32 s61, 65536
    s_add_u32 m0, s60, 103936
    s_nop 0
    buffer_load_dwordx4 v41, s[20:23], s61 offen lds
    s_mov_b32 s61, 98304
    s_add_u32 m0, s60, 108032
    s_nop 0
    buffer_load_dwordx4 v41, s[20:23], s61 offen lds
    s_mov_b32 s61, 131072
    s_add_u32 m0, s60, 112128
    s_nop 0
    buffer_load_dwordx4 v41, s[20:23], s61 offen lds
    s_waitcnt lgkmcnt(0)
    s_barrier
    v_max3_u32 v2, v211, v215, v219
    v_max_u32 v2, v2, v223
    v_cmp_eq_u32 vcc, -1, v2
    s_cbranch_vccnz L_slow_25
L_back_26:
    ds_write_b128 v10, v[208:211] offset:33792
    ds_write_b128 v11, v[212:215] offset:33792
    ds_write_b128 v10, v[216:219] offset:42240
    ds_write_b128 v11, v[220:223] offset:42240
    s_waitcnt vmcnt(21)
    s_add_u32 s61, s59, 352256
    buffer_load_dwordx4 v[128:131], v40, s[24:27], s61 offen
    buffer_load_dwordx4 v[132:135], v40, s[28:31], s61 offen
    s_add_u32 s61, s59, 528384
    buffer_load_dwordx4 v[136:139], v40, s[24:27], s61 offen
    buffer_load_dwordx4 v[140:143], v40, s[28:31], s61 offen
    s_add_u32 s61, s59, 704512
    buffer_load_dwordx4 v[144:147], v40, s[24:27], s61 offen
    buffer_load_dwordx4 v[148:151], v40, s[28:31], s61 offen
    s_add_u32 s61, s59, 880640
    buffer_load_dwordx4 v[152:155], v40, s[24:27], s61 offen
    buffer_load_dwordx4 v[156:159], v40, s[28:31], s61 offen
    s_add_u32 s61, s59, 1056768
    buffer_load_dwordx4 v[192:195], v40, s[24:27], s61 offen
    buffer_load_dwordx4 v[196:199], v40, s[28:31], s61 offen
    s_add_u32 s61, s59, 1232896
    buffer_load_dwordx4 v[200:203], v40, s[24:27], s61 offen
    buffer_load_dwordx4 v[204:207], v40, s[28:31], s61 offen
    s_mov_b32 s61, 1015808
    buffer_load_dwordx4 v[80:83], v41, s[32:35], s61 offen
    s_mov_b32 s61, 1048576
    buffer_load_dwordx4 v[84:87], v41, s[32:35], s61 offen
    s_mov_b32 s61, 1081344
    buffer_load_dwordx4 v[88:91], v41, s[32:35], s61 offen
    s_mov_b32 s61, 1114112
    buffer_load_dwordx4 v[92:95], v41, s[32:35], s61 offen
    s_mov_b32 s61, 163840
    s_add_u32 m0, s60, 116224
    s_nop 0
    buffer_load_dwordx4 v41, s[20:23], s61 offen lds
    s_mov_b32 s61, 196608
    s_add_u32 m0, s60, 120320
    s_nop 0
    buffer_load_dwordx4 v41, s[20:23], s61 offen lds
    s_mov_b32 s61, 229376
    s_add_u32 m0, s60, 124416
    s_nop 0
    buffer_load_dwordx4 v41, s[20:23], s61 offen lds
    s_waitcnt vmcnt(30)
    v_mfma_f32_16x16x32_bf16 v[20:23], v[160:163], v[32:35], v[20:23]
    v_mfma_f32_16x16x32_bf16 v[20:23], v[164:167], v[36:39], v[20:23]
    v_mfma_f32_16x16x32_bf16 v[20:23], v[168:171], v[32:35], v[20:23]
    v_mfma_f32_16x16x32_bf16 v[20:23], v[172:175], v[36:39], v[20:23]
    s_waitcnt vmcnt(26)
    v_mfma_f32_16x16x32_bf16 v[28:31], v[176:179], v[32:35], 0
    v_mfma_f32_16x16x32_bf16 v[28:31], v[180:183], v[36:39], v[28:31]
    v_mfma_f32_16x16x32_bf16 v[28:31], v[184:187], v[32:35], v[28:31]
    v_mfma_f32_16x16x32_bf16 v[28:31], v[188:191], v[36:39], v[28:31]
    s_waitcnt lgkmcnt(0)
    s_barrier
    s_mul_i32 s61, s2, 16
    s_add_u32 s61, s61, 8192
    s_cmp_lg_u32 s50, 0
    s_cbranch_scc1 L_only_29
    s_mov_b64 exec, 1
    v_mov_b32 v2, s4
    v_mov_b32 v3, s5
    buffer_store_dwordx2 v[2:3], off, s[8:11], s61 sc1
    s_mov_b64 exec, -1
L_only_29:
    v_max3_u32 v2, v227, v231, v235
    v_max_u32 v2, v2, v239
    v_cmp_eq_u32 vcc, -1, v2
    s_cbranch_vccnz L_slow_30
L_back_31:
    ds_write_b128 v10, v[224:227] offset:0
    ds_write_b128 v11, v[228:231] offset:0
    ds_write_b128 v10, v[232:235] offset:8448
    ds_write_b128 v11, v[236:239] offset:8448
    s_add_u32 s61, s57, 1056768
    buffer_load_dwordx4 v[176:179], v40, s[24:27], s61 offen
    buffer_load_dwordx4 v[180:183], v40, s[28:31], s61 offen
    s_add_u32 s61, s57, 1232896
    buffer_load_dwordx4 v[184:187], v40, s[24:27], s61 offen
    buffer_load_dwordx4 v[188:191], v40, s[28:31], s61 offen
    s_add_u32 s61, s58, 0
    buffer_load_dwordx4 v[208:211], v40, s[24:27], s61 offen
    buffer_load_dwordx4 v[212:215], v40, s[28:31], s61 offen
    s_add_u32 s61, s58, 176128
    buffer_load_dwordx4 v[216:219], v40, s[24:27], s61 offen
    buffer_load_dwordx4 v[220:223], v40, s[28:31], s61 offen
    s_mov_b32 s61, 1146880
    buffer_load_dwordx4 v[96:99], v41, s[32:35], s61 offen
    s_mov_b32 s61, 1179648
    buffer_load_dwordx4 v[100:103], v41, s[32:35], s61 offen
    s_mov_b32 s61, 1212416
    buffer_load_dwordx4 v[104:107], v41, s[32:35], s61 offen
    s_mov_b32 s61, 1245184
    buffer_load_dwordx4 v[108:111], v41, s[32:35], s61 offen
    s_mov_b32 s61, 1277952
    buffer_load_dwordx4 v[112:115], v41, s[32:35], s61 offen
    s_mov_b32 s61, 1310720
    buffer_load_dwordx4 v[116:119], v41, s[32:35], s61 offen
    s_mov_b32 s61, 1343488
    buffer_load_dwordx4 v[120:123], v41, s[32:35], s61 offen
    s_mov_b32 s61, 1376256
    buffer_load_dwordx4 v[124:127], v41, s[32:35], s61 offen
    s_mov_b32 s61, 262144
    s_add_u32 m0, s60, 128512
    s_nop 0
    buffer_load_dwordx4 v41, s[20:23], s61 offen lds
    s_mov_b32 s61, 294912
    s_add_u32 m0, s60, 132608
    s_nop 0
    buffer_load_dwordx4 v41, s[20:23], s61 offen lds
    s_waitcnt vmcnt(33)
    v_mfma_f32_16x16x32_bf16 v[28:31], v[128:131], v[32:35], v[28:31]
    v_mfma_f32_16x16x32_bf16 v[28:31], v[132:135], v[36:39], v[28:31]
    v_mfma_f32_16x16x32_bf16 v[28:31], v[136:139], v[32:35], v[28:31]
    v_mfma_f32_16x16x32_bf16 v[28:31], v[140:143], v[36:39], v[28:31]
    s_waitcnt vmcnt(29)
    v_mfma_f32_16x16x32_bf16 v[28:31], v[144:147], v[32:35], v[28:31]
    v_mfma_f32_16x16x32_bf16 v[28:31], v[148:151], v[36:39], v[28:31]
    v_mfma_f32_16x16x32_bf16 v[28:31], v[152:155], v[32:35], v[28:31]
    v_mfma_f32_16x16x32_bf16 v[28:31], v[156:159], v[36:39], v[28:31]
    s_waitcnt vmcnt(25)
    v_mfma_f32_16x16x32_bf16 v[28:31], v[192:195], v[32:35], v[28:31]
    v_mfma_f32_16x16x32_bf16 v[28:31], v[196:199], v[36:39], v[28:31]
    v_mfma_f32_16x16x32_bf16 v[28:31], v[200:203], v[32:35], v[28:31]
    v_mfma_f32_16x16x32_bf16 v[28:31], v[204:207], v[36:39], v[28:31]
    s_waitcnt lgkmcnt(0)
    s_barrier
    v_max3_u32 v2, v243, v247, v251
    v_max_u32 v2, v2, v255
    v_cmp_eq_u32 vcc, -1, v2
    s_cbranch_vccnz L_slow_34
L_back_35:
    ds_write_b128 v10, v[240:243] offset:16896
    ds_write_b128 v11, v[244:247] offset:16896
    ds_write_b128 v10, v[248:251] offset:25344
    ds_write_b128 v11, v[252:255] offset:25344
    s_add_u32 s61, s58, 352256
    buffer_load_dwordx4 v[128:131], v40, s[24:27], s61 offen
    buffer_load_dwordx4 v[132:135], v40, s[28:31], s61 offen
    s_add_u32 s61, s58, 528384
    buffer_load_dwordx4 v[136:139], v40, s[24:27], s61 offen
    buffer_load_dwordx4 v[140:143], v40, s[28:31], s61 offen
    s_add_u32 s61, s58, 704512
    buffer_load_dwordx4 v[144:147], v40, s[24:27], s61 offen
    buffer_load_dwordx4 v[148:151], v40, s[28:31], s61 offen
    s_add_u32 s61, s58, 880640
    buffer_load_dwordx4 v[152:155], v40, s[24:27], s61 offen
    buffer_load_dwordx4 v[156:159], v40, s[28:31], s61 offen
    s_add_u32 s61, s58, 1056768
    buffer_load_dwordx4 v[192:195], v40, s[24:27], s61 offen
    buffer_load_dwordx4 v[196:199], v40, s[28:31], s61 offen
    s_add_u32 s61, s58, 1232896
    buffer_load_dwordx4 v[200:203], v40, s[24:27], s61 offen
    buffer_load_dwordx4 v[204:207], v40, s[28:31], s61 offen
    s_mul_i32 s61, s50, 196608
    s_lshr_b32 s56, s46, 2
    s_lshl_b32 s56, s56, 7
    v_lshlrev_b32 v2, 10, v0
    s_mov_b32 s61, 0
    s_cmp_eq_u32 s50, 1
    s_cselect_b32 s61, 196608, s61
    s_cmp_eq_u32 s50, 2
    s_cselect_b32 s61, 393216, s61
    s_cmp_eq_u32 s50, 3
    s_cselect_b32 s61, 589824, s61
    s_add_u32 s61, s61, s56
    buffer_load_dword v4, v2, s[32:35], s61 offen
    s_mov_b32 s61, 65536
    s_cmp_eq_u32 s50, 1
    s_cselect_b32 s61, 262144, s61
    s_cmp_eq_u32 s50, 2
    s_cselect_b32 s61, 458752, s61
    s_cmp_eq_u32 s50, 3
    s_cselect_b32 s61, 655360, s61
    s_add_u32 s61, s61, s56
    buffer_load_dword v5, v2, s[32:35], s61 offen
    s_mov_b32 s61, 131072
    s_cmp_eq_u32 s50, 1
    s_cselect_b32 s61, 327680, s61
    s_cmp_eq_u32 s50, 2
    s_cselect_b32 s61, 524288, s61
    s_cmp_eq_u32 s50, 3
    s_cselect_b32 s61, 720896, s61
    s_add_u32 s61, s61, s56
    buffer_load_dword v6, v2, s[32:35], s61 offen
    s_mov_b32 s61, 327680
    s_add_u32 m0, s60, 136704
    s_nop 0
    buffer_load_dwordx4 v41, s[20:23], s61 offen lds
    s_mov_b32 s61, 360448
    s_add_u32 m0, s60, 140800
    s_nop 0
    buffer_load_dwordx4 v41, s[20:23], s61 offen lds
    s_waitcnt vmcnt(31)
    v_mfma_f32_16x16x32_bf16 v[20:23], v[176:179], v[32:35], v[20:23]
    v_mfma_f32_16x16x32_bf16 v[20:23], v[180:183], v[36:39], v[20:23]
    v_mfma_f32_16x16x32_bf16 v[20:23], v[184:187], v[32:35], v[20:23]
    v_mfma_f32_16x16x32_bf16 v[20:23], v[188:191], v[36:39], v[20:23]
    s_waitcnt vmcnt(27)
    v_mfma_f32_16x16x32_bf16 v[24:27], v[208:211], v[32:35], 0
    v_mfma_f32_16x16x32_bf16 v[24:27], v[212:215], v[36:39], v[24:27]
    v_mfma_f32_16x16x32_bf16 v[24:27], v[216:219], v[32:35], v[24:27]
    v_mfma_f32_16x16x32_bf16 v[24:27], v[220:223], v[36:39], v[24:27]
    s_waitcnt lgkmcnt(0)
    s_barrier
    s_mul_i32 s3, s50, 1024
    s_add_u32 s3, s3, 8192
    v_mul_u32_u24 v17, 16, v0
    v_add_u32 v17, s3, v17
    buffer_load_dwordx2 v[18:19], v17, s[8:11], 0 offen sc1
    s_mov_b32 s61, 393216
    s_add_u32 m0, s60, 144896
    s_nop 0
    buffer_load_dwordx4 v41, s[20:23], s61 offen lds
    s_mov_b32 s61, 425984
    s_add_u32 m0, s60, 148992
    s_nop 0
    buffer_load_dwordx4 v41, s[20:23], s61 offen lds
    s_mov_b32 s61, 458752
    s_add_u32 m0, s60, 153088
    s_nop 0
    buffer_load_dwordx4 v41, s[20:23], s61 offen lds
    s_mov_b32 s61, 491520
    s_add_u32 m0, s60, 157184
    s_nop 0
    buffer_load_dwordx4 v41, s[20:23], s61 offen lds
    s_waitcnt vmcnt(18)
    v_mfma_f32_16x16x32_bf16 v[24:27], v[128:131], v[32:35], v[24:27]
    v_mfma_f32_16x16x32_bf16 v[24:27], v[132:135], v[36:39], v[24:27]
    v_mfma_f32_16x16x32_bf16 v[24:27], v[136:139], v[32:35], v[24:27]
    v_mfma_f32_16x16x32_bf16 v[24:27], v[140:143], v[36:39], v[24:27]
    s_waitcnt vmcnt(14)
    v_mfma_f32_16x16x32_bf16 v[24:27], v[144:147], v[32:35], v[24:27]
    v_mfma_f32_16x16x32_bf16 v[24:27], v[148:151], v[36:39], v[24:27]
    v_mfma_f32_16x16x32_bf16 v[24:27], v[152:155], v[32:35], v[24:27]
    v_mfma_f32_16x16x32_bf16 v[24:27], v[156:159], v[36:39], v[24:27]
    s_waitcnt vmcnt(10)
    v_mfma_f32_16x16x32_bf16 v[24:27], v[192:195], v[32:35], v[24:27]
    v_mfma_f32_16x16x32_bf16 v[24:27], v[196:199], v[36:39], v[24:27]
    v_mfma_f32_16x16x32_bf16 v[24:27], v[200:203], v[32:35], v[24:27]
    v_mfma_f32_16x16x32_bf16 v[24:27], v[204:207], v[36:39], v[24:27]
    s_mul_i32 s61, s50, 3072
    s_add_u32 s61, s61, 83456
    v_add_u32 v2, s61, v1
    s_nop 6
    ds_write_b128 v2, v[20:23] offset:0
    ds_write_b128 v2, v[24:27] offset:1024
    ds_write_b128 v2, v[28:31] offset:2048
    s_waitcnt vmcnt(0)
    v_cmp_ne_u64 vcc, s[4:5], v[18:19]
    s_cbranch_vccnz L_fs_38
L_fb_39:
    s_add_u32 s61, s2, s50
    s_cmp_lg_u32 s61, 0
    s_cbranch_scc1 L_only_41
    s_mov_b64 exec, 1
    v_mov_b32 v2, s4
    v_mov_b32 v3, s5
    buffer_store_dwordx2 v[2:3], off, s[8:11], s61 sc1
    s_mov_b64 exec, -1
L_only_41:
    s_waitcnt lgkmcnt(0)
    s_barrier
    s_waitcnt lgkmcnt(0)
    s_barrier
    ds_write_b128 v42, v[160:163] offset:32896
    ds_write_b128 v42, v[164:167] offset:41120
    ds_write_b128 v42, v[168:171] offset:36992
    ds_write_b128 v42, v[172:175] offset:45216
    ds_write_b128 v42, v[176:179] offset:49344
    ds_write_b128 v42, v[180:183] offset:57568
    ds_write_b128 v42, v[184:187] offset:53440
    ds_write_b128 v42, v[188:191] offset:61664
    ds_write_b128 v43, v[208:211] offset:256
    ds_write_b128 v43, v[212:215] offset:8480
    ds_write_b128 v43, v[216:219] offset:4352
    ds_write_b128 v43, v[220:223] offset:12576
    s_min_u32 s61, s50, 2
    s_lshl_b32 s62, s61, 10
    s_add_u32 s62, s62, 83456
    v_add_u32 v2, s62, v1
    ds_read_b128 v[20:23], v2 offset:0
    ds_read_b128 v[24:27], v2 offset:3072
    ds_read_b128 v[28:31], v2 offset:6144
    ds_read_b128 v[32:35], v2 offset:9216
    v_bfe_u32 v2, v0, 3, 1
    v_lshlrev_b32 v2, 6, v2
    v_and_b32 v3, 7, v0
    v_lshl_add_u32 v2, v3, 2, v2
    s_lshl_b32 s62, s61, 8
    s_add_u32 s62, s62, 162816
    v_add_u32 v2, s62, v2
    s_waitcnt lgkmcnt(0)
    v_add_f32 v20, v20, v24
    v_add_f32 v28, v28, v32
    v_add_f32 v21, v21, v25
    v_add_f32 v29, v29, v33
    v_add_f32 v22, v22, v26
    v_add_f32 v30, v30, v34
    v_add_f32 v23, v23, v27
    v_add_f32 v31, v31, v35
    v_add_f32 v20, v20, v28
    v_add_f32 v21, v21, v29
    v_add_f32 v22, v22, v30
    v_add_f32 v23, v23, v31
    v_mov_b32 v24, v20
    v_mov_b32 v25, v21
    v_mov_b32 v26, v22
    v_mov_b32 v27, v23
    s_nop 1
    v_permlane32_swap_b32 v20, v24
    v_permlane32_swap_b32 v21, v25
    v_permlane32_swap_b32 v22, v26
    v_permlane32_swap_b32 v23, v27
    s_nop 1
    v_add_f32 v20, v20, v24
    v_add_f32 v21, v21, v25
    v_add_f32 v22, v22, v26
    v_add_f32 v23, v23, v27
    v_mov_b32 v24, v20
    v_mov_b32 v25, v21
    v_mov_b32 v26, v22
    v_mov_b32 v27, v23
    s_nop 1
    v_permlane16_swap_b32 v20, v24
    v_permlane16_swap_b32 v21, v25
    v_permlane16_swap_b32 v22, v26
    v_permlane16_swap_b32 v23, v27
    s_nop 1
    v_add_f32 v20, v20, v24
    v_add_f32 v21, v21, v25
    v_add_f32 v22, v22, v26
    v_add_f32 v23, v23, v27
    ds_write_b32 v2, v20 offset:0
    ds_write_b32 v2, v21 offset:32
    ds_write_b32 v2, v22 offset:128
    ds_write_b32 v2, v23 offset:160
    s_waitcnt lgkmcnt(0)
    s_barrier
    s_barrier
    ds_write_b128 v43, v[128:131] offset:16704
    ds_write_b128 v43, v[132:135] offset:24928
    ds_write_b128 v43, v[136:139] offset:20800
    ds_write_b128 v43, v[140:143] offset:29024
    ds_write_b128 v43, v[144:147] offset:33152
    ds_write_b128 v43, v[148:151] offset:41376
    ds_write_b128 v43, v[152:155] offset:37248
    ds_write_b128 v43, v[156:159] offset:45472
    ds_write_b128 v43, v[192:195] offset:49600
    ds_write_b128 v43, v[196:199] offset:57824
    ds_write_b128 v43, v[200:203] offset:53696
    ds_write_b128 v43, v[204:207] offset:61920
    s_waitcnt lgkmcnt(0)
    s_barrier
    s_barrier
    s_add_u32 s61, s59, 0
    s_add_u32 m0, s60, 131584
    s_nop 0
    buffer_load_dwordx4 v40, s[24:27], s61 offen lds
    s_add_u32 m0, s60, 139808
    s_nop 0
    buffer_load_dwordx4 v40, s[28:31], s61 offen lds
    s_add_u32 s61, s59, 176128
    s_add_u32 m0, s60, 135680
    s_nop 0
    buffer_load_dwordx4 v40, s[24:27], s61 offen lds
    s_add_u32 m0, s60, 143904
    s_nop 0
    buffer_load_dwordx4 v40, s[28:31], s61 offen lds
    s_mov_b32 s61, 262144
    s_add_u32 m0, s60, 148032
    s_nop 0
    buffer_load_dwordx4 v41, s[32:35], s61 offen lds
    s_mov_b32 s61, 294912
    s_add_u32 m0, s60, 152128
    s_nop 0
    buffer_load_dwordx4 v41, s[32:35], s61 offen lds
    s_mov_b32 s61, 327680
    s_add_u32 m0, s60, 156224
    s_nop 0
    buffer_load_dwordx4 v41, s[32:35], s61 offen lds
    s_barrier
    s_add_u32 s61, s59, 352256
    s_add_u32 m0, s60, 0
    s_nop 0
    buffer_load_dwordx4 v40, s[24:27], s61 offen lds
    s_add_u32 m0, s60, 8224
    s_nop 0
    buffer_load_dwordx4 v40, s[28:31], s61 offen lds
    s_add_u32 s61, s59, 528384
    s_add_u32 m0, s60, 4096
    s_nop 0
    buffer_load_dwordx4 v40, s[24:27], s61 offen lds
    s_add_u32 m0, s60, 12320
    s_nop 0
    buffer_load_dwordx4 v40, s[28:31], s61 offen lds
    s_add_u32 s61, s59, 704512
    s_add_u32 m0, s60, 16448
    s_nop 0
    buffer_load_dwordx4 v40, s[24:27], s61 offen lds
    s_add_u32 m0, s60, 24672
    s_nop 0
    buffer_load_dwordx4 v40, s[28:31], s61 offen lds
    s_add_u32 s61, s59, 880640
    s_add_u32 m0, s60, 20544
    s_nop 0
    buffer_load_dwordx4 v40, s[24:27], s61 offen lds
    s_add_u32 m0, s60, 28768
    s_nop 0
    buffer_load_dwordx4 v40, s[28:31], s61 offen lds
    s_add_u32 s61, s59, 1056768
    s_add_u32 m0, s60, 32896
    s_nop 0
    buffer_load_dwordx4 v40, s[24:27], s61 offen lds
    s_add_u32 m0, s60, 41120
    s_nop 0
    buffer_load_dwordx4 v40, s[28:31], s61 offen lds
    s_add_u32 s61, s59, 1232896
    s_add_u32 m0, s60, 36992
    s_nop 0
    buffer_load_dwordx4 v40, s[24:27], s61 offen lds
    s_add_u32 m0, s60, 45216
    s_nop 0
    buffer_load_dwordx4 v40, s[28:31], s61 offen lds
    s_mov_b32 s61, 360448
    s_add_u32 m0, s60, 49344
    s_nop 0
    buffer_load_dwordx4 v41, s[32:35], s61 offen lds
    s_mov_b32 s61, 393216
    s_add_u32 m0, s60, 53440
    s_nop 0
    buffer_load_dwordx4 v41, s[32:35], s61 offen lds
    s_mov_b32 s61, 425984
    s_add_u32 m0, s60, 57536
    s_nop 0
    buffer_load_dwordx4 v41, s[32:35], s61 offen lds
    s_mov_b32 s61, 458752
    s_add_u32 m0, s60, 61632
    s_nop 0
    buffer_load_dwordx4 v41, s[32:35], s61 offen lds
    s_lshl_b32 s62, s45, 2
    s_and_b32 s65, s46, 3
    s_add_u32 s62, s62, s65
    s_lshl_b32 s62, s62, 1
    s_and_b32 s65, s50, 1
    s_add_u32 s62, s62, s65
    s_lshr_b32 s63, s50, 1
    s_lshr_b32 s64, s46, 2
    s_lshl_b32 s64, s64, 1
    s_add_u32 s64, s64, s63
    s_mul_i32 s53, s62, 88064
    s_lshl_b32 s54, s63, 10
    s_add_u32 s53, s53, s54
    s_add_u32 s53, s53, 11534336
    v_lshrrev_b32 v38, 5, v0
    v_lshlrev_b32 v38, 2, v38
    v_bfe_u32 v39, v0, 2, 2
    v_add_u32 v38, v38, v39
    v_lshlrev_b32 v38, 7, v38
    v_bfe_u32 v39, v0, 4, 1
    v_lshl_add_u32 v38, v39, 5, v38
    v_and_b32 v39, 3, v0
    v_lshl_add_u32 v38, v39, 3, v38
    v_bfe_u32 v39, v0, 3, 1
    v_xor_b32 v39, s63, v39
    v_lshl_add_u32 v38, v39, 6, v38
    v_xor_b32 v39, 64, v38
    s_lshl_b32 s65, s63, 11
    v_add_u32 v32, s65, v38
    v_add_u32 v35, s65, v39
    v_add_u32 v33, 65536, v32
    v_add_u32 v34, 131072, v32
    v_add_u32 v36, 65536, v35
    v_add_u32 v37, 131072, v35
    s_lshl_b32 s54, s50, 13
    s_add_u32 s54, s54, 65728
    v_add_u32 v38, s54, v1
    s_waitcnt vmcnt(4)
    s_barrier
    s_mov_b32 s61, 491520
    s_add_u32 m0, s60, 65728
    s_nop 0
    buffer_load_dwordx4 v41, s[32:35], s61 offen lds
    s_mov_b32 s61, 524288
    s_add_u32 m0, s60, 69824
    s_nop 0
    buffer_load_dwordx4 v41, s[32:35], s61 offen lds
    s_mov_b32 s61, 557056
    s_add_u32 m0, s60, 73920
    s_nop 0
    buffer_load_dwordx4 v41, s[32:35], s61 offen lds
    s_mov_b32 s61, 589824
    s_add_u32 m0, s60, 78016
    s_nop 0
    buffer_load_dwordx4 v41, s[32:35], s61 offen lds
    s_mov_b32 s61, 622592
    s_add_u32 m0, s60, 82112
    s_nop 0
    buffer_load_dwordx4 v41, s[32:35], s61 offen lds
    s_mov_b32 s61, 655360
    s_add_u32 m0, s60, 86208
    s_nop 0
    buffer_load_dwordx4 v41, s[32:35], s61 offen lds
    s_mov_b32 s61, 688128
    s_add_u32 m0, s60, 90304
    s_nop 0
    buffer_load_dwordx4 v41, s[32:35], s61 offen lds
    s_mov_b32 s61, 720896
    s_add_u32 m0, s60, 94400
    s_nop 0
    buffer_load_dwordx4 v41, s[32:35], s61 offen lds
    buffer_load_dwordx4 v[128:131], v1, s[8:11], s53 offen sc1
    buffer_load_dwordx4 v[132:135], v1, s[8:11], s53 offen offset:2048 sc1
    s_add_u32 s54, s53, 4096
    buffer_load_dwordx4 v[136:139], v1, s[8:11], s54 offen sc1
    buffer_load_dwordx4 v[140:143], v1, s[8:11], s54 offen offset:2048 sc1
    s_add_u32 s54, s53, 8192
    buffer_load_dwordx4 v[144:147], v1, s[8:11], s54 offen sc1
    buffer_load_dwordx4 v[148:151], v1, s[8:11], s54 offen offset:2048 sc1
    s_add_u32 s54, s53, 12288
    buffer_load_dwordx4 v[152:155], v1, s[8:11], s54 offen sc1
    buffer_load_dwordx4 v[156:159], v1, s[8:11], s54 offen offset:2048 sc1
    s_add_u32 s54, s53, 16384
    buffer_load_dwordx4 v[192:195], v1, s[8:11], s54 offen sc1
    buffer_load_dwordx4 v[196:199], v1, s[8:11], s54 offen offset:2048 sc1
    s_add_u32 s54, s53, 20480
    buffer_load_dwordx4 v[200:203], v1, s[8:11], s54 offen sc1
    s_mov_b32 s61, 0
    s_add_u32 m0, s60, 98496
    s_nop 0
    buffer_load_dwordx4 v41, s[32:35], s61 offen lds
    s_mov_b32 s61, 32768
    s_add_u32 m0, s60, 102592
    s_nop 0
    buffer_load_dwordx4 v41, s[32:35], s61 offen lds
    s_mov_b32 s61, 65536
    s_add_u32 m0, s60, 106688
    s_nop 0
    buffer_load_dwordx4 v41, s[32:35], s61 offen lds
    s_mov_b32 s61, 98304
    s_add_u32 m0, s60, 110784
    s_nop 0
    buffer_load_dwordx4 v41, s[32:35], s61 offen lds
    s_mov_b32 s61, 131072
    s_add_u32 m0, s60, 114880
    s_nop 0
    buffer_load_dwordx4 v41, s[32:35], s61 offen lds
    s_mov_b32 s61, 163840
    s_add_u32 m0, s60, 118976
    s_nop 0
    buffer_load_dwordx4 v41, s[32:35], s61 offen lds
    s_mov_b32 s61, 196608
    s_add_u32 m0, s60, 123072
    s_nop 0
    buffer_load_dwordx4 v41, s[32:35], s61 offen lds
    s_mov_b32 s61, 229376
    s_add_u32 m0, s60, 127168
    s_nop 0
    buffer_load_dwordx4 v41, s[32:35], s61 offen lds
    s_waitcnt vmcnt(0)
    s_barrier
    ds_write_b128 v44, v[48:51] offset:512
    ds_write_b128 v44, v[52:55] offset:4608
    ds_write_b128 v44, v[56:59] offset:8704
    ds_write_b128 v44, v[60:63] offset:12800
    ds_write_b128 v42, v[64:67] offset:0
    ds_write_b128 v42, v[68:71] offset:4096
    ds_write_b128 v42, v[72:75] offset:8192
    ds_write_b128 v42, v[76:79] offset:12288
    ds_write_b128 v42, v[80:83] offset:16384
    ds_write_b128 v42, v[84:87] offset:20480
    ds_write_b128 v42, v[88:91] offset:24576
    ds_write_b128 v42, v[92:95] offset:28672
    ds_write_b128 v42, v[96:99] offset:32768
    ds_write_b128 v42, v[100:103] offset:36864
    ds_write_b128 v42, v[104:107] offset:40960
    ds_write_b128 v42, v[108:111] offset:45056
    ds_read_b64_tr_b16 v[160:161], v33 offset:32960
    ds_read_b64_tr_b16 v[162:163], v33 offset:33984
    ds_read_b64_tr_b16 v[164:165], v36 offset:32960
    ds_read_b64_tr_b16 v[166:167], v36 offset:33984
    ds_read_b64_tr_b16 v[168:169], v33 offset:37056
    ds_read_b64_tr_b16 v[170:171], v33 offset:38080
    ds_read_b64_tr_b16 v[172:173], v36 offset:37056
    ds_read_b64_tr_b16 v[174:175], v36 offset:38080
    v_max3_u32 v2, v131, v135, v139
    v_max_u32 v2, v2, v143
    v_cmp_eq_u32 vcc, -1, v2
    s_cbranch_vccnz L_slow_42
L_back_43:
    s_waitcnt lgkmcnt(4)
    v_mfma_f32_32x32x16_bf16 v[224:239], v[160:163], v[128:131], 0
    ds_read_b64_tr_b16 v[176:177], v33 offset:41152
    ds_read_b64_tr_b16 v[178:179], v33 offset:42176
    v_mfma_f32_32x32x16_bf16 v[240:255], v[164:167], v[128:131], 0
    ds_read_b64_tr_b16 v[180:181], v36 offset:41152
    ds_read_b64_tr_b16 v[182:183], v36 offset:42176
    s_waitcnt lgkmcnt(4)
    v_mfma_f32_32x32x16_bf16 v[224:239], v[168:171], v[132:135], v[224:239]
    ds_read_b64_tr_b16 v[160:161], v33 offset:45248
    ds_read_b64_tr_b16 v[162:163], v33 offset:46272
    v_mfma_f32_32x32x16_bf16 v[240:255], v[172:175], v[132:135], v[240:255]
    ds_read_b64_tr_b16 v[164:165], v36 offset:45248
    ds_read_b64_tr_b16 v[166:167], v36 offset:46272
    s_waitcnt lgkmcnt(4)
    v_mfma_f32_32x32x16_bf16 v[224:239], v[176:179], v[136:139], v[224:239]
    ds_read_b64_tr_b16 v[168:169], v33 offset:49344
    ds_read_b64_tr_b16 v[170:171], v33 offset:50368
    v_mfma_f32_32x32x16_bf16 v[240:255], v[180:183], v[136:139], v[240:255]
    ds_read_b64_tr_b16 v[172:173], v36 offset:49344
    ds_read_b64_tr_b16 v[174:175], v36 offset:50368
    s_waitcnt lgkmcnt(4)
    v_mfma_f32_32x32x16_bf16 v[224:239], v[160:163], v[140:143], v[224:239]
    ds_read_b64_tr_b16 v[176:177], v33 offset:53440
    ds_read_b64_tr_b16 v[178:179], v33 offset:54464
    v_mfma_f32_32x32x16_bf16 v[240:255], v[164:167], v[140:143], v[240:255]
    ds_read_b64_tr_b16 v[180:181], v36 offset:53440
    ds_read_b64_tr_b16 v[182:183], v36 offset:54464
    v_max3_u32 v2, v147, v151, v155
    v_max_u32 v2, v2, v159
    v_cmp_eq_u32 vcc, -1, v2
    s_cbranch_vccnz L_slow_46
L_back_47:
    s_waitcnt lgkmcnt(4)
    v_mfma_f32_32x32x16_bf16 v[224:239], v[168:171], v[144:147], v[224:239]
    ds_read_b64_tr_b16 v[160:161], v33 offset:57536
    ds_read_b64_tr_b16 v[162:163], v33 offset:58560
    v_mfma_f32_32x32x16_bf16 v[240:255], v[172:175], v[144:147], v[240:255]
    ds_read_b64_tr_b16 v[164:165], v36 offset:57536
    ds_read_b64_tr_b16 v[166:167], v36 offset:58560
    s_waitcnt lgkmcnt(4)
    v_mfma_f32_32x32x16_bf16 v[224:239], v[176:179], v[148:151], v[224:239]
    ds_read_b64_tr_b16 v[168:169], v33 offset:61632
    ds_read_b64_tr_b16 v[170:171], v33 offset:62656
    v_mfma_f32_32x32x16_bf16 v[240:255], v[180:183], v[148:151], v[240:255]
    ds_read_b64_tr_b16 v[172:173], v36 offset:61632
    ds_read_b64_tr_b16 v[174:175], v36 offset:62656
    s_waitcnt lgkmcnt(4)
    v_mfma_f32_32x32x16_bf16 v[224:239], v[160:163], v[152:155], v[224:239]
    ds_read_b64_tr_b16 v[176:177], v34 offset:16960
    ds_read_b64_tr_b16 v[178:179], v34 offset:17984
    v_mfma_f32_32x32x16_bf16 v[240:255], v[164:167], v[152:155], v[240:255]
    ds_read_b64_tr_b16 v[180:181], v37 offset:16960
    ds_read_b64_tr_b16 v[182:183], v37 offset:17984
    s_waitcnt lgkmcnt(0)
    s_barrier
    v_mfma_f32_32x32x16_bf16 v[224:239], v[168:171], v[156:159], v[224:239]
    ds_read_b64_tr_b16 v[160:161], v34 offset:21056
    ds_read_b64_tr_b16 v[162:163], v34 offset:22080
    ds_write_b128 v42, v[112:115] offset:49344
    v_mfma_f32_32x32x16_bf16 v[240:255], v[172:175], v[156:159], v[240:255]
    ds_read_b64_tr_b16 v[164:165], v37 offset:21056
    ds_read_b64_tr_b16 v[166:167], v37 offset:22080
    ds_write_b128 v42, v[116:119] offset:53440
    v_max3_u32 v2, v195, v199, v203
    v_cmp_eq_u32 vcc, -1, v2
    s_cbranch_vccnz L_slow_50
L_back_51:
    v_mfma_f32_32x32x16_bf16 v[224:239], v[176:179], v[192:195], v[224:239]
    ds_read_b64_tr_b16 v[168:169], v34 offset:25152
    ds_read_b64_tr_b16 v[170:171], v34 offset:26176
    ds_write_b128 v42, v[120:123] offset:57536
    v_mfma_f32_32x32x16_bf16 v[240:255], v[180:183], v[192:195], v[240:255]
    ds_read_b64_tr_b16 v[172:173], v37 offset:25152
    ds_read_b64_tr_b16 v[174:175], v37 offset:26176
    ds_write_b128 v42, v[124:127] offset:61632
    s_waitcnt lgkmcnt(7)
    v_mfma_f32_32x32x16_bf16 v[224:239], v[160:163], v[196:199], v[224:239]
    v_mfma_f32_32x32x16_bf16 v[240:255], v[164:167], v[196:199], v[240:255]
    s_waitcnt lgkmcnt(1)
    v_mfma_f32_32x32x16_bf16 v[224:239], v[168:171], v[200:203], v[224:239]
    v_mfma_f32_32x32x16_bf16 v[240:255], v[172:175], v[200:203], v[240:255]
    s_nop 7
    s_nop 7
    ds_write_b128 v38, v[224:227] offset:0
    ds_write_b128 v38, v[228:231] offset:1024
    ds_write_b128 v38, v[232:235] offset:2048
    ds_write_b128 v38, v[236:239] offset:3072
    ds_write_b128 v38, v[240:243] offset:4096
    ds_write_b128 v38, v[244:247] offset:5120
    ds_write_b128 v38, v[248:251] offset:6144
    ds_write_b128 v38, v[252:255] offset:7168
    s_waitcnt lgkmcnt(0)
    s_barrier
    s_barrier
L_end:
    s_endpgm
L_compute:
    s_cmp_lg_u32 s44, 2
    s_cbranch_scc1 L_only_54
    s_getpc_b64 s[58:59]
L_pc:
    s_mul_i32 s60, s46, 12
    v_add_u32 v12, s60, v0
    v_lshlrev_b32 v12, 7, v12
    v_min_u32 v12, L_last-sequential_preLN__softmax_full_mha__glu_gated_swiglu__prompt_kernel, v12
    s_sub_u32 s58, s58, L_pc-sequential_preLN__softmax_full_mha__glu_gated_swiglu__prompt_kernel
    s_subb_u32 s59, s59, 0
    v_mov_b32 v221, s59
    v_add_co_u32 v220, vcc, s58, v12
    v_addc_co_u32 v221, vcc, 0, v221, vcc
    s_mov_b64 exec, 0xfff
    global_load_dword v222, v[220:221], off
    s_mov_b64 exec, -1
L_only_54:
    s_lshl_b32 s62, s45, 7
    s_lshl_b32 s63, s46, 16
    s_add_u32 s63, s63, s62
    v_lshlrev_b32 v188, 10, v0
    s_mul_i32 s58, s46, 49152
    s_add_u32 s62, s62, s58
    v_and_b32 v189, 15, v0
    v_mul_u32_u24 v189, 3072, v189
    v_lshrrev_b32 v190, 4, v0
    v_lshl_add_u32 v189, v190, 10, v189
    s_waitcnt lgkmcnt(0)
    s_cmp_lg_u32 s44, 3
    s_cbranch_scc1 L_only_56
    s_lshl_b32 s58, s46, 16
    s_add_u32 s59, s58, 7340032
    v_lshlrev_b32 v190, 21, v0
    s_mov_b64 exec, 1
    buffer_load_dword v192, off, s[20:23], s58
    buffer_load_dword v193, off, s[24:27], s58
    buffer_load_dword v194, off, s[28:31], s58
    buffer_load_dword v195, off, s[32:35], s58
    buffer_load_dword v196, off, s[36:39], s58
    s_mov_b64 exec, 0x1f
    buffer_load_dword v197, v190, s[8:11], s59 offen
    s_mov_b64 exec, -1
L_only_56:
L_sk_55:
    v_lshrrev_b32 v12, 5, v0
    v_lshlrev_b32 v12, 3, v12
    v_bfe_u32 v13, v0, 2, 2
    v_add_u32 v12, v12, v13
    v_mul_u32_u24 v8, 192, v12
    v_bfe_u32 v13, v0, 4, 1
    v_lshl_add_u32 v8, v13, 5, v8
    v_and_b32 v13, 3, v0
    v_lshl_add_u32 v8, v13, 3, v8
    v_mov_b32 v9, 0x3f803f80
    v_and_b32 v10, 31, v0
    v_lshrrev_b32 v11, 5, v0
    v_bfe_u32 v12, v0, 1, 3
    s_lshl_b32 s50, s44, 12
    s_add_u32 s50, s50, 61440
    v_lshlrev_b32 v13, 7, v10
    v_add_u32 v13, s50, v13
    v_or_b32 v15, 0, v11
    v_xor_b32 v15, v15, v12
    v_lshl_add_u32 v15, v15, 4, v13
    v_add_u32 v19, 0x10000, v15
    v_or_b32 v16, 2, v11
    v_xor_b32 v16, v16, v12
    v_lshl_add_u32 v16, v16, 4, v13
    v_add_u32 v20, 0x10000, v16
    v_or_b32 v17, 4, v11
    v_xor_b32 v17, v17, v12
    v_lshl_add_u32 v17, v17, 4, v13
    v_add_u32 v21, 0x10000, v17
    v_or_b32 v18, 6, v11
    v_xor_b32 v18, v18, v12
    v_lshl_add_u32 v18, v18, 4, v13
    v_add_u32 v22, 0x10000, v18
    v_mov_b32 v24, 0
    v_mov_b32 v25, 0
    v_mov_b32 v26, 0
    v_mov_b32 v27, 0
    s_lshl_b32 s50, s44, 8
    s_add_u32 s50, s50, 161792
    v_lshl_add_u32 v244, v0, 2, s50
    v_lshl_add_u32 v245, v11, 4, s50
    v_lshlrev_b32 v246, 4, v11
    v_add_u32 v246, 161280, v246
    v_lshlrev_b32 v247, 2, v10
    v_add_u32 v247, 161280, v247
    v_and_b32 v248, 15, v0
    v_lshlrev_b32 v248, 4, v248
    v_lshl_or_b32 v248, v11, 8, v248
    v_bfe_u32 v12, v0, 4, 1
    v_lshl_or_b32 v248, v12, 16, v248
    v_mov_b32 v140, -1
    v_mov_b32 v141, -1
    v_mov_b32 v142, -1
    v_mov_b32 v143, -1
    s_mul_i32 s3, s45, 512
    s_add_u32 s3, s3, 4096
    v_and_b32 v6, 31, v0
    v_mul_u32_u24 v6, 16, v6
    v_add_u32 v6, s3, v6
    s_lshl_b32 s50, s48, 2
    s_add_u32 s50, s50, s44
    s_lshl_b32 s60, s49, 17
    s_lshl_b32 s61, s50, 10
    s_add_u32 s60, s60, s61
    s_add_u32 s51, s60, 1048576
    s_add_u32 s52, s60, 1114112
    s_add_u32 s53, s60, 3145728
    s_add_u32 s54, s60, 3211264
    s_add_u32 s55, s60, 5242880
    s_waitcnt lgkmcnt(0)
    s_load_dwordx2 s[6:7], s[8:9], 0
    buffer_store_dwordx4 v[140:143], v1, s[8:11], s51 offen
    buffer_store_dwordx4 v[140:143], v1, s[8:11], s52 offen
    buffer_store_dwordx4 v[140:143], v1, s[8:11], s53 offen
    buffer_store_dwordx4 v[140:143], v1, s[8:11], s54 offen
    buffer_store_dwordx4 v[140:143], v248, s[8:11], s55 offen offset:0
    buffer_store_dwordx4 v[140:143], v248, s[8:11], s55 offen offset:512
    s_lshl_b32 s57, s45, 5
    s_add_u32 s57, s57, s46
    s_mul_i32 s57, s57, 16
    s_add_u32 s57, s57, 4096
    s_waitcnt lgkmcnt(0)
    s_mul_i32 s4, s6, 0x9e3779b1
    s_add_u32 s4, s4, 0x7f4a7c15
    s_mul_i32 s5, s7, 0x85ebca6d
    s_add_u32 s5, s5, 0x165667b1
    s_getreg_b32 s7, hwreg(HW_REG_XCC_ID, 0, 4)
    s_mov_b32 s6, s4
    s_xor_b32 s7, s7, s5
    s_barrier
    ds_read_b128 v[76:79], v15 offset:0
    ds_read_b64_tr_b16 v[88:89], v8 offset:0
    ds_read_b64_tr_b16 v[90:91], v8 offset:768
    ds_read_b64_tr_b16 v[92:93], v8 offset:64
    ds_read_b64_tr_b16 v[94:95], v8 offset:832
    ds_read_b64_tr_b16 v[96:97], v8 offset:128
    ds_read_b64_tr_b16 v[98:99], v8 offset:896
    ds_read_b128 v[80:83], v16 offset:0
    ds_read_b64_tr_b16 v[100:101], v8 offset:3072
    ds_read_b64_tr_b16 v[102:103], v8 offset:3840
    ds_read_b64_tr_b16 v[104:105], v8 offset:3136
    ds_read_b64_tr_b16 v[106:107], v8 offset:3904
    ds_read_b64_tr_b16 v[108:109], v8 offset:3200
    ds_read_b64_tr_b16 v[110:111], v8 offset:3968
    s_waitcnt lgkmcnt(7)
    v_mfma_f32_32x32x16_bf16 v[28:43], v[88:91], v[76:79], 0
    ds_read_b128 v[84:87], v17 offset:0
    ds_read_b64_tr_b16 v[112:113], v8 offset:6144
    ds_read_b64_tr_b16 v[114:115], v8 offset:6912
    ds_read_b64_tr_b16 v[116:117], v8 offset:6208
    v_mfma_f32_32x32x16_bf16 v[44:59], v[92:95], v[76:79], 0
    ds_read_b64_tr_b16 v[118:119], v8 offset:6976
    ds_read_b64_tr_b16 v[120:121], v8 offset:6272
    ds_read_b64_tr_b16 v[122:123], v8 offset:7040
    v_mfma_f32_32x32x16_bf16 v[60:75], v[76:79], v[96:99], 0
    v_dot2_f32_bf16 v24, v76, v9, v24
    v_dot2_f32_bf16 v26, v76, v76, v26
    v_dot2_f32_bf16 v25, v77, v9, v25
    v_dot2_f32_bf16 v27, v77, v77, v27
    v_dot2_f32_bf16 v24, v78, v9, v24
    v_dot2_f32_bf16 v26, v78, v78, v26
    v_dot2_f32_bf16 v25, v79, v9, v25
    v_dot2_f32_bf16 v27, v79, v79, v27
    s_waitcnt lgkmcnt(7)
    v_mfma_f32_32x32x16_bf16 v[28:43], v[100:103], v[80:83], v[28:43]
    ds_read_b128 v[76:79], v18 offset:0
    ds_read_b64_tr_b16 v[88:89], v8 offset:9216
    ds_read_b64_tr_b16 v[90:91], v8 offset:9984
    ds_read_b64_tr_b16 v[92:93], v8 offset:9280
    v_mfma_f32_32x32x16_bf16 v[44:59], v[104:107], v[80:83], v[44:59]
    ds_read_b64_tr_b16 v[94:95], v8 offset:10048
    ds_read_b64_tr_b16 v[96:97], v8 offset:9344
    ds_read_b64_tr_b16 v[98:99], v8 offset:10112
    v_mfma_f32_32x32x16_bf16 v[60:75], v[80:83], v[108:111], v[60:75]
    v_dot2_f32_bf16 v24, v80, v9, v24
    v_dot2_f32_bf16 v26, v80, v80, v26
    v_dot2_f32_bf16 v25, v81, v9, v25
    v_dot2_f32_bf16 v27, v81, v81, v27
    v_dot2_f32_bf16 v24, v82, v9, v24
    v_dot2_f32_bf16 v26, v82, v82, v26
    v_dot2_f32_bf16 v25, v83, v9, v25
    v_dot2_f32_bf16 v27, v83, v83, v27
    s_barrier
    s_waitcnt lgkmcnt(7)
    v_mfma_f32_32x32x16_bf16 v[28:43], v[112:115], v[84:87], v[28:43]
    ds_read_b128 v[80:83], v15 offset:16384
    ds_read_b64_tr_b16 v[100:101], v8 offset:12288
    ds_read_b64_tr_b16 v[102:103], v8 offset:13056
    ds_read_b64_tr_b16 v[104:105], v8 offset:12352
    v_mfma_f32_32x32x16_bf16 v[44:59], v[116:119], v[84:87], v[44:59]
    ds_read_b64_tr_b16 v[106:107], v8 offset:13120
    ds_read_b64_tr_b16 v[108:109], v8 offset:12416
    ds_read_b64_tr_b16 v[110:111], v8 offset:13184
    v_mfma_f32_32x32x16_bf16 v[60:75], v[84:87], v[120:123], v[60:75]
    v_dot2_f32_bf16 v24, v84, v9, v24
    v_dot2_f32_bf16 v26, v84, v84, v26
    v_dot2_f32_bf16 v25, v85, v9, v25
    v_dot2_f32_bf16 v27, v85, v85, v27
    v_dot2_f32_bf16 v24, v86, v9, v24
    v_dot2_f32_bf16 v26, v86, v86, v26
    v_dot2_f32_bf16 v25, v87, v9, v25
    v_dot2_f32_bf16 v27, v87, v87, v27
    s_waitcnt lgkmcnt(7)
    v_mfma_f32_32x32x16_bf16 v[28:43], v[88:91], v[76:79], v[28:43]
    ds_read_b128 v[84:87], v16 offset:16384
    ds_read_b64_tr_b16 v[112:113], v8 offset:15360
    ds_read_b64_tr_b16 v[114:115], v8 offset:16128
    ds_read_b64_tr_b16 v[116:117], v8 offset:15424
    v_mfma_f32_32x32x16_bf16 v[44:59], v[92:95], v[76:79], v[44:59]
    ds_read_b64_tr_b16 v[118:119], v8 offset:16192
    ds_read_b64_tr_b16 v[120:121], v8 offset:15488
    ds_read_b64_tr_b16 v[122:123], v8 offset:16256
    v_mfma_f32_32x32x16_bf16 v[60:75], v[76:79], v[96:99], v[60:75]
    v_dot2_f32_bf16 v24, v76, v9, v24
    v_dot2_f32_bf16 v26, v76, v76, v26
    v_dot2_f32_bf16 v25, v77, v9, v25
    v_dot2_f32_bf16 v27, v77, v77, v27
    v_dot2_f32_bf16 v24, v78, v9, v24
    v_dot2_f32_bf16 v26, v78, v78, v26
    v_dot2_f32_bf16 v25, v79, v9, v25
    v_dot2_f32_bf16 v27, v79, v79, v27
    s_waitcnt lgkmcnt(7)
    v_mfma_f32_32x32x16_bf16 v[28:43], v[100:103], v[80:83], v[28:43]
    ds_read_b128 v[76:79], v17 offset:16384
    ds_read_b64_tr_b16 v[88:89], v8 offset:18432
    ds_read_b64_tr_b16 v[90:91], v8 offset:19200
    ds_read_b64_tr_b16 v[92:93], v8 offset:18496
    v_mfma_f32_32x32x16_bf16 v[44:59], v[104:107], v[80:83], v[44:59]
    ds_read_b64_tr_b16 v[94:95], v8 offset:19264
    ds_read_b64_tr_b16 v[96:97], v8 offset:18560
    ds_read_b64_tr_b16 v[98:99], v8 offset:19328
    v_mfma_f32_32x32x16_bf16 v[60:75], v[80:83], v[108:111], v[60:75]
    v_dot2_f32_bf16 v24, v80, v9, v24
    v_dot2_f32_bf16 v26, v80, v80, v26
    v_dot2_f32_bf16 v25, v81, v9, v25
    v_dot2_f32_bf16 v27, v81, v81, v27
    v_dot2_f32_bf16 v24, v82, v9, v24
    v_dot2_f32_bf16 v26, v82, v82, v26
    v_dot2_f32_bf16 v25, v83, v9, v25
    v_dot2_f32_bf16 v27, v83, v83, v27
    s_waitcnt lgkmcnt(7)
    v_mfma_f32_32x32x16_bf16 v[28:43], v[112:115], v[84:87], v[28:43]
    ds_read_b128 v[80:83], v18 offset:16384
    ds_read_b64_tr_b16 v[100:101], v8 offset:21504
    ds_read_b64_tr_b16 v[102:103], v8 offset:22272
    ds_read_b64_tr_b16 v[104:105], v8 offset:21568
    v_mfma_f32_32x32x16_bf16 v[44:59], v[116:119], v[84:87], v[44:59]
    ds_read_b64_tr_b16 v[106:107], v8 offset:22336
    ds_read_b64_tr_b16 v[108:109], v8 offset:21632
    ds_read_b64_tr_b16 v[110:111], v8 offset:22400
    v_mfma_f32_32x32x16_bf16 v[60:75], v[84:87], v[120:123], v[60:75]
    v_dot2_f32_bf16 v24, v84, v9, v24
    v_dot2_f32_bf16 v26, v84, v84, v26
    v_dot2_f32_bf16 v25, v85, v9, v25
    v_dot2_f32_bf16 v27, v85, v85, v27
    v_dot2_f32_bf16 v24, v86, v9, v24
    v_dot2_f32_bf16 v26, v86, v86, v26
    v_dot2_f32_bf16 v25, v87, v9, v25
    v_dot2_f32_bf16 v27, v87, v87, v27
    s_barrier
    s_waitcnt lgkmcnt(7)
    v_mfma_f32_32x32x16_bf16 v[28:43], v[88:91], v[76:79], v[28:43]
    ds_read_b128 v[84:87], v15 offset:32768
    ds_read_b64_tr_b16 v[112:113], v8 offset:24576
    ds_read_b64_tr_b16 v[114:115], v8 offset:25344
    ds_read_b64_tr_b16 v[116:117], v8 offset:24640
    v_mfma_f32_32x32x16_bf16 v[44:59], v[92:95], v[76:79], v[44:59]
    ds_read_b64_tr_b16 v[118:119], v8 offset:25408
    ds_read_b64_tr_b16 v[120:121], v8 offset:24704
    ds_read_b64_tr_b16 v[122:123], v8 offset:25472
    v_mfma_f32_32x32x16_bf16 v[60:75], v[76:79], v[96:99], v[60:75]
    v_dot2_f32_bf16 v24, v76, v9, v24
    v_dot2_f32_bf16 v26, v76, v76, v26
    v_dot2_f32_bf16 v25, v77, v9, v25
    v_dot2_f32_bf16 v27, v77, v77, v27
    v_dot2_f32_bf16 v24, v78, v9, v24
    v_dot2_f32_bf16 v26, v78, v78, v26
    v_dot2_f32_bf16 v25, v79, v9, v25
    v_dot2_f32_bf16 v27, v79, v79, v27
    s_waitcnt lgkmcnt(7)
    v_mfma_f32_32x32x16_bf16 v[28:43], v[100:103], v[80:83], v[28:43]
    ds_read_b128 v[76:79], v16 offset:32768
    ds_read_b64_tr_b16 v[88:89], v8 offset:27648
    ds_read_b64_tr_b16 v[90:91], v8 offset:28416
    ds_read_b64_tr_b16 v[92:93], v8 offset:27712
    v_mfma_f32_32x32x16_bf16 v[44:59], v[104:107], v[80:83], v[44:59]
    ds_read_b64_tr_b16 v[94:95], v8 offset:28480
    ds_read_b64_tr_b16 v[96:97], v8 offset:27776
    ds_read_b64_tr_b16 v[98:99], v8 offset:28544
    v_mfma_f32_32x32x16_bf16 v[60:75], v[80:83], v[108:111], v[60:75]
    v_dot2_f32_bf16 v24, v80, v9, v24
    v_dot2_f32_bf16 v26, v80, v80, v26
    v_dot2_f32_bf16 v25, v81, v9, v25
    v_dot2_f32_bf16 v27, v81, v81, v27
    v_dot2_f32_bf16 v24, v82, v9, v24
    v_dot2_f32_bf16 v26, v82, v82, v26
    v_dot2_f32_bf16 v25, v83, v9, v25
    v_dot2_f32_bf16 v27, v83, v83, v27
    s_waitcnt lgkmcnt(7)
    v_mfma_f32_32x32x16_bf16 v[28:43], v[112:115], v[84:87], v[28:43]
    ds_read_b128 v[80:83], v17 offset:32768
    ds_read_b64_tr_b16 v[100:101], v8 offset:30720
    ds_read_b64_tr_b16 v[102:103], v8 offset:31488
    ds_read_b64_tr_b16 v[104:105], v8 offset:30784
    v_mfma_f32_32x32x16_bf16 v[44:59], v[116:119], v[84:87], v[44:59]
    ds_read_b64_tr_b16 v[106:107], v8 offset:31552
    ds_read_b64_tr_b16 v[108:109], v8 offset:30848
    ds_read_b64_tr_b16 v[110:111], v8 offset:31616
    v_mfma_f32_32x32x16_bf16 v[60:75], v[84:87], v[120:123], v[60:75]
    v_dot2_f32_bf16 v24, v84, v9, v24
    v_dot2_f32_bf16 v26, v84, v84, v26
    v_dot2_f32_bf16 v25, v85, v9, v25
    v_dot2_f32_bf16 v27, v85, v85, v27
    v_dot2_f32_bf16 v24, v86, v9, v24
    v_dot2_f32_bf16 v26, v86, v86, v26
    v_dot2_f32_bf16 v25, v87, v9, v25
    v_dot2_f32_bf16 v27, v87, v87, v27
    s_waitcnt lgkmcnt(7)
    v_mfma_f32_32x32x16_bf16 v[28:43], v[88:91], v[76:79], v[28:43]
    ds_read_b128 v[84:87], v18 offset:32768
    ds_read_b64_tr_b16 v[112:113], v8 offset:33792
    ds_read_b64_tr_b16 v[114:115], v8 offset:34560
    ds_read_b64_tr_b16 v[116:117], v8 offset:33856
    v_mfma_f32_32x32x16_bf16 v[44:59], v[92:95], v[76:79], v[44:59]
    ds_read_b64_tr_b16 v[118:119], v8 offset:34624
    ds_read_b64_tr_b16 v[120:121], v8 offset:33920
    ds_read_b64_tr_b16 v[122:123], v8 offset:34688
    v_mfma_f32_32x32x16_bf16 v[60:75], v[76:79], v[96:99], v[60:75]
    v_dot2_f32_bf16 v24, v76, v9, v24
    v_dot2_f32_bf16 v26, v76, v76, v26
    v_dot2_f32_bf16 v25, v77, v9, v25
    v_dot2_f32_bf16 v27, v77, v77, v27
    v_dot2_f32_bf16 v24, v78, v9, v24
    v_dot2_f32_bf16 v26, v78, v78, v26
    v_dot2_f32_bf16 v25, v79, v9, v25
    v_dot2_f32_bf16 v27, v79, v79, v27
    s_waitcnt vmcnt(0)
    s_barrier
    s_cmp_lg_u32 s44, 0
    s_cbranch_scc1 L_only_57
    s_mov_b64 exec, 1
    v_mov_b32 v2, s6
    v_mov_b32 v3, s7
    buffer_store_dwordx2 v[2:3], off, s[8:11], s57 sc1
    s_mov_b64 exec, -1
L_only_57:
    s_waitcnt lgkmcnt(7)
    v_mfma_f32_32x32x16_bf16 v[28:43], v[100:103], v[80:83], v[28:43]
    ds_read_b128 v[76:79], v15 offset:49152
    ds_read_b64_tr_b16 v[88:89], v8 offset:36864
    ds_read_b64_tr_b16 v[90:91], v8 offset:37632
    ds_read_b64_tr_b16 v[92:93], v8 offset:36928
    v_mfma_f32_32x32x16_bf16 v[44:59], v[104:107], v[80:83], v[44:59]
    ds_read_b64_tr_b16 v[94:95], v8 offset:37696
    ds_read_b64_tr_b16 v[96:97], v8 offset:36992
    ds_read_b64_tr_b16 v[98:99], v8 offset:37760
    v_mfma_f32_32x32x16_bf16 v[60:75], v[80:83], v[108:111], v[60:75]
    v_dot2_f32_bf16 v24, v80, v9, v24
    v_dot2_f32_bf16 v26, v80, v80, v26
    v_dot2_f32_bf16 v25, v81, v9, v25
    v_dot2_f32_bf16 v27, v81, v81, v27
    v_dot2_f32_bf16 v24, v82, v9, v24
    v_dot2_f32_bf16 v26, v82, v82, v26
    v_dot2_f32_bf16 v25, v83, v9, v25
    v_dot2_f32_bf16 v27, v83, v83, v27
    s_waitcnt lgkmcnt(7)
    v_mfma_f32_32x32x16_bf16 v[28:43], v[112:115], v[84:87], v[28:43]
    ds_read_b128 v[80:83], v16 offset:49152
    ds_read_b64_tr_b16 v[100:101], v8 offset:39936
    ds_read_b64_tr_b16 v[102:103], v8 offset:40704
    ds_read_b64_tr_b16 v[104:105], v8 offset:40000
    v_mfma_f32_32x32x16_bf16 v[44:59], v[116:119], v[84:87], v[44:59]
    ds_read_b64_tr_b16 v[106:107], v8 offset:40768
    ds_read_b64_tr_b16 v[108:109], v8 offset:40064
    ds_read_b64_tr_b16 v[110:111], v8 offset:40832
    v_mfma_f32_32x32x16_bf16 v[60:75], v[84:87], v[120:123], v[60:75]
    v_dot2_f32_bf16 v24, v84, v9, v24
    v_dot2_f32_bf16 v26, v84, v84, v26
    v_dot2_f32_bf16 v25, v85, v9, v25
    v_dot2_f32_bf16 v27, v85, v85, v27
    v_dot2_f32_bf16 v24, v86, v9, v24
    v_dot2_f32_bf16 v26, v86, v86, v26
    v_dot2_f32_bf16 v25, v87, v9, v25
    v_dot2_f32_bf16 v27, v87, v87, v27
    s_waitcnt lgkmcnt(7)
    v_mfma_f32_32x32x16_bf16 v[28:43], v[88:91], v[76:79], v[28:43]
    ds_read_b128 v[84:87], v17 offset:49152
    ds_read_b64_tr_b16 v[112:113], v8 offset:43008
    ds_read_b64_tr_b16 v[114:115], v8 offset:43776
    ds_read_b64_tr_b16 v[116:117], v8 offset:43072
    v_mfma_f32_32x32x16_bf16 v[44:59], v[92:95], v[76:79], v[44:59]
    ds_read_b64_tr_b16 v[118:119], v8 offset:43840
    ds_read_b64_tr_b16 v[120:121], v8 offset:43136
    ds_read_b64_tr_b16 v[122:123], v8 offset:43904
    v_mfma_f32_32x32x16_bf16 v[60:75], v[76:79], v[96:99], v[60:75]
    v_dot2_f32_bf16 v24, v76, v9, v24
    v_dot2_f32_bf16 v26, v76, v76, v26
    v_dot2_f32_bf16 v25, v77, v9, v25
    v_dot2_f32_bf16 v27, v77, v77, v27
    v_dot2_f32_bf16 v24, v78, v9, v24
    v_dot2_f32_bf16 v26, v78, v78, v26
    v_dot2_f32_bf16 v25, v79, v9, v25
    v_dot2_f32_bf16 v27, v79, v79, v27
    s_waitcnt lgkmcnt(7)
    v_mfma_f32_32x32x16_bf16 v[28:43], v[100:103], v[80:83], v[28:43]
    ds_read_b128 v[76:79], v18 offset:49152
    ds_read_b64_tr_b16 v[88:89], v8 offset:46080
    ds_read_b64_tr_b16 v[90:91], v8 offset:46848
    ds_read_b64_tr_b16 v[92:93], v8 offset:46144
    v_mfma_f32_32x32x16_bf16 v[44:59], v[104:107], v[80:83], v[44:59]
    ds_read_b64_tr_b16 v[94:95], v8 offset:46912
    ds_read_b64_tr_b16 v[96:97], v8 offset:46208
    ds_read_b64_tr_b16 v[98:99], v8 offset:46976
    v_mfma_f32_32x32x16_bf16 v[60:75], v[80:83], v[108:111], v[60:75]
    v_dot2_f32_bf16 v24, v80, v9, v24
    v_dot2_f32_bf16 v26, v80, v80, v26
    v_dot2_f32_bf16 v25, v81, v9, v25
    v_dot2_f32_bf16 v27, v81, v81, v27
    v_dot2_f32_bf16 v24, v82, v9, v24
    v_dot2_f32_bf16 v26, v82, v82, v26
    v_dot2_f32_bf16 v25, v83, v9, v25
    v_dot2_f32_bf16 v27, v83, v83, v27
    s_barrier
    s_waitcnt lgkmcnt(7)
    v_mfma_f32_32x32x16_bf16 v[28:43], v[112:115], v[84:87], v[28:43]
    ds_read_b128 v[80:83], v19
    ds_read_b64_tr_b16 v[100:101], v8 offset:49152
    ds_read_b64_tr_b16 v[102:103], v8 offset:49920
    ds_read_b64_tr_b16 v[104:105], v8 offset:49216
    v_mfma_f32_32x32x16_bf16 v[44:59], v[116:119], v[84:87], v[44:59]
    ds_read_b64_tr_b16 v[106:107], v8 offset:49984
    ds_read_b64_tr_b16 v[108:109], v8 offset:49280
    ds_read_b64_tr_b16 v[110:111], v8 offset:50048
    v_mfma_f32_32x32x16_bf16 v[60:75], v[84:87], v[120:123], v[60:75]
    v_dot2_f32_bf16 v24, v84, v9, v24
    v_dot2_f32_bf16 v26, v84, v84, v26
    v_dot2_f32_bf16 v25, v85, v9, v25
    v_dot2_f32_bf16 v27, v85, v85, v27
    v_dot2_f32_bf16 v24, v86, v9, v24
    v_dot2_f32_bf16 v26, v86, v86, v26
    v_dot2_f32_bf16 v25, v87, v9, v25
    v_dot2_f32_bf16 v27, v87, v87, v27
    s_waitcnt lgkmcnt(7)
    v_mfma_f32_32x32x16_bf16 v[28:43], v[88:91], v[76:79], v[28:43]
    ds_read_b128 v[84:87], v20
    ds_read_b64_tr_b16 v[112:113], v8 offset:52224
    ds_read_b64_tr_b16 v[114:115], v8 offset:52992
    ds_read_b64_tr_b16 v[116:117], v8 offset:52288
    v_mfma_f32_32x32x16_bf16 v[44:59], v[92:95], v[76:79], v[44:59]
    ds_read_b64_tr_b16 v[118:119], v8 offset:53056
    ds_read_b64_tr_b16 v[120:121], v8 offset:52352
    ds_read_b64_tr_b16 v[122:123], v8 offset:53120
    v_mfma_f32_32x32x16_bf16 v[60:75], v[76:79], v[96:99], v[60:75]
    v_dot2_f32_bf16 v24, v76, v9, v24
    v_dot2_f32_bf16 v26, v76, v76, v26
    v_dot2_f32_bf16 v25, v77, v9, v25
    v_dot2_f32_bf16 v27, v77, v77, v27
    v_dot2_f32_bf16 v24, v78, v9, v24
    v_dot2_f32_bf16 v26, v78, v78, v26
    v_dot2_f32_bf16 v25, v79, v9, v25
    v_dot2_f32_bf16 v27, v79, v79, v27
    s_waitcnt lgkmcnt(7)
    v_mfma_f32_32x32x16_bf16 v[28:43], v[100:103], v[80:83], v[28:43]
    ds_read_b128 v[76:79], v21
    ds_read_b64_tr_b16 v[88:89], v8 offset:55296
    ds_read_b64_tr_b16 v[90:91], v8 offset:56064
    ds_read_b64_tr_b16 v[92:93], v8 offset:55360
    v_mfma_f32_32x32x16_bf16 v[44:59], v[104:107], v[80:83], v[44:59]
    ds_read_b64_tr_b16 v[94:95], v8 offset:56128
    ds_read_b64_tr_b16 v[96:97], v8 offset:55424
    ds_read_b64_tr_b16 v[98:99], v8 offset:56192
    v_mfma_f32_32x32x16_bf16 v[60:75], v[80:83], v[108:111], v[60:75]
    v_dot2_f32_bf16 v24, v80, v9, v24
    v_dot2_f32_bf16 v26, v80, v80, v26
    v_dot2_f32_bf16 v25, v81, v9, v25
    v_dot2_f32_bf16 v27, v81, v81, v27
    v_dot2_f32_bf16 v24, v82, v9, v24
    v_dot2_f32_bf16 v26, v82, v82, v26
    v_dot2_f32_bf16 v25, v83, v9, v25
    v_dot2_f32_bf16 v27, v83, v83, v27
    s_waitcnt lgkmcnt(7)
    v_mfma_f32_32x32x16_bf16 v[28:43], v[112:115], v[84:87], v[28:43]
    ds_read_b128 v[80:83], v22
    ds_read_b64_tr_b16 v[100:101], v8 offset:58368
    ds_read_b64_tr_b16 v[102:103], v8 offset:59136
    ds_read_b64_tr_b16 v[104:105], v8 offset:58432
    v_mfma_f32_32x32x16_bf16 v[44:59], v[116:119], v[84:87], v[44:59]
    ds_read_b64_tr_b16 v[106:107], v8 offset:59200
    ds_read_b64_tr_b16 v[108:109], v8 offset:58496
    ds_read_b64_tr_b16 v[110:111], v8 offset:59264
    v_mfma_f32_32x32x16_bf16 v[60:75], v[84:87], v[120:123], v[60:75]
    v_dot2_f32_bf16 v24, v84, v9, v24
    v_dot2_f32_bf16 v26, v84, v84, v26
    v_dot2_f32_bf16 v25, v85, v9, v25
    v_dot2_f32_bf16 v27, v85, v85, v27
    v_dot2_f32_bf16 v24, v86, v9, v24
    v_dot2_f32_bf16 v26, v86, v86, v26
    v_dot2_f32_bf16 v25, v87, v9, v25
    v_dot2_f32_bf16 v27, v87, v87, v27
    s_barrier
    s_waitcnt lgkmcnt(7)
    v_mfma_f32_32x32x16_bf16 v[28:43], v[88:91], v[76:79], v[28:43]
    ds_read_b128 v[84:87], v15 offset:0
    ds_read_b64_tr_b16 v[112:113], v8 offset:0
    ds_read_b64_tr_b16 v[114:115], v8 offset:768
    ds_read_b64_tr_b16 v[116:117], v8 offset:64
    v_mfma_f32_32x32x16_bf16 v[44:59], v[92:95], v[76:79], v[44:59]
    ds_read_b64_tr_b16 v[118:119], v8 offset:832
    ds_read_b64_tr_b16 v[120:121], v8 offset:128
    ds_read_b64_tr_b16 v[122:123], v8 offset:896
    v_mfma_f32_32x32x16_bf16 v[60:75], v[76:79], v[96:99], v[60:75]
    v_dot2_f32_bf16 v24, v76, v9, v24
    v_dot2_f32_bf16 v26, v76, v76, v26
    v_dot2_f32_bf16 v25, v77, v9, v25
    v_dot2_f32_bf16 v27, v77, v77, v27
    v_dot2_f32_bf16 v24, v78, v9, v24
    v_dot2_f32_bf16 v26, v78, v78, v26
    v_dot2_f32_bf16 v25, v79, v9, v25
    v_dot2_f32_bf16 v27, v79, v79, v27
    s_waitcnt lgkmcnt(7)
    v_mfma_f32_32x32x16_bf16 v[28:43], v[100:103], v[80:83], v[28:43]
    ds_read_b128 v[76:79], v16 offset:0
    ds_read_b64_tr_b16 v[88:89], v8 offset:3072
    ds_read_b64_tr_b16 v[90:91], v8 offset:3840
    ds_read_b64_tr_b16 v[92:93], v8 offset:3136
    v_mfma_f32_32x32x16_bf16 v[44:59], v[104:107], v[80:83], v[44:59]
    ds_read_b64_tr_b16 v[94:95], v8 offset:3904
    ds_read_b64_tr_b16 v[96:97], v8 offset:3200
    ds_read_b64_tr_b16 v[98:99], v8 offset:3968
    v_mfma_f32_32x32x16_bf16 v[60:75], v[80:83], v[108:111], v[60:75]
    v_dot2_f32_bf16 v24, v80, v9, v24
    v_dot2_f32_bf16 v26, v80, v80, v26
    v_dot2_f32_bf16 v25, v81, v9, v25
    v_dot2_f32_bf16 v27, v81, v81, v27
    v_dot2_f32_bf16 v24, v82, v9, v24
    v_dot2_f32_bf16 v26, v82, v82, v26
    v_dot2_f32_bf16 v25, v83, v9, v25
    v_dot2_f32_bf16 v27, v83, v83, v27
    s_waitcnt lgkmcnt(7)
    v_mfma_f32_32x32x16_bf16 v[28:43], v[112:115], v[84:87], v[28:43]
    ds_read_b128 v[80:83], v17 offset:0
    ds_read_b64_tr_b16 v[100:101], v8 offset:6144
    ds_read_b64_tr_b16 v[102:103], v8 offset:6912
    ds_read_b64_tr_b16 v[104:105], v8 offset:6208
    v_mfma_f32_32x32x16_bf16 v[44:59], v[116:119], v[84:87], v[44:59]
    ds_read_b64_tr_b16 v[106:107], v8 offset:6976
    ds_read_b64_tr_b16 v[108:109], v8 offset:6272
    ds_read_b64_tr_b16 v[110:111], v8 offset:7040
    v_mfma_f32_32x32x16_bf16 v[60:75], v[84:87], v[120:123], v[60:75]
    v_dot2_f32_bf16 v24, v84, v9, v24
    v_dot2_f32_bf16 v26, v84, v84, v26
    v_dot2_f32_bf16 v25, v85, v9, v25
    v_dot2_f32_bf16 v27, v85, v85, v27
    v_dot2_f32_bf16 v24, v86, v9, v24
    v_dot2_f32_bf16 v26, v86, v86, v26
    v_dot2_f32_bf16 v25, v87, v9, v25
    v_dot2_f32_bf16 v27, v87, v87, v27
    s_waitcnt lgkmcnt(7)
    v_mfma_f32_32x32x16_bf16 v[28:43], v[88:91], v[76:79], v[28:43]
    ds_read_b128 v[84:87], v18 offset:0
    ds_read_b64_tr_b16 v[112:113], v8 offset:9216
    ds_read_b64_tr_b16 v[114:115], v8 offset:9984
    ds_read_b64_tr_b16 v[116:117], v8 offset:9280
    v_mfma_f32_32x32x16_bf16 v[44:59], v[92:95], v[76:79], v[44:59]
    ds_read_b64_tr_b16 v[118:119], v8 offset:10048
    ds_read_b64_tr_b16 v[120:121], v8 offset:9344
    ds_read_b64_tr_b16 v[122:123], v8 offset:10112
    v_mfma_f32_32x32x16_bf16 v[60:75], v[76:79], v[96:99], v[60:75]
    v_dot2_f32_bf16 v24, v76, v9, v24
    v_dot2_f32_bf16 v26, v76, v76, v26
    v_dot2_f32_bf16 v25, v77, v9, v25
    v_dot2_f32_bf16 v27, v77, v77, v27
    v_dot2_f32_bf16 v24, v78, v9, v24
    v_dot2_f32_bf16 v26, v78, v78, v26
    v_dot2_f32_bf16 v25, v79, v9, v25
    v_dot2_f32_bf16 v27, v79, v79, v27
    s_barrier
    buffer_load_dwordx2 v[4:5], v6, s[8:11], 0 offen sc1
    s_waitcnt lgkmcnt(7)
    v_mfma_f32_32x32x16_bf16 v[28:43], v[100:103], v[80:83], v[28:43]
    ds_read_b128 v[76:79], v15 offset:16384
    ds_read_b64_tr_b16 v[88:89], v8 offset:12288
    ds_read_b64_tr_b16 v[90:91], v8 offset:13056
    ds_read_b64_tr_b16 v[92:93], v8 offset:12352
    v_mfma_f32_32x32x16_bf16 v[44:59], v[104:107], v[80:83], v[44:59]
    ds_read_b64_tr_b16 v[94:95], v8 offset:13120
    ds_read_b64_tr_b16 v[96:97], v8 offset:12416
    ds_read_b64_tr_b16 v[98:99], v8 offset:13184
    v_mfma_f32_32x32x16_bf16 v[60:75], v[80:83], v[108:111], v[60:75]
    v_dot2_f32_bf16 v24, v80, v9, v24
    v_dot2_f32_bf16 v26, v80, v80, v26
    v_dot2_f32_bf16 v25, v81, v9, v25
    v_dot2_f32_bf16 v27, v81, v81, v27
    v_dot2_f32_bf16 v24, v82, v9, v24
    v_dot2_f32_bf16 v26, v82, v82, v26
    v_dot2_f32_bf16 v25, v83, v9, v25
    v_dot2_f32_bf16 v27, v83, v83, v27
    s_waitcnt lgkmcnt(7)
    v_mfma_f32_32x32x16_bf16 v[28:43], v[112:115], v[84:87], v[28:43]
    ds_read_b128 v[80:83], v16 offset:16384
    ds_read_b64_tr_b16 v[100:101], v8 offset:15360
    ds_read_b64_tr_b16 v[102:103], v8 offset:16128
    ds_read_b64_tr_b16 v[104:105], v8 offset:15424
    v_mfma_f32_32x32x16_bf16 v[44:59], v[116:119], v[84:87], v[44:59]
    ds_read_b64_tr_b16 v[106:107], v8 offset:16192
    ds_read_b64_tr_b16 v[108:109], v8 offset:15488
    ds_read_b64_tr_b16 v[110:111], v8 offset:16256
    v_mfma_f32_32x32x16_bf16 v[60:75], v[84:87], v[120:123], v[60:75]
    v_dot2_f32_bf16 v24, v84, v9, v24
    v_dot2_f32_bf16 v26, v84, v84, v26
    v_dot2_f32_bf16 v25, v85, v9, v25
    v_dot2_f32_bf16 v27, v85, v85, v27
    v_dot2_f32_bf16 v24, v86, v9, v24
    v_dot2_f32_bf16 v26, v86, v86, v26
    v_dot2_f32_bf16 v25, v87, v9, v25
    v_dot2_f32_bf16 v27, v87, v87, v27
    s_waitcnt lgkmcnt(7)
    v_mfma_f32_32x32x16_bf16 v[28:43], v[88:91], v[76:79], v[28:43]
    ds_read_b128 v[84:87], v17 offset:16384
    ds_read_b64_tr_b16 v[112:113], v8 offset:18432
    ds_read_b64_tr_b16 v[114:115], v8 offset:19200
    ds_read_b64_tr_b16 v[116:117], v8 offset:18496
    v_mfma_f32_32x32x16_bf16 v[44:59], v[92:95], v[76:79], v[44:59]
    ds_read_b64_tr_b16 v[118:119], v8 offset:19264
    ds_read_b64_tr_b16 v[120:121], v8 offset:18560
    ds_read_b64_tr_b16 v[122:123], v8 offset:19328
    v_mfma_f32_32x32x16_bf16 v[60:75], v[76:79], v[96:99], v[60:75]
    v_dot2_f32_bf16 v24, v76, v9, v24
    v_dot2_f32_bf16 v26, v76, v76, v26
    v_dot2_f32_bf16 v25, v77, v9, v25
    v_dot2_f32_bf16 v27, v77, v77, v27
    v_dot2_f32_bf16 v24, v78, v9, v24
    v_dot2_f32_bf16 v26, v78, v78, v26
    v_dot2_f32_bf16 v25, v79, v9, v25
    v_dot2_f32_bf16 v27, v79, v79, v27
    s_waitcnt lgkmcnt(7)
    v_mfma_f32_32x32x16_bf16 v[28:43], v[100:103], v[80:83], v[28:43]
    ds_read_b128 v[76:79], v18 offset:16384
    ds_read_b64_tr_b16 v[88:89], v8 offset:21504
    ds_read_b64_tr_b16 v[90:91], v8 offset:22272
    ds_read_b64_tr_b16 v[92:93], v8 offset:21568
    v_mfma_f32_32x32x16_bf16 v[44:59], v[104:107], v[80:83], v[44:59]
    ds_read_b64_tr_b16 v[94:95], v8 offset:22336
    ds_read_b64_tr_b16 v[96:97], v8 offset:21632
    ds_read_b64_tr_b16 v[98:99], v8 offset:22400
    v_mfma_f32_32x32x16_bf16 v[60:75], v[80:83], v[108:111], v[60:75]
    v_dot2_f32_bf16 v24, v80, v9, v24
    v_dot2_f32_bf16 v26, v80, v80, v26
    v_dot2_f32_bf16 v25, v81, v9, v25
    v_dot2_f32_bf16 v27, v81, v81, v27
    v_dot2_f32_bf16 v24, v82, v9, v24
    v_dot2_f32_bf16 v26, v82, v82, v26
    v_dot2_f32_bf16 v25, v83, v9, v25
    v_dot2_f32_bf16 v27, v83, v83, v27
    s_barrier
    s_waitcnt lgkmcnt(7)
    v_mfma_f32_32x32x16_bf16 v[28:43], v[112:115], v[84:87], v[28:43]
    ds_read_b128 v[80:83], v15 offset:32768
    ds_read_b64_tr_b16 v[100:101], v8 offset:24576
    ds_read_b64_tr_b16 v[102:103], v8 offset:25344
    ds_read_b64_tr_b16 v[104:105], v8 offset:24640
    v_mfma_f32_32x32x16_bf16 v[44:59], v[116:119], v[84:87], v[44:59]
    ds_read_b64_tr_b16 v[106:107], v8 offset:25408
    ds_read_b64_tr_b16 v[108:109], v8 offset:24704
    ds_read_b64_tr_b16 v[110:111], v8 offset:25472
    v_mfma_f32_32x32x16_bf16 v[60:75], v[84:87], v[120:123], v[60:75]
    v_dot2_f32_bf16 v24, v84, v9, v24
    v_dot2_f32_bf16 v26, v84, v84, v26
    v_dot2_f32_bf16 v25, v85, v9, v25
    v_dot2_f32_bf16 v27, v85, v85, v27
    v_dot2_f32_bf16 v24, v86, v9, v24
    v_dot2_f32_bf16 v26, v86, v86, v26
    v_dot2_f32_bf16 v25, v87, v9, v25
    v_dot2_f32_bf16 v27, v87, v87, v27
    s_waitcnt lgkmcnt(7)
    v_mfma_f32_32x32x16_bf16 v[28:43], v[88:91], v[76:79], v[28:43]
    ds_read_b128 v[84:87], v16 offset:32768
    ds_read_b64_tr_b16 v[112:113], v8 offset:27648
    ds_read_b64_tr_b16 v[114:115], v8 offset:28416
    ds_read_b64_tr_b16 v[116:117], v8 offset:27712
    v_mfma_f32_32x32x16_bf16 v[44:59], v[92:95], v[76:79], v[44:59]
    ds_read_b64_tr_b16 v[118:119], v8 offset:28480
    ds_read_b64_tr_b16 v[120:121], v8 offset:27776
    ds_read_b64_tr_b16 v[122:123], v8 offset:28544
    v_mfma_f32_32x32x16_bf16 v[60:75], v[76:79], v[96:99], v[60:75]
    v_dot2_f32_bf16 v24, v76, v9, v24
    v_dot2_f32_bf16 v26, v76, v76, v26
    v_dot2_f32_bf16 v25, v77, v9, v25
    v_dot2_f32_bf16 v27, v77, v77, v27
    v_dot2_f32_bf16 v24, v78, v9, v24
    v_dot2_f32_bf16 v26, v78, v78, v26
    v_dot2_f32_bf16 v25, v79, v9, v25
    v_dot2_f32_bf16 v27, v79, v79, v27
    s_waitcnt lgkmcnt(7)
    v_mfma_f32_32x32x16_bf16 v[28:43], v[100:103], v[80:83], v[28:43]
    ds_read_b128 v[76:79], v17 offset:32768
    ds_read_b64_tr_b16 v[88:89], v8 offset:30720
    ds_read_b64_tr_b16 v[90:91], v8 offset:31488
    ds_read_b64_tr_b16 v[92:93], v8 offset:30784
    v_mfma_f32_32x32x16_bf16 v[44:59], v[104:107], v[80:83], v[44:59]
    ds_read_b64_tr_b16 v[94:95], v8 offset:31552
    ds_read_b64_tr_b16 v[96:97], v8 offset:30848
    ds_read_b64_tr_b16 v[98:99], v8 offset:31616
    v_mfma_f32_32x32x16_bf16 v[60:75], v[80:83], v[108:111], v[60:75]
    v_dot2_f32_bf16 v24, v80, v9, v24
    v_dot2_f32_bf16 v26, v80, v80, v26
    v_dot2_f32_bf16 v25, v81, v9, v25
    v_dot2_f32_bf16 v27, v81, v81, v27
    v_dot2_f32_bf16 v24, v82, v9, v24
    v_dot2_f32_bf16 v26, v82, v82, v26
    v_dot2_f32_bf16 v25, v83, v9, v25
    v_dot2_f32_bf16 v27, v83, v83, v27
    s_waitcnt lgkmcnt(7)
    v_mfma_f32_32x32x16_bf16 v[28:43], v[112:115], v[84:87], v[28:43]
    ds_read_b128 v[80:83], v18 offset:32768
    ds_read_b64_tr_b16 v[100:101], v8 offset:33792
    ds_read_b64_tr_b16 v[102:103], v8 offset:34560
    ds_read_b64_tr_b16 v[104:105], v8 offset:33856
    v_mfma_f32_32x32x16_bf16 v[44:59], v[116:119], v[84:87], v[44:59]
    ds_read_b64_tr_b16 v[106:107], v8 offset:34624
    ds_read_b64_tr_b16 v[108:109], v8 offset:33920
    ds_read_b64_tr_b16 v[110:111], v8 offset:34688
    v_mfma_f32_32x32x16_bf16 v[60:75], v[84:87], v[120:123], v[60:75]
    v_dot2_f32_bf16 v24, v84, v9, v24
    v_dot2_f32_bf16 v26, v84, v84, v26
    v_dot2_f32_bf16 v25, v85, v9, v25
    v_dot2_f32_bf16 v27, v85, v85, v27
    v_dot2_f32_bf16 v24, v86, v9, v24
    v_dot2_f32_bf16 v26, v86, v86, v26
    v_dot2_f32_bf16 v25, v87, v9, v25
    v_dot2_f32_bf16 v27, v87, v87, v27
    s_waitcnt lgkmcnt(7)
    v_mfma_f32_32x32x16_bf16 v[28:43], v[88:91], v[76:79], v[28:43]
    v_mfma_f32_32x32x16_bf16 v[44:59], v[92:95], v[76:79], v[44:59]
    v_mfma_f32_32x32x16_bf16 v[60:75], v[76:79], v[96:99], v[60:75]
    v_dot2_f32_bf16 v24, v76, v9, v24
    v_dot2_f32_bf16 v26, v76, v76, v26
    v_dot2_f32_bf16 v25, v77, v9, v25
    v_dot2_f32_bf16 v27, v77, v77, v27
    v_dot2_f32_bf16 v24, v78, v9, v24
    v_dot2_f32_bf16 v26, v78, v78, v26
    v_dot2_f32_bf16 v25, v79, v9, v25
    v_dot2_f32_bf16 v27, v79, v79, v27
    s_waitcnt lgkmcnt(0)
    v_mfma_f32_32x32x16_bf16 v[28:43], v[100:103], v[80:83], v[28:43]
    v_mfma_f32_32x32x16_bf16 v[44:59], v[104:107], v[80:83], v[44:59]
    v_mfma_f32_32x32x16_bf16 v[60:75], v[80:83], v[108:111], v[60:75]
    v_dot2_f32_bf16 v24, v80, v9, v24
    v_dot2_f32_bf16 v26, v80, v80, v26
    v_dot2_f32_bf16 v25, v81, v9, v25
    v_dot2_f32_bf16 v27, v81, v81, v27
    v_dot2_f32_bf16 v24, v82, v9, v24
    v_dot2_f32_bf16 v26, v82, v82, v26
    v_dot2_f32_bf16 v25, v83, v9, v25
    v_dot2_f32_bf16 v27, v83, v83, v27
    s_nop 2
    v_add_f32 v24, v24, v25
    v_add_f32 v26, v26, v27
    v_mov_b32 v124, v24
    v_mov_b32 v125, v26
    s_nop 1
    v_permlane32_swap_b32 v24, v124
    v_permlane32_swap_b32 v26, v125
    s_nop 1
    v_add_f32 v24, v24, v124
    v_add_f32 v26, v26, v125
    v_mul_f32 v128, 0xbb000000, v24
    v_mul_f32 v26, 0x3b000000, v26
    v_fma_f32 v130, -v128, v128, v26
    v_max_f32 v130, 0, v130
    v_add_f32 v130, 0x3727c5ac, v130
    v_rsq_f32 v130, v130
    v_cmp_gt_u32 vcc, 32, v0
    s_nop 1
    v_cndmask_b32 v124, v128, v130, vcc
    ds_write_b32 v244, v124
    s_waitcnt lgkmcnt(0)
    ds_read_b128 v[188:191], v245 offset:0
    ds_read_b128 v[204:207], v245 offset:128
    ds_read_b128 v[192:195], v245 offset:32
    ds_read_b128 v[208:211], v245 offset:160
    ds_read_b128 v[196:199], v245 offset:64
    ds_read_b128 v[212:215], v245 offset:192
    ds_read_b128 v[200:203], v245 offset:96
    ds_read_b128 v[216:219], v245 offset:224
    s_waitcnt lgkmcnt(0)
    s_waitcnt vmcnt(0)
    v_cmp_ne_u64 vcc, s[6:7], v[4:5]
    s_cbranch_vccnz L_gs_58
L_gb_59:
    s_barrier
    ds_read_b128 v[156:159], v246 offset:128
    ds_read_b128 v[160:163], v246 offset:160
    ds_read_b128 v[164:167], v246 offset:192
    ds_read_b128 v[168:171], v246 offset:224
    ds_read_b32 v138, v247 offset:256
    ds_read_b128 v[140:143], v246 offset:0
    ds_read_b128 v[144:147], v246 offset:32
    ds_read_b128 v[148:151], v246 offset:64
    ds_read_b128 v[152:155], v246 offset:96
    v_mul_f32 v132, 0x3eb8aa3b, v130
    s_waitcnt lgkmcnt(5)
    v_pk_fma_f32 v[44:45], v[156:157], v[128:129], v[44:45] op_sel_hi:[1,0,1]
    v_pk_fma_f32 v[46:47], v[158:159], v[128:129], v[46:47] op_sel_hi:[1,0,1]
    v_pk_fma_f32 v[48:49], v[160:161], v[128:129], v[48:49] op_sel_hi:[1,0,1]
    v_pk_fma_f32 v[50:51], v[162:163], v[128:129], v[50:51] op_sel_hi:[1,0,1]
    v_pk_fma_f32 v[52:53], v[164:165], v[128:129], v[52:53] op_sel_hi:[1,0,1]
    v_pk_fma_f32 v[54:55], v[166:167], v[128:129], v[54:55] op_sel_hi:[1,0,1]
    v_pk_fma_f32 v[56:57], v[168:169], v[128:129], v[56:57] op_sel_hi:[1,0,1]
    v_pk_fma_f32 v[58:59], v[170:171], v[128:129], v[58:59] op_sel_hi:[1,0,1]
    v_pk_mul_f32 v[44:45], v[44:45], v[130:131] op_sel_hi:[1,0]
    v_pk_mul_f32 v[46:47], v[46:47], v[130:131] op_sel_hi:[1,0]
    v_pk_mul_f32 v[48:49], v[48:49], v[130:131] op_sel_hi:[1,0]
    v_pk_mul_f32 v[50:51], v[50:51], v[130:131] op_sel_hi:[1,0]
    v_pk_mul_f32 v[52:53], v[52:53], v[130:131] op_sel_hi:[1,0]
    v_pk_mul_f32 v[54:55], v[54:55], v[130:131] op_sel_hi:[1,0]
    v_pk_mul_f32 v[56:57], v[56:57], v[130:131] op_sel_hi:[1,0]
    v_pk_mul_f32 v[58:59], v[58:59], v[130:131] op_sel_hi:[1,0]
    v_cvt_pk_bf16_f32 v228, v44, v45
    v_cvt_pk_bf16_f32 v229, v46, v47
    v_cvt_pk_bf16_f32 v230, v48, v49
    v_cvt_pk_bf16_f32 v231, v50, v51
    v_cvt_pk_bf16_f32 v232, v52, v53
    v_cvt_pk_bf16_f32 v233, v54, v55
    v_cvt_pk_bf16_f32 v234, v56, v57
    v_cvt_pk_bf16_f32 v235, v58, v59
    v_min_u32 v231, -2, v231
    v_min_u32 v235, -2, v235
    s_cmp_lg_u32 s66, 0
    s_cbranch_scc1 L_wt_63
    buffer_store_dwordx4 v[228:231], v1, s[8:11], s53 offen
    buffer_store_dwordx4 v[232:235], v1, s[8:11], s54 offen
L_wb_64:
    s_waitcnt lgkmcnt(4)
    v_pk_fma_f32 v[60:61], v[204:205], v[138:139], v[60:61] op_sel_hi:[1,0,1]
    v_pk_fma_f32 v[62:63], v[206:207], v[138:139], v[62:63] op_sel_hi:[1,0,1]
    v_pk_fma_f32 v[64:65], v[208:209], v[138:139], v[64:65] op_sel_hi:[1,0,1]
    v_pk_fma_f32 v[66:67], v[210:211], v[138:139], v[66:67] op_sel_hi:[1,0,1]
    v_pk_fma_f32 v[68:69], v[212:213], v[138:139], v[68:69] op_sel_hi:[1,0,1]
    v_pk_fma_f32 v[70:71], v[214:215], v[138:139], v[70:71] op_sel_hi:[1,0,1]
    v_pk_fma_f32 v[72:73], v[216:217], v[138:139], v[72:73] op_sel_hi:[1,0,1]
    v_pk_fma_f32 v[74:75], v[218:219], v[138:139], v[74:75] op_sel_hi:[1,0,1]
    v_pk_mul_f32 v[60:61], v[60:61], v[188:189]
    v_pk_mul_f32 v[62:63], v[62:63], v[190:191]
    v_pk_mul_f32 v[64:65], v[64:65], v[192:193]
    v_pk_mul_f32 v[66:67], v[66:67], v[194:195]
    v_pk_mul_f32 v[68:69], v[68:69], v[196:197]
    v_pk_mul_f32 v[70:71], v[70:71], v[198:199]
    v_pk_mul_f32 v[72:73], v[72:73], v[200:201]
    v_pk_mul_f32 v[74:75], v[74:75], v[202:203]
    v_cvt_pk_bf16_f32 v236, v60, v61
    v_cvt_pk_bf16_f32 v237, v62, v63
    v_cvt_pk_bf16_f32 v238, v64, v65
    v_cvt_pk_bf16_f32 v239, v66, v67
    v_cvt_pk_bf16_f32 v240, v68, v69
    v_cvt_pk_bf16_f32 v241, v70, v71
    v_cvt_pk_bf16_f32 v242, v72, v73
    v_cvt_pk_bf16_f32 v243, v74, v75
    v_min_u32 v239, -2, v239
    v_min_u32 v243, -2, v243
    s_cmp_lg_u32 s66, 0
    s_cbranch_scc1 L_wt_65
    buffer_store_dwordx4 v[236:239], v248, s[8:11], s55 offen offset:0
    buffer_store_dwordx4 v[240:243], v248, s[8:11], s55 offen offset:512
L_wb_66:
    s_barrier
    s_waitcnt lgkmcnt(0)
    v_pk_fma_f32 v[28:29], v[140:141], v[128:129], v[28:29] op_sel_hi:[1,0,1]
    v_pk_fma_f32 v[30:31], v[142:143], v[128:129], v[30:31] op_sel_hi:[1,0,1]
    v_pk_fma_f32 v[32:33], v[144:145], v[128:129], v[32:33] op_sel_hi:[1,0,1]
    v_pk_fma_f32 v[34:35], v[146:147], v[128:129], v[34:35] op_sel_hi:[1,0,1]
    v_pk_fma_f32 v[36:37], v[148:149], v[128:129], v[36:37] op_sel_hi:[1,0,1]
    v_pk_fma_f32 v[38:39], v[150:151], v[128:129], v[38:39] op_sel_hi:[1,0,1]
    v_pk_fma_f32 v[40:41], v[152:153], v[128:129], v[40:41] op_sel_hi:[1,0,1]
    v_pk_fma_f32 v[42:43], v[154:155], v[128:129], v[42:43] op_sel_hi:[1,0,1]
    v_pk_mul_f32 v[28:29], v[28:29], v[132:133] op_sel_hi:[1,0]
    v_pk_mul_f32 v[30:31], v[30:31], v[132:133] op_sel_hi:[1,0]
    v_pk_mul_f32 v[32:33], v[32:33], v[132:133] op_sel_hi:[1,0]
    v_pk_mul_f32 v[34:35], v[34:35], v[132:133] op_sel_hi:[1,0]
    v_pk_mul_f32 v[36:37], v[36:37], v[132:133] op_sel_hi:[1,0]
    v_pk_mul_f32 v[38:39], v[38:39], v[132:133] op_sel_hi:[1,0]
    v_pk_mul_f32 v[40:41], v[40:41], v[132:133] op_sel_hi:[1,0]
    v_pk_mul_f32 v[42:43], v[42:43], v[132:133] op_sel_hi:[1,0]
    v_cvt_pk_bf16_f32 v220, v28, v29
    v_cvt_pk_bf16_f32 v221, v30, v31
    v_cvt_pk_bf16_f32 v222, v32, v33
    v_cvt_pk_bf16_f32 v223, v34, v35
    v_cvt_pk_bf16_f32 v224, v36, v37
    v_cvt_pk_bf16_f32 v225, v38, v39
    v_cvt_pk_bf16_f32 v226, v40, v41
    v_cvt_pk_bf16_f32 v227, v42, v43
    v_min_u32 v223, -2, v223
    v_min_u32 v227, -2, v227
    s_cmp_lg_u32 s66, 0
    s_cbranch_scc1 L_wt_67
    buffer_store_dwordx4 v[220:223], v1, s[8:11], s51 offen
    buffer_store_dwordx4 v[224:227], v1, s[8:11], s52 offen
L_wb_68:
    s_and_b32 s48, s46, 1
    s_lshl1_add_u32 s48, s45, s48
    s_bfe_u32 s49, s46, 0x10001
    s_lshl1_add_u32 s48, s48, s49
    s_lshr_b32 s49, s46, 2
    s_lshl_b32 s50, s49, 3
    s_lshl_b32 s53, s44, 1
    s_add_u32 s50, s50, s53
    s_lshl_b32 s54, s48, 16
    s_lshl_b32 s55, s50, 10
    s_add_u32 s54, s54, s55
    s_add_u32 s54, s54, 1048576
    buffer_load_dwordx4 v[24:27], v1, s[8:11], s54 offen sc1
    buffer_load_dwordx4 v[28:31], v1, s[8:11], s54 offen offset:1024 sc1
    s_lshl_b32 s60, s45, 2
    s_and_b32 s55, s46, 3
    s_add_u32 s60, s60, s55
    s_lshl_b32 s60, s60, 1
    s_and_b32 s55, s44, 1
    s_add_u32 s60, s60, s55
    s_lshr_b32 s61, s44, 1
    s_lshr_b32 s62, s46, 2
    s_lshl_b32 s62, s62, 1
    s_add_u32 s62, s62, s61
    v_and_b32 v23, 31, v0
    v_lshlrev_b32 v5, 10, v23
    v_lshrrev_b32 v23, 5, v0
    v_lshl_add_u32 v5, v23, 3, v5
    s_lshl_b32 s55, s60, 15
    s_lshl_b32 s56, s62, 6
    s_add_u32 s55, s55, s56
    v_mov_b32 v16, 0xdddddddd
    v_and_b32 v17, 15, v0
    v_lshlrev_b32 v17, 4, v17
    v_lshl_add_u32 v17, v23, 8, v17
    v_and_b32 v23, 16, v0
    v_cmp_eq_u32 vcc, 0, v23
    v_and_b32 v22, 0x1b, v0
    v_cmp_eq_u32 s[56:57], 16, v22
    v_mov_b32 v22, 512
    v_mov_b32 v23, 528
    v_cndmask_b32 v23, v23, v22, s[56:57]
    v_mov_b32 v64, 0
    v_mov_b32 v80, 0
    v_mov_b32 v148, 0
    v_mov_b32 v65, 0
    v_mov_b32 v81, 0
    v_mov_b32 v149, 0
    v_mov_b32 v66, 0
    v_mov_b32 v82, 0
    v_mov_b32 v150, 0
    v_mov_b32 v67, 0
    v_mov_b32 v83, 0
    v_mov_b32 v151, 0
    v_mov_b32 v68, 0
    v_mov_b32 v84, 0
    v_mov_b32 v69, 0
    v_mov_b32 v85, 0
    v_mov_b32 v70, 0
    v_mov_b32 v86, 0
    v_mov_b32 v71, 0
    v_mov_b32 v87, 0
    v_mov_b32 v72, 0
    v_mov_b32 v88, 0
    v_mov_b32 v120, 0
    v_mov_b32 v73, 0
    v_mov_b32 v89, 0
    v_mov_b32 v121, 0
    v_mov_b32 v74, 0
    v_mov_b32 v90, 0
    v_mov_b32 v122, 0
    v_mov_b32 v75, 0
    v_mov_b32 v91, 0
    v_mov_b32 v123, 0
    v_mov_b32 v76, 0
    v_mov_b32 v92, 0
    v_mov_b32 v124, 0
    v_mov_b32 v77, 0
    v_mov_b32 v93, 0
    v_mov_b32 v125, 0
    v_mov_b32 v78, 0
    v_mov_b32 v94, 0
    v_mov_b32 v126, 0
    v_mov_b32 v79, 0
    v_mov_b32 v95, 0
    v_mov_b32 v127, 0
    v_cndmask_b32 v17, v23, v17, vcc
    v_add_u32 v20, 32896, v17
    v_add_u32 v21, 49792, v17
    s_mov_b32 s51, 49792
    s_mov_b32 s52, 0
    v_add_u32 v18, 32896, v1
    v_add_u32 v19, 49792, v1
    s_waitcnt vmcnt(0)
    v_max_u32 v4, v27, v31
    v_cmp_eq_u32 vcc, -1, v4
    s_cbranch_vccnz L_slow_69
L_back_70:
    s_barrier
    ds_read_b128 v[128:131], v18 offset:1088
    ds_read_b128 v[136:139], v20
    ds_read_b128 v[140:143], v20 offset:544
    ds_read_b128 v[132:135], v18 offset:3200
    s_waitcnt lgkmcnt(3)
    v_mfma_f32_32x32x16_bf16 v[32:47], v[128:131], v[24:27], 0
    v_mfma_f32_32x32x16_bf16 v[48:63], v[128:131], v[28:31], 0
    buffer_load_dwordx2 v[8:9], v5, s[12:15], s55 offen offset:0
    buffer_load_dwordx2 v[10:11], v5, s[12:15], s55 offen offset:16
    buffer_load_dwordx2 v[12:13], v5, s[12:15], s55 offen offset:32
    buffer_load_dwordx2 v[14:15], v5, s[12:15], s55 offen offset:48
    s_nop 7
    s_nop 2
    v_max3_f32 v22, v32, v33, v34
    v_max3_f32 v23, v35, v36, v37
    v_max3_f32 v22, v38, v39, v22
    v_max3_f32 v23, v40, v41, v23
    v_max3_f32 v22, v42, v43, v22
    v_max3_f32 v23, v44, v45, v23
    v_max3_f32 v22, v46, v47, v22
    v_max_f32 v22, v22, v23
    v_mov_b32 v23, v22
    s_nop 1
    v_permlane32_swap_b32 v22, v23
    s_nop 1
    v_max_f32 v22, v22, v23
    v_sub_f32 v22, 0, v22
    v_mov_b32 v32, v22
    v_mov_b32 v33, v22
    v_mov_b32 v34, v22
    v_mov_b32 v35, v22
    v_mov_b32 v36, v22
    v_mov_b32 v37, v22
    v_mov_b32 v38, v22
    v_mov_b32 v39, v22
    v_mov_b32 v40, v22
    v_mov_b32 v41, v22
    v_mov_b32 v42, v22
    v_mov_b32 v43, v22
    v_mov_b32 v44, v22
    v_mov_b32 v45, v22
    v_mov_b32 v46, v22
    v_mov_b32 v47, v22
    s_nop 1
    v_mfma_f32_32x32x16_bf16 v[96:111], v[128:131], v[24:27], v[32:47]
    v_max3_f32 v22, v48, v49, v50
    v_max3_f32 v23, v51, v52, v53
    v_max3_f32 v22, v54, v55, v22
    v_max3_f32 v23, v56, v57, v23
    v_max3_f32 v22, v58, v59, v22
    v_max3_f32 v23, v60, v61, v23
    v_max3_f32 v22, v62, v63, v22
    v_max_f32 v22, v22, v23
    v_mov_b32 v23, v22
    s_nop 1
    v_permlane32_swap_b32 v22, v23
    s_nop 1
    v_max_f32 v22, v22, v23
    v_sub_f32 v22, 0, v22
    v_mov_b32 v48, v22
    v_mov_b32 v49, v22
    v_mov_b32 v50, v22
    v_mov_b32 v51, v22
    v_mov_b32 v52, v22
    v_mov_b32 v53, v22
    v_mov_b32 v54, v22
    v_mov_b32 v55, v22
    v_mov_b32 v56, v22
    v_mov_b32 v57, v22
    v_mov_b32 v58, v22
    v_mov_b32 v59, v22
    v_mov_b32 v60, v22
    v_mov_b32 v61, v22
    v_mov_b32 v62, v22
    v_mov_b32 v63, v22
.p2align 6
L_attn:
    v_exp_f32 v96, v96
    v_exp_f32 v97, v97
    v_smfmac_f32_32x32x32_bf16 v[80:95], v[148:151], v[120:127], v16
    ds_read_b128 v[144:147], v20 offset:2112
    v_exp_f32 v98, v98
    v_exp_f32 v99, v99
    v_exp_f32 v100, v100
    v_exp_f32 v101, v101
    v_exp_f32 v102, v102
    v_mfma_f32_32x32x16_bf16 v[112:127], v[128:131], v[28:31], v[48:63]
    ds_read_b128 v[148:151], v20 offset:2656
    v_exp_f32 v103, v103
    v_exp_f32 v104, v104
    v_exp_f32 v105, v105
    v_exp_f32 v106, v106
    v_exp_f32 v107, v107
    s_waitcnt lgkmcnt(2)
    v_smfmac_f32_32x32x32_bf16 v[64:79], v[136:139], v[96:103], v16
    ds_read_b128 v[128:131], v18 offset:5312
    v_exp_f32 v108, v108
    v_exp_f32 v109, v109
    v_exp_f32 v110, v110
    v_exp_f32 v111, v111
    v_exp_f32 v112, v112
    v_exp_f32 v113, v113
    v_smfmac_f32_32x32x32_bf16 v[64:79], v[140:143], v[104:111], v16
    v_exp_f32 v114, v114
    v_exp_f32 v115, v115
    v_exp_f32 v116, v116
    v_exp_f32 v117, v117
    v_exp_f32 v118, v118
    v_mfma_f32_32x32x16_bf16 v[96:111], v[132:135], v[24:27], v[32:47]
    v_exp_f32 v119, v119
    v_exp_f32 v120, v120
    v_exp_f32 v121, v121
    v_exp_f32 v122, v122
    v_exp_f32 v123, v123
    v_smfmac_f32_32x32x32_bf16 v[80:95], v[136:139], v[112:119], v16
    v_exp_f32 v124, v124
    v_exp_f32 v125, v125
    v_exp_f32 v126, v126
    v_exp_f32 v127, v127
    v_exp_f32 v96, v96
    v_exp_f32 v97, v97
    v_smfmac_f32_32x32x32_bf16 v[80:95], v[140:143], v[120:127], v16
    ds_read_b128 v[136:139], v20 offset:4224
    v_exp_f32 v98, v98
    v_exp_f32 v99, v99
    v_exp_f32 v100, v100
    v_exp_f32 v101, v101
    v_exp_f32 v102, v102
    v_mfma_f32_32x32x16_bf16 v[112:127], v[132:135], v[28:31], v[48:63]
    ds_read_b128 v[140:143], v20 offset:4768
    v_exp_f32 v103, v103
    v_exp_f32 v104, v104
    v_exp_f32 v105, v105
    v_exp_f32 v106, v106
    v_exp_f32 v107, v107
    s_waitcnt lgkmcnt(2)
    v_smfmac_f32_32x32x32_bf16 v[64:79], v[144:147], v[96:103], v16
    ds_read_b128 v[132:135], v18 offset:7424
    v_exp_f32 v108, v108
    v_exp_f32 v109, v109
    v_exp_f32 v110, v110
    v_exp_f32 v111, v111
    v_exp_f32 v112, v112
    v_exp_f32 v113, v113
    v_smfmac_f32_32x32x32_bf16 v[64:79], v[148:151], v[104:111], v16
    v_exp_f32 v114, v114
    v_exp_f32 v115, v115
    v_exp_f32 v116, v116
    v_exp_f32 v117, v117
    v_exp_f32 v118, v118
    v_mfma_f32_32x32x16_bf16 v[96:111], v[128:131], v[24:27], v[32:47]
    v_exp_f32 v119, v119
    v_exp_f32 v120, v120
    v_exp_f32 v121, v121
    v_exp_f32 v122, v122
    v_exp_f32 v123, v123
    v_smfmac_f32_32x32x32_bf16 v[80:95], v[144:147], v[112:119], v16
    v_exp_f32 v124, v124
    v_exp_f32 v125, v125
    v_exp_f32 v126, v126
    v_exp_f32 v127, v127
    v_exp_f32 v96, v96
    v_exp_f32 v97, v97
    v_smfmac_f32_32x32x32_bf16 v[80:95], v[148:151], v[120:127], v16
    ds_read_b128 v[144:147], v20 offset:6336
    v_exp_f32 v98, v98
    v_exp_f32 v99, v99
    v_exp_f32 v100, v100
    v_exp_f32 v101, v101
    v_exp_f32 v102, v102
    v_mfma_f32_32x32x16_bf16 v[112:127], v[128:131], v[28:31], v[48:63]
    ds_read_b128 v[148:151], v20 offset:6880
    v_exp_f32 v103, v103
    v_exp_f32 v104, v104
    v_exp_f32 v105, v105
    v_exp_f32 v106, v106
    v_exp_f32 v107, v107
    s_waitcnt lgkmcnt(2)
    v_smfmac_f32_32x32x32_bf16 v[64:79], v[136:139], v[96:103], v16
    ds_read_b128 v[128:131], v18 offset:9536
    v_exp_f32 v108, v108
    v_exp_f32 v109, v109
    v_exp_f32 v110, v110
    v_exp_f32 v111, v111
    v_exp_f32 v112, v112
    v_exp_f32 v113, v113
    v_smfmac_f32_32x32x32_bf16 v[64:79], v[140:143], v[104:111], v16
    v_exp_f32 v114, v114
    v_exp_f32 v115, v115
    v_exp_f32 v116, v116
    v_exp_f32 v117, v117
    v_exp_f32 v118, v118
    v_mfma_f32_32x32x16_bf16 v[96:111], v[132:135], v[24:27], v[32:47]
    v_exp_f32 v119, v119
    v_exp_f32 v120, v120
    v_exp_f32 v121, v121
    v_exp_f32 v122, v122
    v_exp_f32 v123, v123
    v_smfmac_f32_32x32x32_bf16 v[80:95], v[136:139], v[112:119], v16
    v_exp_f32 v124, v124
    v_exp_f32 v125, v125
    v_exp_f32 v126, v126
    v_exp_f32 v127, v127
    v_exp_f32 v96, v96
    v_exp_f32 v97, v97
    v_smfmac_f32_32x32x32_bf16 v[80:95], v[140:143], v[120:127], v16
    ds_read_b128 v[136:139], v20 offset:8448
    v_exp_f32 v98, v98
    v_exp_f32 v99, v99
    v_exp_f32 v100, v100
    v_exp_f32 v101, v101
    v_exp_f32 v102, v102
    v_mfma_f32_32x32x16_bf16 v[112:127], v[132:135], v[28:31], v[48:63]
    ds_read_b128 v[140:143], v20 offset:8992
    v_exp_f32 v103, v103
    v_exp_f32 v104, v104
    v_exp_f32 v105, v105
    v_exp_f32 v106, v106
    v_exp_f32 v107, v107
    s_waitcnt lgkmcnt(2)
    v_smfmac_f32_32x32x32_bf16 v[64:79], v[144:147], v[96:103], v16
    ds_read_b128 v[132:135], v18 offset:11648
    v_exp_f32 v108, v108
    v_exp_f32 v109, v109
    v_exp_f32 v110, v110
    v_exp_f32 v111, v111
    v_exp_f32 v112, v112
    v_exp_f32 v113, v113
    v_smfmac_f32_32x32x32_bf16 v[64:79], v[148:151], v[104:111], v16
    v_exp_f32 v114, v114
    v_exp_f32 v115, v115
    v_exp_f32 v116, v116
    v_exp_f32 v117, v117
    v_exp_f32 v118, v118
    v_mfma_f32_32x32x16_bf16 v[96:111], v[128:131], v[24:27], v[32:47]
    v_exp_f32 v119, v119
    v_exp_f32 v120, v120
    v_exp_f32 v121, v121
    v_exp_f32 v122, v122
    v_exp_f32 v123, v123
    v_smfmac_f32_32x32x32_bf16 v[80:95], v[144:147], v[112:119], v16
    v_exp_f32 v124, v124
    v_exp_f32 v125, v125
    v_exp_f32 v126, v126
    v_exp_f32 v127, v127
    v_exp_f32 v96, v96
    v_exp_f32 v97, v97
    v_smfmac_f32_32x32x32_bf16 v[80:95], v[148:151], v[120:127], v16
    ds_read_b128 v[144:147], v20 offset:10560
    v_exp_f32 v98, v98
    v_exp_f32 v99, v99
    v_exp_f32 v100, v100
    v_exp_f32 v101, v101
    v_exp_f32 v102, v102
    v_mfma_f32_32x32x16_bf16 v[112:127], v[128:131], v[28:31], v[48:63]
    ds_read_b128 v[148:151], v20 offset:11104
    v_exp_f32 v103, v103
    v_exp_f32 v104, v104
    v_exp_f32 v105, v105
    v_exp_f32 v106, v106
    v_exp_f32 v107, v107
    s_waitcnt lgkmcnt(2)
    v_smfmac_f32_32x32x32_bf16 v[64:79], v[136:139], v[96:103], v16
    ds_read_b128 v[128:131], v18 offset:13760
    v_exp_f32 v108, v108
    v_exp_f32 v109, v109
    v_exp_f32 v110, v110
    v_exp_f32 v111, v111
    v_exp_f32 v112, v112
    v_exp_f32 v113, v113
    v_smfmac_f32_32x32x32_bf16 v[64:79], v[140:143], v[104:111], v16
    v_exp_f32 v114, v114
    v_exp_f32 v115, v115
    v_exp_f32 v116, v116
    v_exp_f32 v117, v117
    v_exp_f32 v118, v118
    v_mfma_f32_32x32x16_bf16 v[96:111], v[132:135], v[24:27], v[32:47]
    v_exp_f32 v119, v119
    v_exp_f32 v120, v120
    v_exp_f32 v121, v121
    v_exp_f32 v122, v122
    v_exp_f32 v123, v123
    v_smfmac_f32_32x32x32_bf16 v[80:95], v[136:139], v[112:119], v16
    v_exp_f32 v124, v124
    v_exp_f32 v125, v125
    v_exp_f32 v126, v126
    v_exp_f32 v127, v127
    v_exp_f32 v96, v96
    v_exp_f32 v97, v97
    v_smfmac_f32_32x32x32_bf16 v[80:95], v[140:143], v[120:127], v16
    ds_read_b128 v[136:139], v20 offset:12672
    v_exp_f32 v98, v98
    v_exp_f32 v99, v99
    v_exp_f32 v100, v100
    v_exp_f32 v101, v101
    v_exp_f32 v102, v102
    v_mfma_f32_32x32x16_bf16 v[112:127], v[132:135], v[28:31], v[48:63]
    ds_read_b128 v[140:143], v20 offset:13216
    v_exp_f32 v103, v103
    v_exp_f32 v104, v104
    v_exp_f32 v105, v105
    v_exp_f32 v106, v106
    v_exp_f32 v107, v107
    s_waitcnt lgkmcnt(2)
    v_smfmac_f32_32x32x32_bf16 v[64:79], v[144:147], v[96:103], v16
    ds_read_b128 v[132:135], v18 offset:15872
    v_exp_f32 v108, v108
    v_exp_f32 v109, v109
    v_exp_f32 v110, v110
    v_exp_f32 v111, v111
    v_exp_f32 v112, v112
    v_exp_f32 v113, v113
    v_smfmac_f32_32x32x32_bf16 v[64:79], v[148:151], v[104:111], v16
    v_exp_f32 v114, v114
    v_exp_f32 v115, v115
    v_exp_f32 v116, v116
    v_exp_f32 v117, v117
    v_exp_f32 v118, v118
    v_mfma_f32_32x32x16_bf16 v[96:111], v[128:131], v[24:27], v[32:47]
    v_exp_f32 v119, v119
    v_exp_f32 v120, v120
    v_exp_f32 v121, v121
    v_exp_f32 v122, v122
    v_exp_f32 v123, v123
    v_smfmac_f32_32x32x32_bf16 v[80:95], v[144:147], v[112:119], v16
    v_exp_f32 v124, v124
    v_exp_f32 v125, v125
    v_exp_f32 v126, v126
    v_exp_f32 v127, v127
    v_exp_f32 v96, v96
    v_exp_f32 v97, v97
    v_smfmac_f32_32x32x32_bf16 v[80:95], v[148:151], v[120:127], v16
    ds_read_b128 v[144:147], v20 offset:14784
    v_exp_f32 v98, v98
    v_exp_f32 v99, v99
    v_exp_f32 v100, v100
    v_exp_f32 v101, v101
    v_exp_f32 v102, v102
    v_mfma_f32_32x32x16_bf16 v[112:127], v[128:131], v[28:31], v[48:63]
    ds_read_b128 v[148:151], v20 offset:15328
    v_exp_f32 v103, v103
    v_exp_f32 v104, v104
    v_exp_f32 v105, v105
    v_exp_f32 v106, v106
    v_exp_f32 v107, v107
    s_waitcnt lgkmcnt(2)
    v_smfmac_f32_32x32x32_bf16 v[64:79], v[136:139], v[96:103], v16
    s_barrier
    ds_read_b128 v[128:131], v19 offset:1088
    v_exp_f32 v108, v108
    v_exp_f32 v109, v109
    v_exp_f32 v110, v110
    v_exp_f32 v111, v111
    v_exp_f32 v112, v112
    v_exp_f32 v113, v113
    v_smfmac_f32_32x32x32_bf16 v[64:79], v[140:143], v[104:111], v16
    v_exp_f32 v114, v114
    v_exp_f32 v115, v115
    v_exp_f32 v116, v116
    v_exp_f32 v117, v117
    v_exp_f32 v118, v118
    v_mfma_f32_32x32x16_bf16 v[96:111], v[132:135], v[24:27], v[32:47]
    v_exp_f32 v119, v119
    v_exp_f32 v120, v120
    v_exp_f32 v121, v121
    v_exp_f32 v122, v122
    v_exp_f32 v123, v123
    v_smfmac_f32_32x32x32_bf16 v[80:95], v[136:139], v[112:119], v16
    v_exp_f32 v124, v124
    v_exp_f32 v125, v125
    v_exp_f32 v126, v126
    v_exp_f32 v127, v127
    v_exp_f32 v96, v96
    v_exp_f32 v97, v97
    v_smfmac_f32_32x32x32_bf16 v[80:95], v[140:143], v[120:127], v16
    ds_read_b128 v[136:139], v21 offset:0
    v_exp_f32 v98, v98
    v_exp_f32 v99, v99
    v_exp_f32 v100, v100
    v_exp_f32 v101, v101
    v_exp_f32 v102, v102
    v_mfma_f32_32x32x16_bf16 v[112:127], v[132:135], v[28:31], v[48:63]
    ds_read_b128 v[140:143], v21 offset:544
    v_exp_f32 v103, v103
    v_exp_f32 v104, v104
    v_exp_f32 v105, v105
    v_exp_f32 v106, v106
    v_exp_f32 v107, v107
    s_waitcnt lgkmcnt(2)
    v_smfmac_f32_32x32x32_bf16 v[64:79], v[144:147], v[96:103], v16
    ds_read_b128 v[132:135], v19 offset:3200
    v_exp_f32 v108, v108
    v_exp_f32 v109, v109
    v_exp_f32 v110, v110
    v_exp_f32 v111, v111
    v_exp_f32 v112, v112
    v_exp_f32 v113, v113
    v_smfmac_f32_32x32x32_bf16 v[64:79], v[148:151], v[104:111], v16
    s_add_u32 s51, s51, 16896
    s_cmp_eq_u32 s51, 83584
    s_cselect_b32 s51, 32896, s51
    v_exp_f32 v114, v114
    v_exp_f32 v115, v115
    v_exp_f32 v116, v116
    v_exp_f32 v117, v117
    v_exp_f32 v118, v118
    v_mfma_f32_32x32x16_bf16 v[96:111], v[128:131], v[24:27], v[32:47]
    v_add_u32 v18, s51, v1
    v_add_u32 v20, s51, v17
    v_exp_f32 v119, v119
    v_exp_f32 v120, v120
    v_exp_f32 v121, v121
    v_exp_f32 v122, v122
    v_exp_f32 v123, v123
    v_smfmac_f32_32x32x32_bf16 v[80:95], v[144:147], v[112:119], v16
    v_exp_f32 v124, v124
    v_exp_f32 v125, v125
    v_exp_f32 v126, v126
    v_exp_f32 v127, v127
    v_exp_f32 v96, v96
    v_exp_f32 v97, v97
    v_smfmac_f32_32x32x32_bf16 v[80:95], v[148:151], v[120:127], v16
    ds_read_b128 v[144:147], v21 offset:2112
    v_exp_f32 v98, v98
    v_exp_f32 v99, v99
    v_exp_f32 v100, v100
    v_exp_f32 v101, v101
    v_exp_f32 v102, v102
    v_mfma_f32_32x32x16_bf16 v[112:127], v[128:131], v[28:31], v[48:63]
    ds_read_b128 v[148:151], v21 offset:2656
    v_exp_f32 v103, v103
    v_exp_f32 v104, v104
    v_exp_f32 v105, v105
    v_exp_f32 v106, v106
    v_exp_f32 v107, v107
    s_waitcnt lgkmcnt(2)
    v_smfmac_f32_32x32x32_bf16 v[64:79], v[136:139], v[96:103], v16
    ds_read_b128 v[128:131], v19 offset:5312
    v_exp_f32 v108, v108
    v_exp_f32 v109, v109
    v_exp_f32 v110, v110
    v_exp_f32 v111, v111
    v_exp_f32 v112, v112
    v_exp_f32 v113, v113
    v_smfmac_f32_32x32x32_bf16 v[64:79], v[140:143], v[104:111], v16
    v_exp_f32 v114, v114
    v_exp_f32 v115, v115
    v_exp_f32 v116, v116
    v_exp_f32 v117, v117
    v_exp_f32 v118, v118
    v_mfma_f32_32x32x16_bf16 v[96:111], v[132:135], v[24:27], v[32:47]
    v_exp_f32 v119, v119
    v_exp_f32 v120, v120
    v_exp_f32 v121, v121
    v_exp_f32 v122, v122
    v_exp_f32 v123, v123
    v_smfmac_f32_32x32x32_bf16 v[80:95], v[136:139], v[112:119], v16
    v_exp_f32 v124, v124
    v_exp_f32 v125, v125
    v_exp_f32 v126, v126
    v_exp_f32 v127, v127
    v_exp_f32 v96, v96
    v_exp_f32 v97, v97
    v_smfmac_f32_32x32x32_bf16 v[80:95], v[140:143], v[120:127], v16
    ds_read_b128 v[136:139], v21 offset:4224
    v_exp_f32 v98, v98
    v_exp_f32 v99, v99
    v_exp_f32 v100, v100
    v_exp_f32 v101, v101
    v_exp_f32 v102, v102
    v_mfma_f32_32x32x16_bf16 v[112:127], v[132:135], v[28:31], v[48:63]
    ds_read_b128 v[140:143], v21 offset:4768
    v_exp_f32 v103, v103
    v_exp_f32 v104, v104
    v_exp_f32 v105, v105
    v_exp_f32 v106, v106
    v_exp_f32 v107, v107
    s_waitcnt lgkmcnt(2)
    v_smfmac_f32_32x32x32_bf16 v[64:79], v[144:147], v[96:103], v16
    ds_read_b128 v[132:135], v19 offset:7424
    v_exp_f32 v108, v108
    v_exp_f32 v109, v109
    v_exp_f32 v110, v110
    v_exp_f32 v111, v111
    v_exp_f32 v112, v112
    v_exp_f32 v113, v113
    v_smfmac_f32_32x32x32_bf16 v[64:79], v[148:151], v[104:111], v16
    v_exp_f32 v114, v114
    v_exp_f32 v115, v115
    v_exp_f32 v116, v116
    v_exp_f32 v117, v117
    v_exp_f32 v118, v118
    v_mfma_f32_32x32x16_bf16 v[96:111], v[128:131], v[24:27], v[32:47]
    v_exp_f32 v119, v119
    v_exp_f32 v120, v120
    v_exp_f32 v121, v121
    v_exp_f32 v122, v122
    v_exp_f32 v123, v123
    v_smfmac_f32_32x32x32_bf16 v[80:95], v[144:147], v[112:119], v16
    v_exp_f32 v124, v124
    v_exp_f32 v125, v125
    v_exp_f32 v126, v126
    v_exp_f32 v127, v127
    v_exp_f32 v96, v96
    v_exp_f32 v97, v97
    v_smfmac_f32_32x32x32_bf16 v[80:95], v[148:151], v[120:127], v16
    ds_read_b128 v[144:147], v21 offset:6336
    v_exp_f32 v98, v98
    v_exp_f32 v99, v99
    v_exp_f32 v100, v100
    v_exp_f32 v101, v101
    v_exp_f32 v102, v102
    v_mfma_f32_32x32x16_bf16 v[112:127], v[128:131], v[28:31], v[48:63]
    ds_read_b128 v[148:151], v21 offset:6880
    v_exp_f32 v103, v103
    v_exp_f32 v104, v104
    v_exp_f32 v105, v105
    v_exp_f32 v106, v106
    v_exp_f32 v107, v107
    s_waitcnt lgkmcnt(2)
    v_smfmac_f32_32x32x32_bf16 v[64:79], v[136:139], v[96:103], v16
    ds_read_b128 v[128:131], v19 offset:9536
    v_exp_f32 v108, v108
    v_exp_f32 v109, v109
    v_exp_f32 v110, v110
    v_exp_f32 v111, v111
    v_exp_f32 v112, v112
    v_exp_f32 v113, v113
    v_smfmac_f32_32x32x32_bf16 v[64:79], v[140:143], v[104:111], v16
    v_exp_f32 v114, v114
    v_exp_f32 v115, v115
    v_exp_f32 v116, v116
    v_exp_f32 v117, v117
    v_exp_f32 v118, v118
    v_mfma_f32_32x32x16_bf16 v[96:111], v[132:135], v[24:27], v[32:47]
    v_exp_f32 v119, v119
    v_exp_f32 v120, v120
    v_exp_f32 v121, v121
    v_exp_f32 v122, v122
    v_exp_f32 v123, v123
    v_smfmac_f32_32x32x32_bf16 v[80:95], v[136:139], v[112:119], v16
    v_exp_f32 v124, v124
    v_exp_f32 v125, v125
    v_exp_f32 v126, v126
    v_exp_f32 v127, v127
    v_exp_f32 v96, v96
    v_exp_f32 v97, v97
    v_smfmac_f32_32x32x32_bf16 v[80:95], v[140:143], v[120:127], v16
    ds_read_b128 v[136:139], v21 offset:8448
    v_exp_f32 v98, v98
    v_exp_f32 v99, v99
    v_exp_f32 v100, v100
    v_exp_f32 v101, v101
    v_exp_f32 v102, v102
    v_mfma_f32_32x32x16_bf16 v[112:127], v[132:135], v[28:31], v[48:63]
    ds_read_b128 v[140:143], v21 offset:8992
    v_exp_f32 v103, v103
    v_exp_f32 v104, v104
    v_exp_f32 v105, v105
    v_exp_f32 v106, v106
    v_exp_f32 v107, v107
    s_waitcnt lgkmcnt(2)
    v_smfmac_f32_32x32x32_bf16 v[64:79], v[144:147], v[96:103], v16
    ds_read_b128 v[132:135], v19 offset:11648
    v_exp_f32 v108, v108
    v_exp_f32 v109, v109
    v_exp_f32 v110, v110
    v_exp_f32 v111, v111
    v_exp_f32 v112, v112
    v_exp_f32 v113, v113
    v_smfmac_f32_32x32x32_bf16 v[64:79], v[148:151], v[104:111], v16
    v_exp_f32 v114, v114
    v_exp_f32 v115, v115
    v_exp_f32 v116, v116
    v_exp_f32 v117, v117
    v_exp_f32 v118, v118
    v_mfma_f32_32x32x16_bf16 v[96:111], v[128:131], v[24:27], v[32:47]
    v_exp_f32 v119, v119
    v_exp_f32 v120, v120
    v_exp_f32 v121, v121
    v_exp_f32 v122, v122
    v_exp_f32 v123, v123
    v_smfmac_f32_32x32x32_bf16 v[80:95], v[144:147], v[112:119], v16
    v_exp_f32 v124, v124
    v_exp_f32 v125, v125
    v_exp_f32 v126, v126
    v_exp_f32 v127, v127
    v_exp_f32 v96, v96
    v_exp_f32 v97, v97
    v_smfmac_f32_32x32x32_bf16 v[80:95], v[148:151], v[120:127], v16
    ds_read_b128 v[144:147], v21 offset:10560
    v_exp_f32 v98, v98
    v_exp_f32 v99, v99
    v_exp_f32 v100, v100
    v_exp_f32 v101, v101
    v_exp_f32 v102, v102
    v_mfma_f32_32x32x16_bf16 v[112:127], v[128:131], v[28:31], v[48:63]
    ds_read_b128 v[148:151], v21 offset:11104
    v_exp_f32 v103, v103
    v_exp_f32 v104, v104
    v_exp_f32 v105, v105
    v_exp_f32 v106, v106
    v_exp_f32 v107, v107
    s_waitcnt lgkmcnt(2)
    v_smfmac_f32_32x32x32_bf16 v[64:79], v[136:139], v[96:103], v16
    ds_read_b128 v[128:131], v19 offset:13760
    v_exp_f32 v108, v108
    v_exp_f32 v109, v109
    v_exp_f32 v110, v110
    v_exp_f32 v111, v111
    v_exp_f32 v112, v112
    v_exp_f32 v113, v113
    v_smfmac_f32_32x32x32_bf16 v[64:79], v[140:143], v[104:111], v16
    v_exp_f32 v114, v114
    v_exp_f32 v115, v115
    v_exp_f32 v116, v116
    v_exp_f32 v117, v117
    v_exp_f32 v118, v118
    v_mfma_f32_32x32x16_bf16 v[96:111], v[132:135], v[24:27], v[32:47]
    v_exp_f32 v119, v119
    v_exp_f32 v120, v120
    v_exp_f32 v121, v121
    v_exp_f32 v122, v122
    v_exp_f32 v123, v123
    v_smfmac_f32_32x32x32_bf16 v[80:95], v[136:139], v[112:119], v16
    v_exp_f32 v124, v124
    v_exp_f32 v125, v125
    v_exp_f32 v126, v126
    v_exp_f32 v127, v127
    v_exp_f32 v96, v96
    v_exp_f32 v97, v97
    v_smfmac_f32_32x32x32_bf16 v[80:95], v[140:143], v[120:127], v16
    ds_read_b128 v[136:139], v21 offset:12672
    v_exp_f32 v98, v98
    v_exp_f32 v99, v99
    v_exp_f32 v100, v100
    v_exp_f32 v101, v101
    v_exp_f32 v102, v102
    v_mfma_f32_32x32x16_bf16 v[112:127], v[132:135], v[28:31], v[48:63]
    ds_read_b128 v[140:143], v21 offset:13216
    v_exp_f32 v103, v103
    v_exp_f32 v104, v104
    v_exp_f32 v105, v105
    v_exp_f32 v106, v106
    v_exp_f32 v107, v107
    s_waitcnt lgkmcnt(2)
    v_smfmac_f32_32x32x32_bf16 v[64:79], v[144:147], v[96:103], v16
    ds_read_b128 v[132:135], v19 offset:15872
    v_exp_f32 v108, v108
    v_exp_f32 v109, v109
    v_exp_f32 v110, v110
    v_exp_f32 v111, v111
    v_exp_f32 v112, v112
    v_exp_f32 v113, v113
    v_smfmac_f32_32x32x32_bf16 v[64:79], v[148:151], v[104:111], v16
    v_exp_f32 v114, v114
    v_exp_f32 v115, v115
    v_exp_f32 v116, v116
    v_exp_f32 v117, v117
    v_exp_f32 v118, v118
    v_mfma_f32_32x32x16_bf16 v[96:111], v[128:131], v[24:27], v[32:47]
    v_exp_f32 v119, v119
    v_exp_f32 v120, v120
    v_exp_f32 v121, v121
    v_exp_f32 v122, v122
    v_exp_f32 v123, v123
    v_smfmac_f32_32x32x32_bf16 v[80:95], v[144:147], v[112:119], v16
    v_exp_f32 v124, v124
    v_exp_f32 v125, v125
    v_exp_f32 v126, v126
    v_exp_f32 v127, v127
    v_exp_f32 v96, v96
    v_exp_f32 v97, v97
    v_smfmac_f32_32x32x32_bf16 v[80:95], v[148:151], v[120:127], v16
    ds_read_b128 v[144:147], v21 offset:14784
    v_exp_f32 v98, v98
    v_exp_f32 v99, v99
    v_exp_f32 v100, v100
    v_exp_f32 v101, v101
    v_exp_f32 v102, v102
    v_mfma_f32_32x32x16_bf16 v[112:127], v[128:131], v[28:31], v[48:63]
    ds_read_b128 v[148:151], v21 offset:15328
    v_exp_f32 v103, v103
    v_exp_f32 v104, v104
    v_exp_f32 v105, v105
    v_exp_f32 v106, v106
    v_exp_f32 v107, v107
    s_waitcnt lgkmcnt(2)
    v_smfmac_f32_32x32x32_bf16 v[64:79], v[136:139], v[96:103], v16
    s_barrier
    ds_read_b128 v[128:131], v18 offset:1088
    v_exp_f32 v108, v108
    v_exp_f32 v109, v109
    v_exp_f32 v110, v110
    v_exp_f32 v111, v111
    v_exp_f32 v112, v112
    v_exp_f32 v113, v113
    v_smfmac_f32_32x32x32_bf16 v[64:79], v[140:143], v[104:111], v16
    v_exp_f32 v114, v114
    v_exp_f32 v115, v115
    v_exp_f32 v116, v116
    v_exp_f32 v117, v117
    v_exp_f32 v118, v118
    v_mfma_f32_32x32x16_bf16 v[96:111], v[132:135], v[24:27], v[32:47]
    v_exp_f32 v119, v119
    v_exp_f32 v120, v120
    v_exp_f32 v121, v121
    v_exp_f32 v122, v122
    v_exp_f32 v123, v123
    v_smfmac_f32_32x32x32_bf16 v[80:95], v[136:139], v[112:119], v16
    v_exp_f32 v124, v124
    v_exp_f32 v125, v125
    v_exp_f32 v126, v126
    v_exp_f32 v127, v127
    v_exp_f32 v96, v96
    v_exp_f32 v97, v97
    v_smfmac_f32_32x32x32_bf16 v[80:95], v[140:143], v[120:127], v16
    ds_read_b128 v[136:139], v20 offset:0
    v_exp_f32 v98, v98
    v_exp_f32 v99, v99
    v_exp_f32 v100, v100
    v_exp_f32 v101, v101
    v_exp_f32 v102, v102
    v_mfma_f32_32x32x16_bf16 v[112:127], v[132:135], v[28:31], v[48:63]
    ds_read_b128 v[140:143], v20 offset:544
    v_exp_f32 v103, v103
    v_exp_f32 v104, v104
    v_exp_f32 v105, v105
    v_exp_f32 v106, v106
    v_exp_f32 v107, v107
    s_waitcnt lgkmcnt(2)
    v_smfmac_f32_32x32x32_bf16 v[64:79], v[144:147], v[96:103], v16
    ds_read_b128 v[132:135], v18 offset:3200
    v_exp_f32 v108, v108
    v_exp_f32 v109, v109
    v_exp_f32 v110, v110
    v_exp_f32 v111, v111
    v_exp_f32 v112, v112
    v_exp_f32 v113, v113
    v_smfmac_f32_32x32x32_bf16 v[64:79], v[148:151], v[104:111], v16
    s_add_u32 s51, s51, 16896
    s_cmp_eq_u32 s51, 83584
    s_cselect_b32 s51, 32896, s51
    v_exp_f32 v114, v114
    v_exp_f32 v115, v115
    v_exp_f32 v116, v116
    v_exp_f32 v117, v117
    v_exp_f32 v118, v118
    v_mfma_f32_32x32x16_bf16 v[96:111], v[128:131], v[24:27], v[32:47]
    v_add_u32 v19, s51, v1
    v_add_u32 v21, s51, v17
    v_exp_f32 v119, v119
    v_exp_f32 v120, v120
    v_exp_f32 v121, v121
    v_exp_f32 v122, v122
    v_exp_f32 v123, v123
    v_smfmac_f32_32x32x32_bf16 v[80:95], v[144:147], v[112:119], v16
    s_add_u32 s52, s52, 1
    s_cmp_lt_u32 s52, 4
    v_exp_f32 v124, v124
    v_exp_f32 v125, v125
    v_exp_f32 v126, v126
    v_exp_f32 v127, v127
    s_cbranch_scc1 L_attn
    s_nop 1
    v_smfmac_f32_32x32x32_bf16 v[80:95], v[148:151], v[120:127], v16
    s_waitcnt lgkmcnt(0)
    s_barrier
    s_lshl_b32 s53, s50, 15
    s_lshl_b32 s54, s48, 10
    s_add_u32 s53, s53, s54
    s_add_u32 s53, s53, 7340032
    s_add_u32 s55, s53, 0x8000
    v_mov_b32 v22, 0x4e800000
    v_cmp_nge_f32 vcc, v22, v72
    s_cbranch_vccnz L_fb_a
L_fz_a:
    v_rcp_f32 v18, v72
    s_nop 0
    v_pk_mul_f32 v[64:65], v[64:65], v[18:19] op_sel_hi:[1,0]
    v_pk_mul_f32 v[66:67], v[66:67], v[18:19] op_sel_hi:[1,0]
    v_pk_mul_f32 v[68:69], v[68:69], v[18:19] op_sel_hi:[1,0]
    v_pk_mul_f32 v[70:71], v[70:71], v[18:19] op_sel_hi:[1,0]
    v_cvt_pk_bf16_f32 v76, v64, v65
    v_cvt_pk_bf16_f32 v77, v66, v67
    v_cvt_pk_bf16_f32 v78, v68, v69
    v_cvt_pk_bf16_f32 v79, v70, v71
    v_min_u32 v79, -2, v79
    buffer_store_dwordx4 v[76:79], v1, s[8:11], s53 offen sc1
    v_cmp_nge_f32 vcc, v22, v88
    s_cbranch_vccnz L_fb_b
L_fz_b:
    v_rcp_f32 v18, v88
    s_nop 0
    v_pk_mul_f32 v[80:81], v[80:81], v[18:19] op_sel_hi:[1,0]
    v_pk_mul_f32 v[82:83], v[82:83], v[18:19] op_sel_hi:[1,0]
    v_pk_mul_f32 v[84:85], v[84:85], v[18:19] op_sel_hi:[1,0]
    v_pk_mul_f32 v[86:87], v[86:87], v[18:19] op_sel_hi:[1,0]
    v_cvt_pk_bf16_f32 v92, v80, v81
    v_cvt_pk_bf16_f32 v93, v82, v83
    v_cvt_pk_bf16_f32 v94, v84, v85
    v_cvt_pk_bf16_f32 v95, v86, v87
    v_min_u32 v95, -2, v95
    buffer_store_dwordx4 v[92:95], v1, s[8:11], s55 offen sc1
    s_lshl_b32 s48, s60, 15
    s_lshl_b32 s49, s61, 10
    s_add_u32 s48, s48, s49
    s_add_u32 s48, s48, 7340032
    v_lshrrev_b32 v16, 5, v0
    v_lshlrev_b32 v16, 2, v16
    v_bfe_u32 v17, v0, 2, 2
    v_add_u32 v16, v16, v17
    v_lshlrev_b32 v16, 7, v16
    v_bfe_u32 v17, v0, 4, 1
    v_lshl_add_u32 v16, v17, 5, v16
    v_and_b32 v17, 3, v0
    v_lshl_add_u32 v16, v17, 3, v16
    v_bfe_u32 v17, v0, 3, 1
    v_xor_b32 v17, s61, v17
    v_lshl_add_u32 v16, v17, 6, v16
    v_xor_b32 v17, 64, v16
    s_lshl_b32 s59, s61, 11
    s_add_u32 s59, s59, 95744
    v_add_u32 v20, s59, v16
    v_add_u32 v21, s59, v17
    ds_read_b64_tr_b16 v[56:57], v20 offset:0
    ds_read_b64_tr_b16 v[58:59], v20 offset:1024
    ds_read_b64_tr_b16 v[60:61], v21 offset:0
    ds_read_b64_tr_b16 v[62:63], v21 offset:1024
    ds_read_b64_tr_b16 v[64:65], v20 offset:4096
    ds_read_b64_tr_b16 v[66:67], v20 offset:5120
    ds_read_b64_tr_b16 v[68:69], v21 offset:4096
    ds_read_b64_tr_b16 v[70:71], v21 offset:5120
    buffer_load_dwordx4 v[160:163], v1, s[8:11], s48 offen sc1
    buffer_load_dwordx4 v[164:167], v1, s[8:11], s48 offen offset:2048 sc1
    s_add_u32 s49, s48, 4096
    buffer_load_dwordx4 v[168:171], v1, s[8:11], s49 offen sc1
    buffer_load_dwordx4 v[172:175], v1, s[8:11], s49 offen offset:2048 sc1
    s_add_u32 s49, s48, 8192
    buffer_load_dwordx4 v[176:179], v1, s[8:11], s49 offen sc1
    buffer_load_dwordx4 v[180:183], v1, s[8:11], s49 offen offset:2048 sc1
    s_add_u32 s49, s48, 12288
    buffer_load_dwordx4 v[184:187], v1, s[8:11], s49 offen sc1
    buffer_load_dwordx4 v[188:191], v1, s[8:11], s49 offen offset:2048 sc1
    s_add_u32 s49, s48, 16384
    buffer_load_dwordx4 v[192:195], v1, s[8:11], s49 offen sc1
    buffer_load_dwordx4 v[196:199], v1, s[8:11], s49 offen offset:2048 sc1
    s_add_u32 s49, s48, 20480
    buffer_load_dwordx4 v[200:203], v1, s[8:11], s49 offen sc1
    buffer_load_dwordx4 v[204:207], v1, s[8:11], s49 offen offset:2048 sc1
    s_add_u32 s49, s48, 24576
    buffer_load_dwordx4 v[208:211], v1, s[8:11], s49 offen sc1
    buffer_load_dwordx4 v[212:215], v1, s[8:11], s49 offen offset:2048 sc1
    s_add_u32 s49, s48, 28672
    buffer_load_dwordx4 v[216:219], v1, s[8:11], s49 offen sc1
    buffer_load_dwordx4 v[220:223], v1, s[8:11], s49 offen offset:2048 sc1
    s_lshl_b32 s50, s60, 15
    s_lshl_b32 s51, s62, 11
    s_add_u32 s50, s50, s51
    s_add_u32 s50, s50, 9437184
    s_lshl_b32 s51, s60, 4
    s_add_u32 s51, s51, s62
    s_lshl_b32 s51, s51, 8
    s_add_u32 s51, s51, 17170432
    v_and_b32 v22, 31, v0
    v_lshlrev_b32 v22, 3, v22
    s_waitcnt vmcnt(14)
    v_max_u32 v4, v163, v167
    v_cmp_eq_u32 vcc, -1, v4
    s_cbranch_vccnz L_slow_73
L_back_74:
    s_waitcnt lgkmcnt(4)
    v_mfma_f32_32x32x16_bf16 v[24:39], v[56:59], v[160:163], 0
    ds_read_b64_tr_b16 v[72:73], v20 offset:8192
    ds_read_b64_tr_b16 v[74:75], v20 offset:9216
    v_mfma_f32_32x32x16_bf16 v[40:55], v[60:63], v[160:163], 0
    ds_read_b64_tr_b16 v[76:77], v21 offset:8192
    ds_read_b64_tr_b16 v[78:79], v21 offset:9216
    s_waitcnt lgkmcnt(4)
    v_mfma_f32_32x32x16_bf16 v[24:39], v[64:67], v[164:167], v[24:39]
    ds_read_b64_tr_b16 v[56:57], v20 offset:12288
    ds_read_b64_tr_b16 v[58:59], v20 offset:13312
    v_mfma_f32_32x32x16_bf16 v[40:55], v[68:71], v[164:167], v[40:55]
    ds_read_b64_tr_b16 v[60:61], v21 offset:12288
    ds_read_b64_tr_b16 v[62:63], v21 offset:13312
    s_waitcnt vmcnt(12)
    v_max_u32 v4, v171, v175
    v_cmp_eq_u32 vcc, -1, v4
    s_cbranch_vccnz L_slow_77
L_back_78:
    s_waitcnt lgkmcnt(4)
    v_mfma_f32_32x32x16_bf16 v[24:39], v[72:75], v[168:171], v[24:39]
    ds_read_b64_tr_b16 v[64:65], v20 offset:16384
    ds_read_b64_tr_b16 v[66:67], v20 offset:17408
    v_mfma_f32_32x32x16_bf16 v[40:55], v[76:79], v[168:171], v[40:55]
    ds_read_b64_tr_b16 v[68:69], v21 offset:16384
    ds_read_b64_tr_b16 v[70:71], v21 offset:17408
    s_waitcnt lgkmcnt(4)
    v_mfma_f32_32x32x16_bf16 v[24:39], v[56:59], v[172:175], v[24:39]
    ds_read_b64_tr_b16 v[72:73], v20 offset:20480
    ds_read_b64_tr_b16 v[74:75], v20 offset:21504
    v_mfma_f32_32x32x16_bf16 v[40:55], v[60:63], v[172:175], v[40:55]
    ds_read_b64_tr_b16 v[76:77], v21 offset:20480
    ds_read_b64_tr_b16 v[78:79], v21 offset:21504
    s_waitcnt vmcnt(8)
    v_max3_u32 v4, v179, v183, v187
    v_max_u32 v4, v4, v191
    v_cmp_eq_u32 vcc, -1, v4
    s_cbranch_vccnz L_slow_81
L_back_82:
    s_waitcnt lgkmcnt(4)
    v_mfma_f32_32x32x16_bf16 v[24:39], v[64:67], v[176:179], v[24:39]
    ds_read_b64_tr_b16 v[56:57], v20 offset:24576
    ds_read_b64_tr_b16 v[58:59], v20 offset:25600
    v_mfma_f32_32x32x16_bf16 v[40:55], v[68:71], v[176:179], v[40:55]
    ds_read_b64_tr_b16 v[60:61], v21 offset:24576
    ds_read_b64_tr_b16 v[62:63], v21 offset:25600
    s_waitcnt lgkmcnt(4)
    v_mfma_f32_32x32x16_bf16 v[24:39], v[72:75], v[180:183], v[24:39]
    ds_read_b64_tr_b16 v[64:65], v20 offset:28672
    ds_read_b64_tr_b16 v[66:67], v20 offset:29696
    v_mfma_f32_32x32x16_bf16 v[40:55], v[76:79], v[180:183], v[40:55]
    ds_read_b64_tr_b16 v[68:69], v21 offset:28672
    ds_read_b64_tr_b16 v[70:71], v21 offset:29696
    s_waitcnt lgkmcnt(4)
    v_mfma_f32_32x32x16_bf16 v[24:39], v[56:59], v[184:187], v[24:39]
    ds_read_b64_tr_b16 v[72:73], v20 offset:32768
    ds_read_b64_tr_b16 v[74:75], v20 offset:33792
    v_mfma_f32_32x32x16_bf16 v[40:55], v[60:63], v[184:187], v[40:55]
    ds_read_b64_tr_b16 v[76:77], v21 offset:32768
    ds_read_b64_tr_b16 v[78:79], v21 offset:33792
    s_waitcnt lgkmcnt(4)
    v_mfma_f32_32x32x16_bf16 v[24:39], v[64:67], v[188:191], v[24:39]
    ds_read_b64_tr_b16 v[56:57], v20 offset:36864
    ds_read_b64_tr_b16 v[58:59], v20 offset:37888
    v_mfma_f32_32x32x16_bf16 v[40:55], v[68:71], v[188:191], v[40:55]
    ds_read_b64_tr_b16 v[60:61], v21 offset:36864
    ds_read_b64_tr_b16 v[62:63], v21 offset:37888
    s_waitcnt vmcnt(4)
    v_max3_u32 v4, v195, v199, v203
    v_max_u32 v4, v4, v207
    v_cmp_eq_u32 vcc, -1, v4
    s_cbranch_vccnz L_slow_85
L_back_86:
    s_waitcnt lgkmcnt(4)
    v_mfma_f32_32x32x16_bf16 v[24:39], v[72:75], v[192:195], v[24:39]
    ds_read_b64_tr_b16 v[64:65], v20 offset:40960
    ds_read_b64_tr_b16 v[66:67], v20 offset:41984
    v_mfma_f32_32x32x16_bf16 v[40:55], v[76:79], v[192:195], v[40:55]
    ds_read_b64_tr_b16 v[68:69], v21 offset:40960
    ds_read_b64_tr_b16 v[70:71], v21 offset:41984
    s_waitcnt lgkmcnt(4)
    v_mfma_f32_32x32x16_bf16 v[24:39], v[56:59], v[196:199], v[24:39]
    ds_read_b64_tr_b16 v[72:73], v20 offset:45056
    ds_read_b64_tr_b16 v[74:75], v20 offset:46080
    v_mfma_f32_32x32x16_bf16 v[40:55], v[60:63], v[196:199], v[40:55]
    ds_read_b64_tr_b16 v[76:77], v21 offset:45056
    ds_read_b64_tr_b16 v[78:79], v21 offset:46080
    s_waitcnt lgkmcnt(4)
    v_mfma_f32_32x32x16_bf16 v[24:39], v[64:67], v[200:203], v[24:39]
    ds_read_b64_tr_b16 v[56:57], v20 offset:49152
    ds_read_b64_tr_b16 v[58:59], v20 offset:50176
    v_mfma_f32_32x32x16_bf16 v[40:55], v[68:71], v[200:203], v[40:55]
    ds_read_b64_tr_b16 v[60:61], v21 offset:49152
    ds_read_b64_tr_b16 v[62:63], v21 offset:50176
    s_waitcnt lgkmcnt(4)
    v_mfma_f32_32x32x16_bf16 v[24:39], v[72:75], v[204:207], v[24:39]
    ds_read_b64_tr_b16 v[64:65], v20 offset:53248
    ds_read_b64_tr_b16 v[66:67], v20 offset:54272
    v_mfma_f32_32x32x16_bf16 v[40:55], v[76:79], v[204:207], v[40:55]
    ds_read_b64_tr_b16 v[68:69], v21 offset:53248
    ds_read_b64_tr_b16 v[70:71], v21 offset:54272
    s_waitcnt vmcnt(0)
    v_max3_u32 v4, v211, v215, v219
    v_max_u32 v4, v4, v223
    v_cmp_eq_u32 vcc, -1, v4
    s_cbranch_vccnz L_slow_89
L_back_90:
    s_waitcnt lgkmcnt(4)
    v_mfma_f32_32x32x16_bf16 v[24:39], v[56:59], v[208:211], v[24:39]
    ds_read_b64_tr_b16 v[72:73], v20 offset:57344
    ds_read_b64_tr_b16 v[74:75], v20 offset:58368
    v_mfma_f32_32x32x16_bf16 v[40:55], v[60:63], v[208:211], v[40:55]
    ds_read_b64_tr_b16 v[76:77], v21 offset:57344
    ds_read_b64_tr_b16 v[78:79], v21 offset:58368
    s_waitcnt lgkmcnt(4)
    v_mfma_f32_32x32x16_bf16 v[24:39], v[64:67], v[212:215], v[24:39]
    ds_read_b64_tr_b16 v[56:57], v20 offset:61440
    ds_read_b64_tr_b16 v[58:59], v20 offset:62464
    v_mfma_f32_32x32x16_bf16 v[40:55], v[68:71], v[212:215], v[40:55]
    ds_read_b64_tr_b16 v[60:61], v21 offset:61440
    ds_read_b64_tr_b16 v[62:63], v21 offset:62464
    s_waitcnt lgkmcnt(4)
    v_mfma_f32_32x32x16_bf16 v[24:39], v[72:75], v[216:219], v[24:39]
    v_mfma_f32_32x32x16_bf16 v[40:55], v[76:79], v[216:219], v[40:55]
    s_waitcnt lgkmcnt(0)
    v_mfma_f32_32x32x16_bf16 v[24:39], v[56:59], v[220:223], v[24:39]
    v_mfma_f32_32x32x16_bf16 v[40:55], v[60:63], v[220:223], v[40:55]
    s_barrier
    s_lshl_b32 s59, s44, 12
    s_add_u32 s58, s59, 144896
    v_add_u32 v16, s58, v1
    s_xor_b32 s59, s59, 0x2000
    s_add_u32 s59, s59, 144896
    v_add_u32 v17, s59, v1
    v_lshlrev_b32 v160, 16, v8
    v_and_b32 v161, 0xffff0000, v8
    v_lshlrev_b32 v162, 16, v9
    v_and_b32 v163, 0xffff0000, v9
    v_lshlrev_b32 v164, 16, v10
    v_and_b32 v165, 0xffff0000, v10
    v_lshlrev_b32 v166, 16, v11
    v_and_b32 v167, 0xffff0000, v11
    ds_write_b128 v16, v[40:43] offset:0
    ds_write_b128 v16, v[44:47] offset:1024
    ds_write_b128 v16, v[48:51] offset:2048
    ds_write_b128 v16, v[52:55] offset:3072
    v_lshlrev_b32 v168, 16, v12
    v_and_b32 v169, 0xffff0000, v12
    v_lshlrev_b32 v170, 16, v13
    v_and_b32 v171, 0xffff0000, v13
    v_lshlrev_b32 v172, 16, v14
    v_and_b32 v173, 0xffff0000, v14
    v_lshlrev_b32 v174, 16, v15
    v_and_b32 v175, 0xffff0000, v15
    s_waitcnt lgkmcnt(0)
    s_barrier
    ds_read_b128 v[40:43], v17 offset:0
    ds_read_b128 v[44:47], v17 offset:1024
    ds_read_b128 v[48:51], v17 offset:2048
    ds_read_b128 v[52:55], v17 offset:3072
    v_pk_add_f32 v[24:25], v[24:25], v[160:161]
    v_pk_add_f32 v[26:27], v[26:27], v[162:163]
    v_pk_add_f32 v[28:29], v[28:29], v[164:165]
    v_pk_add_f32 v[30:31], v[30:31], v[166:167]
    v_pk_add_f32 v[32:33], v[32:33], v[168:169]
    v_pk_add_f32 v[34:35], v[34:35], v[170:171]
    v_pk_add_f32 v[36:37], v[36:37], v[172:173]
    v_pk_add_f32 v[38:39], v[38:39], v[174:175]
    s_waitcnt lgkmcnt(3)
    v_pk_add_f32 v[24:25], v[24:25], v[40:41]
    v_pk_add_f32 v[26:27], v[26:27], v[42:43]
    s_waitcnt lgkmcnt(2)
    v_pk_add_f32 v[28:29], v[28:29], v[44:45]
    v_pk_add_f32 v[30:31], v[30:31], v[46:47]
    s_waitcnt lgkmcnt(1)
    v_pk_add_f32 v[32:33], v[32:33], v[48:49]
    v_pk_add_f32 v[34:35], v[34:35], v[50:51]
    s_waitcnt lgkmcnt(0)
    v_pk_add_f32 v[36:37], v[36:37], v[52:53]
    v_pk_add_f32 v[38:39], v[38:39], v[54:55]
    v_cvt_pk_bf16_f32 v8, v24, v25
    v_cvt_pk_bf16_f32 v9, v26, v27
    v_cvt_pk_bf16_f32 v10, v28, v29
    v_cvt_pk_bf16_f32 v11, v30, v31
    v_cvt_pk_bf16_f32 v12, v32, v33
    v_cvt_pk_bf16_f32 v13, v34, v35
    v_cvt_pk_bf16_f32 v14, v36, v37
    v_cvt_pk_bf16_f32 v15, v38, v39
    v_min_u32 v11, -2, v11
    v_min_u32 v15, -2, v15
    s_cmp_lg_u32 s66, 0
    s_cbranch_scc1 L_wt_93
    buffer_store_dwordx4 v[8:11], v1, s[8:11], s50 offen offset:0
    buffer_store_dwordx4 v[12:15], v1, s[8:11], s50 offen offset:1024
L_wb_94:
    v_pk_mul_f32 v[40:41], v[24:25], v[24:25]
    v_pk_mul_f32 v[42:43], v[26:27], v[26:27]
    v_pk_mul_f32 v[44:45], v[28:29], v[28:29]
    v_pk_mul_f32 v[46:47], v[30:31], v[30:31]
    v_pk_mul_f32 v[48:49], v[32:33], v[32:33]
    v_pk_mul_f32 v[50:51], v[34:35], v[34:35]
    v_pk_mul_f32 v[52:53], v[36:37], v[36:37]
    v_pk_mul_f32 v[54:55], v[38:39], v[38:39]
    v_pk_add_f32 v[24:25], v[24:25], v[32:33]
    v_pk_add_f32 v[40:41], v[40:41], v[48:49]
    v_pk_add_f32 v[26:27], v[26:27], v[34:35]
    v_pk_add_f32 v[42:43], v[42:43], v[50:51]
    v_pk_add_f32 v[28:29], v[28:29], v[36:37]
    v_pk_add_f32 v[44:45], v[44:45], v[52:53]
    v_pk_add_f32 v[30:31], v[30:31], v[38:39]
    v_pk_add_f32 v[46:47], v[46:47], v[54:55]
    v_pk_add_f32 v[24:25], v[24:25], v[28:29]
    v_pk_add_f32 v[40:41], v[40:41], v[44:45]
    v_pk_add_f32 v[26:27], v[26:27], v[30:31]
    v_pk_add_f32 v[42:43], v[42:43], v[46:47]
    v_pk_add_f32 v[24:25], v[24:25], v[26:27]
    v_pk_add_f32 v[40:41], v[40:41], v[42:43]
    v_add_f32 v16, v24, v25
    v_add_f32 v17, v40, v41
    v_mov_b32 v18, v16
    v_mov_b32 v19, v17
    s_nop 1
    v_permlane32_swap_b32 v16, v18
    v_permlane32_swap_b32 v17, v19
    s_nop 1
    v_pk_add_f32 v[16:17], v[16:17], v[18:19]
    v_min_u32 v17, -2, v17
    s_cmp_lg_u32 s66, 0
    s_cbranch_scc1 L_wt_95
    buffer_store_dwordx2 v[16:17], v22, s[8:11], s51 offen
L_wb_96:
    s_and_b32 s58, s46, 1
    s_lshl1_add_u32 s48, s45, s58
    s_lshl2_add_u32 s48, s48, s44
    s_lshr_b32 s49, s46, 1
    s_lshl_b32 s50, s48, 15
    s_add_u32 s50, s50, 9437184
    s_lshl_b32 s51, s48, 12
    s_add_u32 s51, s51, 17170432
    buffer_load_dwordx4 v[16:19], v1, s[8:11], s50 offen sc1
    buffer_load_dwordx4 v[20:23], v1, s[8:11], s50 offen offset:1024 sc1
    buffer_load_dwordx4 v[24:27], v1, s[8:11], s50 offen offset:2048 sc1
    buffer_load_dwordx4 v[28:31], v1, s[8:11], s50 offen offset:3072 sc1
    s_add_u32 s56, s50, 4096
    buffer_load_dwordx4 v[32:35], v1, s[8:11], s56 offen sc1
    buffer_load_dwordx4 v[36:39], v1, s[8:11], s56 offen offset:1024 sc1
    buffer_load_dwordx4 v[40:43], v1, s[8:11], s56 offen offset:2048 sc1
    buffer_load_dwordx4 v[44:47], v1, s[8:11], s56 offen offset:3072 sc1
    s_add_u32 s56, s50, 8192
    buffer_load_dwordx4 v[48:51], v1, s[8:11], s56 offen sc1
    buffer_load_dwordx4 v[52:55], v1, s[8:11], s56 offen offset:1024 sc1
    buffer_load_dwordx4 v[56:59], v1, s[8:11], s56 offen offset:2048 sc1
    buffer_load_dwordx4 v[60:63], v1, s[8:11], s56 offen offset:3072 sc1
    s_mul_i32 s58, s48, 88064
    s_lshl_b32 s59, s49, 11
    s_add_u32 s58, s58, s59
    s_add_u32 s53, s58, 11534336
    s_add_u32 s54, s58, 11567104
    s_add_u32 s55, s58, 11599872
    s_lshl_b32 s58, s49, 6
    s_add_u32 s58, s58, s48
    s_lshl_b32 s58, s58, 11
    s_add_u32 s58, s58, 4293787648
    s_cmp_gt_u32 s49, 10
    s_cselect_b32 s55, s58, s55
    s_mul_i32 s57, s60, 88064
    s_lshl_b32 s58, s61, 10
    s_add_u32 s57, s57, s58
    s_add_u32 s57, s57, 11534336
    v_lshrrev_b32 v232, 5, v0
    v_lshlrev_b32 v254, 4, v232
    v_add_u32 v254, 162816, v254
    v_lshlrev_b32 v255, 11, v232
    v_and_b32 v233, 31, v0
    v_lshl_add_u32 v255, v233, 3, v255
    v_lshlrev_b32 v232, 2, v232
    v_bfe_u32 v233, v0, 2, 2
    v_add_u32 v232, v232, v233
    v_lshlrev_b32 v232, 6, v232
    v_bfe_u32 v233, v0, 4, 1
    v_mul_u32_u24 v233, 8224, v233
    v_add_u32 v232, v232, v233
    v_and_b32 v233, 3, v0
    v_lshl_add_u32 v249, v233, 3, v232
    v_add_u32 v251, 0x10000, v249
    v_add_u32 v253, 0x20000, v249
    v_lshrrev_b32 v208, 5, v0
    v_lshlrev_b32 v208, 2, v208
    v_bfe_u32 v209, v0, 2, 2
    v_add_u32 v208, v208, v209
    v_lshlrev_b32 v208, 7, v208
    v_bfe_u32 v209, v0, 4, 1
    v_lshl_add_u32 v208, v209, 5, v208
    v_and_b32 v209, 3, v0
    v_lshl_add_u32 v208, v209, 3, v208
    v_bfe_u32 v209, v0, 3, 1
    v_xor_b32 v209, s61, v209
    v_lshl_add_u32 v208, v209, 6, v208
    v_xor_b32 v209, 64, v208
    s_lshl_b32 s59, s61, 11
    v_add_u32 v6, s59, v208
    v_add_u32 v7, s59, v209
    buffer_load_dwordx2 v[176:177], v255, s[8:11], s51 offen sc1
    buffer_load_dwordx2 v[178:179], v255, s[8:11], s51 offen offset:256 sc1
    buffer_load_dwordx2 v[180:181], v255, s[8:11], s51 offen offset:512 sc1
    buffer_load_dwordx2 v[182:183], v255, s[8:11], s51 offen offset:768 sc1
    buffer_load_dwordx2 v[184:185], v255, s[8:11], s51 offen offset:1024 sc1
    buffer_load_dwordx2 v[186:187], v255, s[8:11], s51 offen offset:1280 sc1
    buffer_load_dwordx2 v[188:189], v255, s[8:11], s51 offen offset:1536 sc1
    buffer_load_dwordx2 v[190:191], v255, s[8:11], s51 offen offset:1792 sc1
    s_barrier
    ds_read_b64_tr_b16 v[208:209], v249 offset:0
    ds_read_b64_tr_b16 v[210:211], v249 offset:512
    ds_read_b64_tr_b16 v[212:213], v249 offset:32
    ds_read_b64_tr_b16 v[214:215], v249 offset:544
    ds_read_b64_tr_b16 v[216:217], v249 offset:1024
    ds_read_b64_tr_b16 v[218:219], v249 offset:1536
    ds_read_b64_tr_b16 v[220:221], v249 offset:1056
    ds_read_b64_tr_b16 v[222:223], v249 offset:1568
    s_waitcnt vmcnt(18)
    v_max_u32 v4, v19, v23
    v_cmp_eq_u32 vcc, -1, v4
    s_cbranch_vccnz L_slow_97
L_back_98:
    s_waitcnt lgkmcnt(4)
    v_mfma_f32_32x32x16_bf16 v[144:159], v[208:211], v[16:19], 0
    ds_read_b64_tr_b16 v[224:225], v249 offset:2048
    ds_read_b64_tr_b16 v[226:227], v249 offset:2560
    s_add_u32 s56, s50, 12288
    buffer_load_dwordx4 v[64:67], v1, s[8:11], s56 offen sc1
    v_mfma_f32_32x32x16_bf16 v[160:175], v[212:215], v[16:19], 0
    ds_read_b64_tr_b16 v[228:229], v249 offset:2080
    ds_read_b64_tr_b16 v[230:231], v249 offset:2592
    s_waitcnt lgkmcnt(4)
    v_mfma_f32_32x32x16_bf16 v[144:159], v[216:219], v[20:23], v[144:159]
    ds_read_b64_tr_b16 v[208:209], v249 offset:3072
    ds_read_b64_tr_b16 v[210:211], v249 offset:3584
    buffer_load_dwordx4 v[68:71], v1, s[8:11], s56 offen offset:1024 sc1
    v_mfma_f32_32x32x16_bf16 v[160:175], v[220:223], v[20:23], v[160:175]
    ds_read_b64_tr_b16 v[212:213], v249 offset:3104
    ds_read_b64_tr_b16 v[214:215], v249 offset:3616
    s_waitcnt vmcnt(18)
    v_max_u32 v4, v27, v31
    v_cmp_eq_u32 vcc, -1, v4
    s_cbranch_vccnz L_slow_101
L_back_102:
    s_waitcnt lgkmcnt(4)
    v_mfma_f32_32x32x16_bf16 v[144:159], v[224:227], v[24:27], v[144:159]
    ds_read_b64_tr_b16 v[216:217], v249 offset:4096
    ds_read_b64_tr_b16 v[218:219], v249 offset:4608
    buffer_load_dwordx4 v[72:75], v1, s[8:11], s56 offen offset:2048 sc1
    v_mfma_f32_32x32x16_bf16 v[160:175], v[228:231], v[24:27], v[160:175]
    ds_read_b64_tr_b16 v[220:221], v249 offset:4128
    ds_read_b64_tr_b16 v[222:223], v249 offset:4640
    s_waitcnt lgkmcnt(4)
    v_mfma_f32_32x32x16_bf16 v[144:159], v[208:211], v[28:31], v[144:159]
    ds_read_b64_tr_b16 v[224:225], v249 offset:5120
    ds_read_b64_tr_b16 v[226:227], v249 offset:5632
    buffer_load_dwordx4 v[76:79], v1, s[8:11], s56 offen offset:3072 sc1
    v_mfma_f32_32x32x16_bf16 v[160:175], v[212:215], v[28:31], v[160:175]
    ds_read_b64_tr_b16 v[228:229], v249 offset:5152
    ds_read_b64_tr_b16 v[230:231], v249 offset:5664
    s_waitcnt vmcnt(16)
    v_max3_u32 v4, v35, v39, v43
    v_max_u32 v4, v4, v47
    v_cmp_eq_u32 vcc, -1, v4
    s_cbranch_vccnz L_slow_105
L_back_106:
    s_waitcnt lgkmcnt(4)
    v_mfma_f32_32x32x16_bf16 v[144:159], v[216:219], v[32:35], v[144:159]
    ds_read_b64_tr_b16 v[208:209], v249 offset:6144
    ds_read_b64_tr_b16 v[210:211], v249 offset:6656
    s_add_u32 s56, s50, 16384
    buffer_load_dwordx4 v[80:83], v1, s[8:11], s56 offen sc1
    v_mfma_f32_32x32x16_bf16 v[160:175], v[220:223], v[32:35], v[160:175]
    ds_read_b64_tr_b16 v[212:213], v249 offset:6176
    ds_read_b64_tr_b16 v[214:215], v249 offset:6688
    s_waitcnt lgkmcnt(4)
    v_mfma_f32_32x32x16_bf16 v[144:159], v[224:227], v[36:39], v[144:159]
    ds_read_b64_tr_b16 v[216:217], v249 offset:7168
    ds_read_b64_tr_b16 v[218:219], v249 offset:7680
    buffer_load_dwordx4 v[84:87], v1, s[8:11], s56 offen offset:1024 sc1
    v_mfma_f32_32x32x16_bf16 v[160:175], v[228:231], v[36:39], v[160:175]
    ds_read_b64_tr_b16 v[220:221], v249 offset:7200
    ds_read_b64_tr_b16 v[222:223], v249 offset:7712
    s_waitcnt lgkmcnt(4)
    v_mfma_f32_32x32x16_bf16 v[144:159], v[208:211], v[40:43], v[144:159]
    ds_read_b64_tr_b16 v[224:225], v249 offset:16448
    ds_read_b64_tr_b16 v[226:227], v249 offset:16960
    buffer_load_dwordx4 v[88:91], v1, s[8:11], s56 offen offset:2048 sc1
    v_mfma_f32_32x32x16_bf16 v[160:175], v[212:215], v[40:43], v[160:175]
    ds_read_b64_tr_b16 v[228:229], v249 offset:16480
    ds_read_b64_tr_b16 v[230:231], v249 offset:16992
    s_waitcnt lgkmcnt(4)
    v_mfma_f32_32x32x16_bf16 v[144:159], v[216:219], v[44:47], v[144:159]
    ds_read_b64_tr_b16 v[208:209], v249 offset:17472
    ds_read_b64_tr_b16 v[210:211], v249 offset:17984
    buffer_load_dwordx4 v[92:95], v1, s[8:11], s56 offen offset:3072 sc1
    v_mfma_f32_32x32x16_bf16 v[160:175], v[220:223], v[44:47], v[160:175]
    ds_read_b64_tr_b16 v[212:213], v249 offset:17504
    ds_read_b64_tr_b16 v[214:215], v249 offset:18016
    s_waitcnt vmcnt(16)
    v_max3_u32 v4, v51, v55, v59
    v_max_u32 v4, v4, v63
    v_cmp_eq_u32 vcc, -1, v4
    s_cbranch_vccnz L_slow_109
L_back_110:
    s_waitcnt lgkmcnt(4)
    v_mfma_f32_32x32x16_bf16 v[144:159], v[224:227], v[48:51], v[144:159]
    ds_read_b64_tr_b16 v[216:217], v249 offset:18496
    ds_read_b64_tr_b16 v[218:219], v249 offset:19008
    s_add_u32 s56, s50, 20480
    buffer_load_dwordx4 v[96:99], v1, s[8:11], s56 offen sc1
    v_mfma_f32_32x32x16_bf16 v[160:175], v[228:231], v[48:51], v[160:175]
    ds_read_b64_tr_b16 v[220:221], v249 offset:18528
    ds_read_b64_tr_b16 v[222:223], v249 offset:19040
    s_waitcnt lgkmcnt(4)
    v_mfma_f32_32x32x16_bf16 v[144:159], v[208:211], v[52:55], v[144:159]
    ds_read_b64_tr_b16 v[224:225], v249 offset:19520
    ds_read_b64_tr_b16 v[226:227], v249 offset:20032
    buffer_load_dwordx4 v[100:103], v1, s[8:11], s56 offen offset:1024 sc1
    v_mfma_f32_32x32x16_bf16 v[160:175], v[212:215], v[52:55], v[160:175]
    ds_read_b64_tr_b16 v[228:229], v249 offset:19552
    ds_read_b64_tr_b16 v[230:231], v249 offset:20064
    s_waitcnt lgkmcnt(4)
    v_mfma_f32_32x32x16_bf16 v[144:159], v[216:219], v[56:59], v[144:159]
    ds_read_b64_tr_b16 v[208:209], v249 offset:20544
    ds_read_b64_tr_b16 v[210:211], v249 offset:21056
    buffer_load_dwordx4 v[104:107], v1, s[8:11], s56 offen offset:2048 sc1
    v_mfma_f32_32x32x16_bf16 v[160:175], v[220:223], v[56:59], v[160:175]
    ds_read_b64_tr_b16 v[212:213], v249 offset:20576
    ds_read_b64_tr_b16 v[214:215], v249 offset:21088
    s_waitcnt lgkmcnt(4)
    v_mfma_f32_32x32x16_bf16 v[144:159], v[224:227], v[60:63], v[144:159]
    ds_read_b64_tr_b16 v[216:217], v249 offset:21568
    ds_read_b64_tr_b16 v[218:219], v249 offset:22080
    buffer_load_dwordx4 v[108:111], v1, s[8:11], s56 offen offset:3072 sc1
    v_mfma_f32_32x32x16_bf16 v[160:175], v[228:231], v[60:63], v[160:175]
    ds_read_b64_tr_b16 v[220:221], v249 offset:21600
    ds_read_b64_tr_b16 v[222:223], v249 offset:22112
    s_waitcnt vmcnt(8)
    v_max3_u32 v4, v67, v71, v75
    v_max_u32 v4, v4, v79
    v_cmp_eq_u32 vcc, -1, v4
    s_cbranch_vccnz L_slow_113
L_back_114:
    s_waitcnt lgkmcnt(4)
    v_mfma_f32_32x32x16_bf16 v[144:159], v[208:211], v[64:67], v[144:159]
    ds_read_b64_tr_b16 v[224:225], v249 offset:22592
    ds_read_b64_tr_b16 v[226:227], v249 offset:23104
    s_add_u32 s56, s50, 24576
    buffer_load_dwordx4 v[112:115], v1, s[8:11], s56 offen sc1
    v_mfma_f32_32x32x16_bf16 v[160:175], v[212:215], v[64:67], v[160:175]
    ds_read_b64_tr_b16 v[228:229], v249 offset:22624
    ds_read_b64_tr_b16 v[230:231], v249 offset:23136
    s_waitcnt lgkmcnt(4)
    v_mfma_f32_32x32x16_bf16 v[144:159], v[216:219], v[68:71], v[144:159]
    ds_read_b64_tr_b16 v[208:209], v249 offset:23616
    ds_read_b64_tr_b16 v[210:211], v249 offset:24128
    buffer_load_dwordx4 v[116:119], v1, s[8:11], s56 offen offset:1024 sc1
    v_mfma_f32_32x32x16_bf16 v[160:175], v[220:223], v[68:71], v[160:175]
    ds_read_b64_tr_b16 v[212:213], v249 offset:23648
    ds_read_b64_tr_b16 v[214:215], v249 offset:24160
    s_waitcnt lgkmcnt(4)
    v_mfma_f32_32x32x16_bf16 v[144:159], v[224:227], v[72:75], v[144:159]
    ds_read_b64_tr_b16 v[216:217], v249 offset:32896
    ds_read_b64_tr_b16 v[218:219], v249 offset:33408
    buffer_load_dwordx4 v[120:123], v1, s[8:11], s56 offen offset:2048 sc1
    v_mfma_f32_32x32x16_bf16 v[160:175], v[228:231], v[72:75], v[160:175]
    ds_read_b64_tr_b16 v[220:221], v249 offset:32928
    ds_read_b64_tr_b16 v[222:223], v249 offset:33440
    s_waitcnt lgkmcnt(4)
    v_mfma_f32_32x32x16_bf16 v[144:159], v[208:211], v[76:79], v[144:159]
    ds_read_b64_tr_b16 v[224:225], v249 offset:33920
    ds_read_b64_tr_b16 v[226:227], v249 offset:34432
    buffer_load_dwordx4 v[124:127], v1, s[8:11], s56 offen offset:3072 sc1
    v_mfma_f32_32x32x16_bf16 v[160:175], v[212:215], v[76:79], v[160:175]
    ds_read_b64_tr_b16 v[228:229], v249 offset:33952
    ds_read_b64_tr_b16 v[230:231], v249 offset:34464
    v_max3_u32 v5, v177, v179, v181
    v_max3_u32 v5, v5, v183, v185
    s_waitcnt vmcnt(8)
    v_max3_u32 v4, v83, v87, v91
    v_max_u32 v4, v4, v95
    v_cmp_eq_u32 vcc, -1, v4
    s_cbranch_vccnz L_slow_117
L_back_118:
    s_waitcnt lgkmcnt(4)
    v_mfma_f32_32x32x16_bf16 v[144:159], v[216:219], v[80:83], v[144:159]
    ds_read_b64_tr_b16 v[208:209], v249 offset:34944
    ds_read_b64_tr_b16 v[210:211], v249 offset:35456
    s_add_u32 s56, s50, 28672
    buffer_load_dwordx4 v[128:131], v1, s[8:11], s56 offen sc1
    v_max3_u32 v5, v5, v187, v189
    v_max_u32 v5, v5, v191
    v_mfma_f32_32x32x16_bf16 v[160:175], v[220:223], v[80:83], v[160:175]
    ds_read_b64_tr_b16 v[212:213], v249 offset:34976
    ds_read_b64_tr_b16 v[214:215], v249 offset:35488
    v_cmp_eq_u32 vcc, -1, v5
    s_cbranch_vccnz L_slow_121
L_back_122:
    v_add_f32 v176, v176, v184
    s_waitcnt lgkmcnt(4)
    v_mfma_f32_32x32x16_bf16 v[144:159], v[224:227], v[84:87], v[144:159]
    ds_read_b64_tr_b16 v[216:217], v249 offset:35968
    ds_read_b64_tr_b16 v[218:219], v249 offset:36480
    buffer_load_dwordx4 v[132:135], v1, s[8:11], s56 offen offset:1024 sc1
    v_add_f32 v177, v177, v185
    v_add_f32 v178, v178, v186
    v_mfma_f32_32x32x16_bf16 v[160:175], v[228:231], v[84:87], v[160:175]
    ds_read_b64_tr_b16 v[220:221], v249 offset:36000
    ds_read_b64_tr_b16 v[222:223], v249 offset:36512
    v_add_f32 v179, v179, v187
    v_add_f32 v180, v180, v188
    v_add_f32 v181, v181, v189
    s_waitcnt lgkmcnt(4)
    v_mfma_f32_32x32x16_bf16 v[144:159], v[208:211], v[88:91], v[144:159]
    ds_read_b64_tr_b16 v[224:225], v249 offset:36992
    ds_read_b64_tr_b16 v[226:227], v249 offset:37504
    buffer_load_dwordx4 v[136:139], v1, s[8:11], s56 offen offset:2048 sc1
    v_add_f32 v182, v182, v190
    v_add_f32 v183, v183, v191
    v_mfma_f32_32x32x16_bf16 v[160:175], v[212:215], v[88:91], v[160:175]
    ds_read_b64_tr_b16 v[228:229], v249 offset:37024
    ds_read_b64_tr_b16 v[230:231], v249 offset:37536
    v_add_f32 v176, v176, v180
    v_add_f32 v177, v177, v181
    v_add_f32 v178, v178, v182
    s_waitcnt lgkmcnt(4)
    v_mfma_f32_32x32x16_bf16 v[144:159], v[216:219], v[92:95], v[144:159]
    ds_read_b64_tr_b16 v[208:209], v249 offset:38016
    ds_read_b64_tr_b16 v[210:211], v249 offset:38528
    buffer_load_dwordx4 v[140:143], v1, s[8:11], s56 offen offset:3072 sc1
    v_add_f32 v179, v179, v183
    v_add_f32 v176, v176, v178
    v_mfma_f32_32x32x16_bf16 v[160:175], v[220:223], v[92:95], v[160:175]
    ds_read_b64_tr_b16 v[212:213], v249 offset:38048
    ds_read_b64_tr_b16 v[214:215], v249 offset:38560
    v_add_f32 v177, v177, v179
    v_mov_b32 v178, v176
    v_mov_b32 v179, v177
    s_waitcnt vmcnt(8)
    v_max3_u32 v4, v99, v103, v107
    v_max_u32 v4, v4, v111
    v_cmp_eq_u32 vcc, -1, v4
    s_cbranch_vccnz L_slow_125
L_back_126:
    s_waitcnt lgkmcnt(4)
    v_mfma_f32_32x32x16_bf16 v[144:159], v[224:227], v[96:99], v[144:159]
    ds_read_b64_tr_b16 v[216:217], v249 offset:39040
    ds_read_b64_tr_b16 v[218:219], v249 offset:39552
    s_nop 1
    v_permlane32_swap_b32 v176, v178
    v_permlane32_swap_b32 v177, v179
    v_mfma_f32_32x32x16_bf16 v[160:175], v[228:231], v[96:99], v[160:175]
    ds_read_b64_tr_b16 v[220:221], v249 offset:39072
    ds_read_b64_tr_b16 v[222:223], v249 offset:39584
    s_nop 1
    v_add_f32 v176, v176, v178
    v_add_f32 v177, v177, v179
    s_waitcnt lgkmcnt(4)
    v_mfma_f32_32x32x16_bf16 v[144:159], v[208:211], v[100:103], v[144:159]
    ds_read_b64_tr_b16 v[224:225], v249 offset:40064
    ds_read_b64_tr_b16 v[226:227], v249 offset:40576
    v_mul_f32 v248, 0xbb000000, v176
    v_mul_f32 v177, 0x3b000000, v177
    v_fma_f32 v250, -v248, v248, v177
    v_mfma_f32_32x32x16_bf16 v[160:175], v[212:215], v[100:103], v[160:175]
    ds_read_b64_tr_b16 v[228:229], v249 offset:40096
    ds_read_b64_tr_b16 v[230:231], v249 offset:40608
    v_max_f32 v250, 0, v250
    v_add_f32 v250, 0x3727c5ac, v250
    s_barrier
    s_waitcnt lgkmcnt(4)
    v_mfma_f32_32x32x16_bf16 v[144:159], v[216:219], v[104:107], v[144:159]
    ds_read_b64_tr_b16 v[208:209], v249 offset:49344
    ds_read_b64_tr_b16 v[210:211], v249 offset:49856
    v_rsq_f32 v252, v250
    s_nop 0
    v_mfma_f32_32x32x16_bf16 v[160:175], v[220:223], v[104:107], v[160:175]
    ds_read_b64_tr_b16 v[212:213], v249 offset:49376
    ds_read_b64_tr_b16 v[214:215], v249 offset:49888
    v_mul_f32 v252, 0xbfb8aa3b, v252
    s_waitcnt lgkmcnt(4)
    v_mfma_f32_32x32x16_bf16 v[144:159], v[224:227], v[108:111], v[144:159]
    ds_read_b64_tr_b16 v[216:217], v249 offset:50368
    ds_read_b64_tr_b16 v[218:219], v249 offset:50880
    v_mfma_f32_32x32x16_bf16 v[160:175], v[228:231], v[108:111], v[160:175]
    ds_read_b64_tr_b16 v[220:221], v249 offset:50400
    ds_read_b64_tr_b16 v[222:223], v249 offset:50912
    s_waitcnt vmcnt(4)
    v_max3_u32 v4, v115, v119, v123
    v_max_u32 v4, v4, v127
    v_cmp_eq_u32 vcc, -1, v4
    s_cbranch_vccnz L_slow_129
L_back_130:
    s_waitcnt lgkmcnt(4)
    v_mfma_f32_32x32x16_bf16 v[144:159], v[208:211], v[112:115], v[144:159]
    ds_read_b64_tr_b16 v[224:225], v249 offset:51392
    ds_read_b64_tr_b16 v[226:227], v249 offset:51904
    v_mfma_f32_32x32x16_bf16 v[160:175], v[212:215], v[112:115], v[160:175]
    ds_read_b64_tr_b16 v[228:229], v249 offset:51424
    ds_read_b64_tr_b16 v[230:231], v249 offset:51936
    s_waitcnt lgkmcnt(4)
    v_mfma_f32_32x32x16_bf16 v[144:159], v[216:219], v[116:119], v[144:159]
    ds_read_b64_tr_b16 v[208:209], v249 offset:52416
    ds_read_b64_tr_b16 v[210:211], v249 offset:52928
    v_mfma_f32_32x32x16_bf16 v[160:175], v[220:223], v[116:119], v[160:175]
    ds_read_b64_tr_b16 v[212:213], v249 offset:52448
    ds_read_b64_tr_b16 v[214:215], v249 offset:52960
    s_waitcnt lgkmcnt(4)
    v_mfma_f32_32x32x16_bf16 v[144:159], v[224:227], v[120:123], v[144:159]
    ds_read_b64_tr_b16 v[216:217], v249 offset:53440
    ds_read_b64_tr_b16 v[218:219], v249 offset:53952
    v_mfma_f32_32x32x16_bf16 v[160:175], v[228:231], v[120:123], v[160:175]
    ds_read_b64_tr_b16 v[220:221], v249 offset:53472
    ds_read_b64_tr_b16 v[222:223], v249 offset:53984
    s_waitcnt lgkmcnt(4)
    v_mfma_f32_32x32x16_bf16 v[144:159], v[208:211], v[124:127], v[144:159]
    ds_read_b64_tr_b16 v[224:225], v249 offset:54464
    ds_read_b64_tr_b16 v[226:227], v249 offset:54976
    v_mfma_f32_32x32x16_bf16 v[160:175], v[212:215], v[124:127], v[160:175]
    ds_read_b64_tr_b16 v[228:229], v249 offset:54496
    ds_read_b64_tr_b16 v[230:231], v249 offset:55008
    s_waitcnt vmcnt(0)
    v_max3_u32 v4, v131, v135, v139
    v_max_u32 v4, v4, v143
    v_cmp_eq_u32 vcc, -1, v4
    s_cbranch_vccnz L_slow_133
L_back_134:
    s_waitcnt lgkmcnt(4)
    v_mfma_f32_32x32x16_bf16 v[144:159], v[216:219], v[128:131], v[144:159]
    ds_read_b64_tr_b16 v[208:209], v249 offset:55488
    ds_read_b64_tr_b16 v[210:211], v249 offset:56000
    v_mfma_f32_32x32x16_bf16 v[160:175], v[220:223], v[128:131], v[160:175]
    ds_read_b64_tr_b16 v[212:213], v249 offset:55520
    ds_read_b64_tr_b16 v[214:215], v249 offset:56032
    s_waitcnt lgkmcnt(4)
    v_mfma_f32_32x32x16_bf16 v[144:159], v[224:227], v[132:135], v[144:159]
    ds_read_b64_tr_b16 v[216:217], v249 offset:56512
    ds_read_b64_tr_b16 v[218:219], v249 offset:57024
    v_mfma_f32_32x32x16_bf16 v[160:175], v[228:231], v[132:135], v[160:175]
    ds_read_b64_tr_b16 v[220:221], v249 offset:56544
    ds_read_b64_tr_b16 v[222:223], v249 offset:57056
    s_waitcnt lgkmcnt(4)
    v_mfma_f32_32x32x16_bf16 v[144:159], v[208:211], v[136:139], v[144:159]
    ds_read_b64_tr_b16 v[224:225], v251 offset:256
    ds_read_b64_tr_b16 v[226:227], v251 offset:768
    v_mfma_f32_32x32x16_bf16 v[160:175], v[212:215], v[136:139], v[160:175]
    ds_read_b64_tr_b16 v[228:229], v251 offset:288
    ds_read_b64_tr_b16 v[230:231], v251 offset:800
    s_waitcnt lgkmcnt(4)
    v_mfma_f32_32x32x16_bf16 v[144:159], v[216:219], v[140:143], v[144:159]
    ds_read_b64_tr_b16 v[208:209], v251 offset:1280
    ds_read_b64_tr_b16 v[210:211], v251 offset:1792
    v_mfma_f32_32x32x16_bf16 v[160:175], v[220:223], v[140:143], v[160:175]
    ds_read_b64_tr_b16 v[212:213], v251 offset:1312
    ds_read_b64_tr_b16 v[214:215], v251 offset:1824
    s_barrier
    s_waitcnt lgkmcnt(4)
    v_mfma_f32_32x32x16_bf16 v[176:191], v[224:227], v[16:19], 0
    ds_read_b64_tr_b16 v[216:217], v251 offset:2304
    ds_read_b64_tr_b16 v[218:219], v251 offset:2816
    v_mfma_f32_32x32x16_bf16 v[192:207], v[228:231], v[16:19], 0
    ds_read_b64_tr_b16 v[220:221], v251 offset:2336
    ds_read_b64_tr_b16 v[222:223], v251 offset:2848
    s_waitcnt lgkmcnt(4)
    v_mfma_f32_32x32x16_bf16 v[176:191], v[208:211], v[20:23], v[176:191]
    ds_read_b64_tr_b16 v[224:225], v251 offset:3328
    ds_read_b64_tr_b16 v[226:227], v251 offset:3840
    v_mfma_f32_32x32x16_bf16 v[192:207], v[212:215], v[20:23], v[192:207]
    ds_read_b64_tr_b16 v[228:229], v251 offset:3360
    ds_read_b64_tr_b16 v[230:231], v251 offset:3872
    ds_read_b128 v[232:235], v254 offset:0
    ds_read_b128 v[236:239], v254 offset:32
    ds_read_b128 v[240:243], v254 offset:64
    ds_read_b128 v[244:247], v254 offset:96
    s_waitcnt lgkmcnt(8)
    v_mfma_f32_32x32x16_bf16 v[176:191], v[216:219], v[24:27], v[176:191]
    ds_read_b64_tr_b16 v[208:209], v251 offset:4352
    ds_read_b64_tr_b16 v[210:211], v251 offset:4864
    v_mfma_f32_32x32x16_bf16 v[192:207], v[220:223], v[24:27], v[192:207]
    ds_read_b64_tr_b16 v[212:213], v251 offset:4384
    ds_read_b64_tr_b16 v[214:215], v251 offset:4896
    s_waitcnt lgkmcnt(4)
    v_fma_f32 v144, v232, v248, v144
    v_fma_f32 v145, v233, v248, v145
    v_mfma_f32_32x32x16_bf16 v[176:191], v[224:227], v[28:31], v[176:191]
    ds_read_b64_tr_b16 v[216:217], v251 offset:5376
    ds_read_b64_tr_b16 v[218:219], v251 offset:5888
    v_fma_f32 v146, v234, v248, v146
    v_fma_f32 v147, v235, v248, v147
    v_fma_f32 v148, v236, v248, v148
    v_mfma_f32_32x32x16_bf16 v[192:207], v[228:231], v[28:31], v[192:207]
    ds_read_b64_tr_b16 v[220:221], v251 offset:5408
    ds_read_b64_tr_b16 v[222:223], v251 offset:5920
    v_fma_f32 v149, v237, v248, v149
    v_fma_f32 v150, v238, v248, v150
    v_fma_f32 v151, v239, v248, v151
    s_waitcnt lgkmcnt(4)
    v_mfma_f32_32x32x16_bf16 v[176:191], v[208:211], v[32:35], v[176:191]
    ds_read_b64_tr_b16 v[224:225], v251 offset:6400
    ds_read_b64_tr_b16 v[226:227], v251 offset:6912
    v_fma_f32 v152, v240, v248, v152
    v_fma_f32 v153, v241, v248, v153
    v_fma_f32 v154, v242, v248, v154
    v_mfma_f32_32x32x16_bf16 v[192:207], v[212:215], v[32:35], v[192:207]
    ds_read_b64_tr_b16 v[228:229], v251 offset:6432
    ds_read_b64_tr_b16 v[230:231], v251 offset:6944
    v_fma_f32 v155, v243, v248, v155
    v_fma_f32 v156, v244, v248, v156
    v_fma_f32 v157, v245, v248, v157
    s_waitcnt lgkmcnt(4)
    v_mfma_f32_32x32x16_bf16 v[176:191], v[216:219], v[36:39], v[176:191]
    ds_read_b64_tr_b16 v[208:209], v251 offset:7424
    ds_read_b64_tr_b16 v[210:211], v251 offset:7936
    v_fma_f32 v158, v246, v248, v158
    v_fma_f32 v159, v247, v248, v159
    v_mul_f32 v240, v144, v252
    v_mfma_f32_32x32x16_bf16 v[192:207], v[220:223], v[36:39], v[192:207]
    ds_read_b64_tr_b16 v[212:213], v251 offset:7456
    ds_read_b64_tr_b16 v[214:215], v251 offset:7968
    v_mul_f32 v241, v145, v252
    v_mul_f32 v242, v146, v252
    v_mul_f32 v243, v147, v252
    s_waitcnt lgkmcnt(4)
    v_mfma_f32_32x32x16_bf16 v[176:191], v[224:227], v[40:43], v[176:191]
    ds_read_b64_tr_b16 v[216:217], v251 offset:16704
    ds_read_b64_tr_b16 v[218:219], v251 offset:17216
    v_mul_f32 v244, v148, v252
    v_mul_f32 v245, v149, v252
    v_mul_f32 v246, v150, v252
    v_mfma_f32_32x32x16_bf16 v[192:207], v[228:231], v[40:43], v[192:207]
    ds_read_b64_tr_b16 v[220:221], v251 offset:16736
    ds_read_b64_tr_b16 v[222:223], v251 offset:17248
    v_mul_f32 v247, v151, v252
    v_exp_f32 v240, v240
    s_waitcnt lgkmcnt(4)
    v_mfma_f32_32x32x16_bf16 v[176:191], v[208:211], v[44:47], v[176:191]
    ds_read_b64_tr_b16 v[224:225], v251 offset:17728
    ds_read_b64_tr_b16 v[226:227], v251 offset:18240
    v_mul_f32 v144, v144, v152
    v_exp_f32 v241, v241
    v_mfma_f32_32x32x16_bf16 v[192:207], v[212:215], v[44:47], v[192:207]
    ds_read_b64_tr_b16 v[228:229], v251 offset:17760
    ds_read_b64_tr_b16 v[230:231], v251 offset:18272
    v_mul_f32 v145, v145, v153
    v_exp_f32 v242, v242
    s_waitcnt lgkmcnt(4)
    v_mfma_f32_32x32x16_bf16 v[176:191], v[216:219], v[48:51], v[176:191]
    ds_read_b64_tr_b16 v[208:209], v251 offset:18752
    ds_read_b64_tr_b16 v[210:211], v251 offset:19264
    v_mul_f32 v146, v146, v154
    v_exp_f32 v243, v243
    v_mfma_f32_32x32x16_bf16 v[192:207], v[220:223], v[48:51], v[192:207]
    ds_read_b64_tr_b16 v[212:213], v251 offset:18784
    ds_read_b64_tr_b16 v[214:215], v251 offset:19296
    v_mul_f32 v147, v147, v155
    v_exp_f32 v244, v244
    s_waitcnt lgkmcnt(4)
    v_mfma_f32_32x32x16_bf16 v[176:191], v[224:227], v[52:55], v[176:191]
    ds_read_b64_tr_b16 v[216:217], v251 offset:19776
    ds_read_b64_tr_b16 v[218:219], v251 offset:20288
    v_mul_f32 v148, v148, v156
    v_exp_f32 v245, v245
    v_mfma_f32_32x32x16_bf16 v[192:207], v[228:231], v[52:55], v[192:207]
    ds_read_b64_tr_b16 v[220:221], v251 offset:19808
    ds_read_b64_tr_b16 v[222:223], v251 offset:20320
    v_mul_f32 v149, v149, v157
    v_exp_f32 v246, v246
    s_waitcnt lgkmcnt(4)
    v_mfma_f32_32x32x16_bf16 v[176:191], v[208:211], v[56:59], v[176:191]
    ds_read_b64_tr_b16 v[224:225], v251 offset:20800
    ds_read_b64_tr_b16 v[226:227], v251 offset:21312
    v_mul_f32 v150, v150, v158
    v_exp_f32 v247, v247
    v_mfma_f32_32x32x16_bf16 v[192:207], v[212:215], v[56:59], v[192:207]
    ds_read_b64_tr_b16 v[228:229], v251 offset:20832
    ds_read_b64_tr_b16 v[230:231], v251 offset:21344
    v_mul_f32 v151, v151, v159
    v_fma_f32 v240, v240, v250, v250
    v_fma_f32 v241, v241, v250, v250
    s_waitcnt lgkmcnt(4)
    v_mfma_f32_32x32x16_bf16 v[176:191], v[216:219], v[60:63], v[176:191]
    ds_read_b64_tr_b16 v[208:209], v251 offset:21824
    ds_read_b64_tr_b16 v[210:211], v251 offset:22336
    v_fma_f32 v242, v242, v250, v250
    v_fma_f32 v243, v243, v250, v250
    v_fma_f32 v244, v244, v250, v250
    v_mfma_f32_32x32x16_bf16 v[192:207], v[220:223], v[60:63], v[192:207]
    ds_read_b64_tr_b16 v[212:213], v251 offset:21856
    ds_read_b64_tr_b16 v[214:215], v251 offset:22368
    v_fma_f32 v245, v245, v250, v250
    v_fma_f32 v246, v246, v250, v250
    v_fma_f32 v247, v247, v250, v250
    s_waitcnt lgkmcnt(4)
    v_mfma_f32_32x32x16_bf16 v[176:191], v[224:227], v[64:67], v[176:191]
    ds_read_b64_tr_b16 v[216:217], v251 offset:22848
    ds_read_b64_tr_b16 v[218:219], v251 offset:23360
    v_rcp_f32 v240, v240
    v_mfma_f32_32x32x16_bf16 v[192:207], v[228:231], v[64:67], v[192:207]
    ds_read_b64_tr_b16 v[220:221], v251 offset:22880
    ds_read_b64_tr_b16 v[222:223], v251 offset:23392
    v_rcp_f32 v241, v241
    s_waitcnt lgkmcnt(4)
    v_mfma_f32_32x32x16_bf16 v[176:191], v[208:211], v[68:71], v[176:191]
    ds_read_b64_tr_b16 v[224:225], v251 offset:23872
    ds_read_b64_tr_b16 v[226:227], v251 offset:24384
    v_rcp_f32 v242, v242
    v_mul_f32 v144, v144, v240
    v_mfma_f32_32x32x16_bf16 v[192:207], v[212:215], v[68:71], v[192:207]
    ds_read_b64_tr_b16 v[228:229], v251 offset:23904
    ds_read_b64_tr_b16 v[230:231], v251 offset:24416
    v_rcp_f32 v243, v243
    v_mul_f32 v145, v145, v241
    s_waitcnt lgkmcnt(4)
    v_mfma_f32_32x32x16_bf16 v[176:191], v[216:219], v[72:75], v[176:191]
    ds_read_b64_tr_b16 v[208:209], v251 offset:33152
    ds_read_b64_tr_b16 v[210:211], v251 offset:33664
    v_rcp_f32 v244, v244
    v_mul_f32 v146, v146, v242
    v_mfma_f32_32x32x16_bf16 v[192:207], v[220:223], v[72:75], v[192:207]
    ds_read_b64_tr_b16 v[212:213], v251 offset:33184
    ds_read_b64_tr_b16 v[214:215], v251 offset:33696
    v_rcp_f32 v245, v245
    v_mul_f32 v147, v147, v243
    s_waitcnt lgkmcnt(4)
    v_mfma_f32_32x32x16_bf16 v[176:191], v[224:227], v[76:79], v[176:191]
    ds_read_b64_tr_b16 v[216:217], v251 offset:34176
    ds_read_b64_tr_b16 v[218:219], v251 offset:34688
    v_rcp_f32 v246, v246
    v_mul_f32 v148, v148, v244
    v_mfma_f32_32x32x16_bf16 v[192:207], v[228:231], v[76:79], v[192:207]
    ds_read_b64_tr_b16 v[220:221], v251 offset:34208
    ds_read_b64_tr_b16 v[222:223], v251 offset:34720
    v_rcp_f32 v247, v247
    v_mul_f32 v149, v149, v245
    s_waitcnt lgkmcnt(4)
    v_mfma_f32_32x32x16_bf16 v[176:191], v[208:211], v[80:83], v[176:191]
    ds_read_b64_tr_b16 v[224:225], v251 offset:35200
    ds_read_b64_tr_b16 v[226:227], v251 offset:35712
    v_mul_f32 v150, v150, v246
    v_cvt_pk_bf16_f32 v152, v144, v145
    v_mul_f32 v151, v151, v247
    v_mfma_f32_32x32x16_bf16 v[192:207], v[212:215], v[80:83], v[192:207]
    ds_read_b64_tr_b16 v[228:229], v251 offset:35232
    ds_read_b64_tr_b16 v[230:231], v251 offset:35744
    v_cvt_pk_bf16_f32 v153, v146, v147
    v_cvt_pk_bf16_f32 v154, v148, v149
    v_cvt_pk_bf16_f32 v155, v150, v151
    s_waitcnt lgkmcnt(4)
    v_mfma_f32_32x32x16_bf16 v[176:191], v[216:219], v[84:87], v[176:191]
    ds_read_b64_tr_b16 v[208:209], v251 offset:36224
    ds_read_b64_tr_b16 v[210:211], v251 offset:36736
    v_min_u32 v155, -2, v155
    s_cmp_lg_u32 s66, 0
    s_cbranch_scc1 L_wt_137
    buffer_store_dwordx4 v[152:155], v1, s[8:11], s53 offen offset:0
L_wb_138:
    v_mfma_f32_32x32x16_bf16 v[192:207], v[220:223], v[84:87], v[192:207]
    ds_read_b64_tr_b16 v[212:213], v251 offset:36256
    ds_read_b64_tr_b16 v[214:215], v251 offset:36768
    s_waitcnt lgkmcnt(4)
    v_mfma_f32_32x32x16_bf16 v[176:191], v[224:227], v[88:91], v[176:191]
    ds_read_b64_tr_b16 v[216:217], v251 offset:37248
    ds_read_b64_tr_b16 v[218:219], v251 offset:37760
    ds_read_b128 v[232:235], v254 offset:128
    ds_read_b128 v[236:239], v254 offset:160
    ds_read_b128 v[240:243], v254 offset:192
    ds_read_b128 v[244:247], v254 offset:224
    v_mfma_f32_32x32x16_bf16 v[192:207], v[228:231], v[88:91], v[192:207]
    ds_read_b64_tr_b16 v[220:221], v251 offset:37280
    ds_read_b64_tr_b16 v[222:223], v251 offset:37792
    s_waitcnt lgkmcnt(8)
    v_mfma_f32_32x32x16_bf16 v[176:191], v[208:211], v[92:95], v[176:191]
    ds_read_b64_tr_b16 v[224:225], v251 offset:38272
    ds_read_b64_tr_b16 v[226:227], v251 offset:38784
    s_waitcnt lgkmcnt(4)
    v_fma_f32 v160, v232, v248, v160
    v_fma_f32 v161, v233, v248, v161
    v_mfma_f32_32x32x16_bf16 v[192:207], v[212:215], v[92:95], v[192:207]
    ds_read_b64_tr_b16 v[228:229], v251 offset:38304
    ds_read_b64_tr_b16 v[230:231], v251 offset:38816
    v_fma_f32 v162, v234, v248, v162
    v_fma_f32 v163, v235, v248, v163
    v_fma_f32 v164, v236, v248, v164
    s_waitcnt lgkmcnt(4)
    v_mfma_f32_32x32x16_bf16 v[176:191], v[216:219], v[96:99], v[176:191]
    ds_read_b64_tr_b16 v[208:209], v251 offset:39296
    ds_read_b64_tr_b16 v[210:211], v251 offset:39808
    v_fma_f32 v165, v237, v248, v165
    v_fma_f32 v166, v238, v248, v166
    v_fma_f32 v167, v239, v248, v167
    v_mfma_f32_32x32x16_bf16 v[192:207], v[220:223], v[96:99], v[192:207]
    ds_read_b64_tr_b16 v[212:213], v251 offset:39328
    ds_read_b64_tr_b16 v[214:215], v251 offset:39840
    v_fma_f32 v168, v240, v248, v168
    v_fma_f32 v169, v241, v248, v169
    v_fma_f32 v170, v242, v248, v170
    s_waitcnt lgkmcnt(4)
    v_mfma_f32_32x32x16_bf16 v[176:191], v[224:227], v[100:103], v[176:191]
    ds_read_b64_tr_b16 v[216:217], v251 offset:40320
    ds_read_b64_tr_b16 v[218:219], v251 offset:40832
    v_fma_f32 v171, v243, v248, v171
    v_fma_f32 v172, v244, v248, v172
    v_fma_f32 v173, v245, v248, v173
    v_mfma_f32_32x32x16_bf16 v[192:207], v[228:231], v[100:103], v[192:207]
    ds_read_b64_tr_b16 v[220:221], v251 offset:40352
    ds_read_b64_tr_b16 v[222:223], v251 offset:40864
    v_fma_f32 v174, v246, v248, v174
    v_fma_f32 v175, v247, v248, v175
    v_mul_f32 v240, v160, v252
    s_waitcnt lgkmcnt(4)
    v_mfma_f32_32x32x16_bf16 v[176:191], v[208:211], v[104:107], v[176:191]
    ds_read_b64_tr_b16 v[224:225], v251 offset:49600
    ds_read_b64_tr_b16 v[226:227], v251 offset:50112
    v_mul_f32 v241, v161, v252
    v_mul_f32 v242, v162, v252
    v_mul_f32 v243, v163, v252
    v_mfma_f32_32x32x16_bf16 v[192:207], v[212:215], v[104:107], v[192:207]
    ds_read_b64_tr_b16 v[228:229], v251 offset:49632
    ds_read_b64_tr_b16 v[230:231], v251 offset:50144
    v_mul_f32 v244, v164, v252
    v_mul_f32 v245, v165, v252
    v_mul_f32 v246, v166, v252
    s_waitcnt lgkmcnt(4)
    v_mfma_f32_32x32x16_bf16 v[176:191], v[216:219], v[108:111], v[176:191]
    ds_read_b64_tr_b16 v[208:209], v251 offset:50624
    ds_read_b64_tr_b16 v[210:211], v251 offset:51136
    v_mul_f32 v247, v167, v252
    v_exp_f32 v240, v240
    v_mfma_f32_32x32x16_bf16 v[192:207], v[220:223], v[108:111], v[192:207]
    ds_read_b64_tr_b16 v[212:213], v251 offset:50656
    ds_read_b64_tr_b16 v[214:215], v251 offset:51168
    v_mul_f32 v160, v160, v168
    v_exp_f32 v241, v241
    s_waitcnt lgkmcnt(4)
    v_mfma_f32_32x32x16_bf16 v[176:191], v[224:227], v[112:115], v[176:191]
    ds_read_b64_tr_b16 v[216:217], v251 offset:51648
    ds_read_b64_tr_b16 v[218:219], v251 offset:52160
    v_mul_f32 v161, v161, v169
    v_exp_f32 v242, v242
    v_mfma_f32_32x32x16_bf16 v[192:207], v[228:231], v[112:115], v[192:207]
    ds_read_b64_tr_b16 v[220:221], v251 offset:51680
    ds_read_b64_tr_b16 v[222:223], v251 offset:52192
    v_mul_f32 v162, v162, v170
    v_exp_f32 v243, v243
    s_waitcnt lgkmcnt(4)
    v_mfma_f32_32x32x16_bf16 v[176:191], v[208:211], v[116:119], v[176:191]
    ds_read_b64_tr_b16 v[224:225], v251 offset:52672
    ds_read_b64_tr_b16 v[226:227], v251 offset:53184
    v_mul_f32 v163, v163, v171
    v_exp_f32 v244, v244
    v_mfma_f32_32x32x16_bf16 v[192:207], v[212:215], v[116:119], v[192:207]
    ds_read_b64_tr_b16 v[228:229], v251 offset:52704
    ds_read_b64_tr_b16 v[230:231], v251 offset:53216
    v_mul_f32 v164, v164, v172
    v_exp_f32 v245, v245
    s_waitcnt lgkmcnt(4)
    v_mfma_f32_32x32x16_bf16 v[176:191], v[216:219], v[120:123], v[176:191]
    ds_read_b64_tr_b16 v[208:209], v251 offset:53696
    ds_read_b64_tr_b16 v[210:211], v251 offset:54208
    v_mul_f32 v165, v165, v173
    v_exp_f32 v246, v246
    v_mfma_f32_32x32x16_bf16 v[192:207], v[220:223], v[120:123], v[192:207]
    ds_read_b64_tr_b16 v[212:213], v251 offset:53728
    ds_read_b64_tr_b16 v[214:215], v251 offset:54240
    v_mul_f32 v166, v166, v174
    v_exp_f32 v247, v247
    s_waitcnt lgkmcnt(4)
    v_mfma_f32_32x32x16_bf16 v[176:191], v[224:227], v[124:127], v[176:191]
    ds_read_b64_tr_b16 v[216:217], v251 offset:54720
    ds_read_b64_tr_b16 v[218:219], v251 offset:55232
    v_mul_f32 v167, v167, v175
    v_fma_f32 v240, v240, v250, v250
    v_fma_f32 v241, v241, v250, v250
    v_mfma_f32_32x32x16_bf16 v[192:207], v[228:231], v[124:127], v[192:207]
    ds_read_b64_tr_b16 v[220:221], v251 offset:54752
    ds_read_b64_tr_b16 v[222:223], v251 offset:55264
    v_fma_f32 v242, v242, v250, v250
    v_fma_f32 v243, v243, v250, v250
    v_fma_f32 v244, v244, v250, v250
    s_waitcnt lgkmcnt(4)
    v_mfma_f32_32x32x16_bf16 v[176:191], v[208:211], v[128:131], v[176:191]
    ds_read_b64_tr_b16 v[224:225], v251 offset:55744
    ds_read_b64_tr_b16 v[226:227], v251 offset:56256
    v_fma_f32 v245, v245, v250, v250
    v_fma_f32 v246, v246, v250, v250
    v_fma_f32 v247, v247, v250, v250
    v_mfma_f32_32x32x16_bf16 v[192:207], v[212:215], v[128:131], v[192:207]
    ds_read_b64_tr_b16 v[228:229], v251 offset:55776
    ds_read_b64_tr_b16 v[230:231], v251 offset:56288
    v_rcp_f32 v240, v240
    s_waitcnt lgkmcnt(4)
    v_mfma_f32_32x32x16_bf16 v[176:191], v[216:219], v[132:135], v[176:191]
    ds_read_b64_tr_b16 v[208:209], v251 offset:56768
    ds_read_b64_tr_b16 v[210:211], v251 offset:57280
    v_rcp_f32 v241, v241
    v_mfma_f32_32x32x16_bf16 v[192:207], v[220:223], v[132:135], v[192:207]
    ds_read_b64_tr_b16 v[212:213], v251 offset:56800
    ds_read_b64_tr_b16 v[214:215], v251 offset:57312
    v_rcp_f32 v242, v242
    v_mul_f32 v160, v160, v240
    s_waitcnt lgkmcnt(4)
    v_mfma_f32_32x32x16_bf16 v[176:191], v[224:227], v[136:139], v[176:191]
    ds_read_b64_tr_b16 v[216:217], v253 offset:512
    ds_read_b64_tr_b16 v[218:219], v253 offset:1024
    v_rcp_f32 v243, v243
    v_mul_f32 v161, v161, v241
    v_mfma_f32_32x32x16_bf16 v[192:207], v[228:231], v[136:139], v[192:207]
    ds_read_b64_tr_b16 v[220:221], v253 offset:544
    ds_read_b64_tr_b16 v[222:223], v253 offset:1056
    v_rcp_f32 v244, v244
    v_mul_f32 v162, v162, v242
    s_waitcnt lgkmcnt(4)
    v_mfma_f32_32x32x16_bf16 v[176:191], v[208:211], v[140:143], v[176:191]
    ds_read_b64_tr_b16 v[224:225], v253 offset:1536
    ds_read_b64_tr_b16 v[226:227], v253 offset:2048
    v_rcp_f32 v245, v245
    v_mul_f32 v163, v163, v243
    v_mfma_f32_32x32x16_bf16 v[192:207], v[212:215], v[140:143], v[192:207]
    ds_read_b64_tr_b16 v[228:229], v253 offset:1568
    ds_read_b64_tr_b16 v[230:231], v253 offset:2080
    v_rcp_f32 v246, v246
    v_mul_f32 v164, v164, v244
    v_rcp_f32 v247, v247
    v_mul_f32 v165, v165, v245
    v_mul_f32 v166, v166, v246
    v_cvt_pk_bf16_f32 v168, v160, v161
    v_mul_f32 v167, v167, v247
    v_cvt_pk_bf16_f32 v169, v162, v163
    v_cvt_pk_bf16_f32 v170, v164, v165
    v_cvt_pk_bf16_f32 v171, v166, v167
    v_min_u32 v171, -2, v171
    s_cmp_lg_u32 s66, 0
    s_cbranch_scc1 L_wt_139
    buffer_store_dwordx4 v[168:171], v1, s[8:11], s53 offen offset:1024
L_wb_140:
    s_barrier
    s_waitcnt lgkmcnt(4)
    v_mfma_f32_32x32x16_bf16 v[144:159], v[216:219], v[16:19], 0
    ds_read_b64_tr_b16 v[208:209], v253 offset:2560
    ds_read_b64_tr_b16 v[210:211], v253 offset:3072
    v_mfma_f32_32x32x16_bf16 v[160:175], v[220:223], v[16:19], 0
    ds_read_b64_tr_b16 v[212:213], v253 offset:2592
    ds_read_b64_tr_b16 v[214:215], v253 offset:3104
    s_waitcnt lgkmcnt(4)
    v_mfma_f32_32x32x16_bf16 v[144:159], v[224:227], v[20:23], v[144:159]
    ds_read_b64_tr_b16 v[216:217], v253 offset:3584
    ds_read_b64_tr_b16 v[218:219], v253 offset:4096
    v_mfma_f32_32x32x16_bf16 v[160:175], v[228:231], v[20:23], v[160:175]
    ds_read_b64_tr_b16 v[220:221], v253 offset:3616
    ds_read_b64_tr_b16 v[222:223], v253 offset:4128
    ds_read_b128 v[232:235], v254 offset:256
    ds_read_b128 v[236:239], v254 offset:288
    ds_read_b128 v[240:243], v254 offset:320
    ds_read_b128 v[244:247], v254 offset:352
    s_waitcnt lgkmcnt(8)
    v_mfma_f32_32x32x16_bf16 v[144:159], v[208:211], v[24:27], v[144:159]
    ds_read_b64_tr_b16 v[224:225], v253 offset:4608
    ds_read_b64_tr_b16 v[226:227], v253 offset:5120
    v_mfma_f32_32x32x16_bf16 v[160:175], v[212:215], v[24:27], v[160:175]
    ds_read_b64_tr_b16 v[228:229], v253 offset:4640
    ds_read_b64_tr_b16 v[230:231], v253 offset:5152
    s_waitcnt lgkmcnt(4)
    v_fma_f32 v176, v232, v248, v176
    v_fma_f32 v177, v233, v248, v177
    v_mfma_f32_32x32x16_bf16 v[144:159], v[216:219], v[28:31], v[144:159]
    ds_read_b64_tr_b16 v[208:209], v253 offset:5632
    ds_read_b64_tr_b16 v[210:211], v253 offset:6144
    v_fma_f32 v178, v234, v248, v178
    v_fma_f32 v179, v235, v248, v179
    v_fma_f32 v180, v236, v248, v180
    v_mfma_f32_32x32x16_bf16 v[160:175], v[220:223], v[28:31], v[160:175]
    ds_read_b64_tr_b16 v[212:213], v253 offset:5664
    ds_read_b64_tr_b16 v[214:215], v253 offset:6176
    v_fma_f32 v181, v237, v248, v181
    v_fma_f32 v182, v238, v248, v182
    v_fma_f32 v183, v239, v248, v183
    s_waitcnt lgkmcnt(4)
    v_mfma_f32_32x32x16_bf16 v[144:159], v[224:227], v[32:35], v[144:159]
    ds_read_b64_tr_b16 v[216:217], v253 offset:6656
    ds_read_b64_tr_b16 v[218:219], v253 offset:7168
    v_fma_f32 v184, v240, v248, v184
    v_fma_f32 v185, v241, v248, v185
    v_fma_f32 v186, v242, v248, v186
    v_mfma_f32_32x32x16_bf16 v[160:175], v[228:231], v[32:35], v[160:175]
    ds_read_b64_tr_b16 v[220:221], v253 offset:6688
    ds_read_b64_tr_b16 v[222:223], v253 offset:7200
    v_fma_f32 v187, v243, v248, v187
    v_fma_f32 v188, v244, v248, v188
    v_fma_f32 v189, v245, v248, v189
    s_waitcnt lgkmcnt(4)
    v_mfma_f32_32x32x16_bf16 v[144:159], v[208:211], v[36:39], v[144:159]
    ds_read_b64_tr_b16 v[224:225], v253 offset:7680
    ds_read_b64_tr_b16 v[226:227], v253 offset:8192
    v_fma_f32 v190, v246, v248, v190
    v_fma_f32 v191, v247, v248, v191
    v_mul_f32 v240, v176, v252
    v_mfma_f32_32x32x16_bf16 v[160:175], v[212:215], v[36:39], v[160:175]
    ds_read_b64_tr_b16 v[228:229], v253 offset:7712
    ds_read_b64_tr_b16 v[230:231], v253 offset:8224
    v_mul_f32 v241, v177, v252
    v_mul_f32 v242, v178, v252
    v_mul_f32 v243, v179, v252
    s_waitcnt lgkmcnt(4)
    v_mfma_f32_32x32x16_bf16 v[144:159], v[216:219], v[40:43], v[144:159]
    ds_read_b64_tr_b16 v[208:209], v249 offset:0
    ds_read_b64_tr_b16 v[210:211], v249 offset:512
    v_mul_f32 v244, v180, v252
    v_mul_f32 v245, v181, v252
    v_mul_f32 v246, v182, v252
    v_mfma_f32_32x32x16_bf16 v[160:175], v[220:223], v[40:43], v[160:175]
    ds_read_b64_tr_b16 v[212:213], v249 offset:32
    ds_read_b64_tr_b16 v[214:215], v249 offset:544
    v_mul_f32 v247, v183, v252
    v_exp_f32 v240, v240
    s_waitcnt lgkmcnt(4)
    v_mfma_f32_32x32x16_bf16 v[144:159], v[224:227], v[44:47], v[144:159]
    ds_read_b64_tr_b16 v[216:217], v249 offset:1024
    ds_read_b64_tr_b16 v[218:219], v249 offset:1536
    v_mul_f32 v176, v176, v184
    v_exp_f32 v241, v241
    v_mfma_f32_32x32x16_bf16 v[160:175], v[228:231], v[44:47], v[160:175]
    ds_read_b64_tr_b16 v[220:221], v249 offset:1056
    ds_read_b64_tr_b16 v[222:223], v249 offset:1568
    v_mul_f32 v177, v177, v185
    v_exp_f32 v242, v242
    s_waitcnt lgkmcnt(4)
    v_mfma_f32_32x32x16_bf16 v[144:159], v[208:211], v[48:51], v[144:159]
    ds_read_b64_tr_b16 v[224:225], v249 offset:2048
    ds_read_b64_tr_b16 v[226:227], v249 offset:2560
    v_mul_f32 v178, v178, v186
    v_exp_f32 v243, v243
    v_mfma_f32_32x32x16_bf16 v[160:175], v[212:215], v[48:51], v[160:175]
    ds_read_b64_tr_b16 v[228:229], v249 offset:2080
    ds_read_b64_tr_b16 v[230:231], v249 offset:2592
    v_mul_f32 v179, v179, v187
    v_exp_f32 v244, v244
    s_waitcnt lgkmcnt(4)
    v_mfma_f32_32x32x16_bf16 v[144:159], v[216:219], v[52:55], v[144:159]
    ds_read_b64_tr_b16 v[208:209], v249 offset:3072
    ds_read_b64_tr_b16 v[210:211], v249 offset:3584
    v_mul_f32 v180, v180, v188
    v_exp_f32 v245, v245
    v_mfma_f32_32x32x16_bf16 v[160:175], v[220:223], v[52:55], v[160:175]
    ds_read_b64_tr_b16 v[212:213], v249 offset:3104
    ds_read_b64_tr_b16 v[214:215], v249 offset:3616
    v_mul_f32 v181, v181, v189
    v_exp_f32 v246, v246
    s_waitcnt lgkmcnt(4)
    v_mfma_f32_32x32x16_bf16 v[144:159], v[224:227], v[56:59], v[144:159]
    ds_read_b64_tr_b16 v[216:217], v249 offset:4096
    ds_read_b64_tr_b16 v[218:219], v249 offset:4608
    v_mul_f32 v182, v182, v190
    v_exp_f32 v247, v247
    v_mfma_f32_32x32x16_bf16 v[160:175], v[228:231], v[56:59], v[160:175]
    ds_read_b64_tr_b16 v[220:221], v249 offset:4128
    ds_read_b64_tr_b16 v[222:223], v249 offset:4640
    v_mul_f32 v183, v183, v191
    v_fma_f32 v240, v240, v250, v250
    v_fma_f32 v241, v241, v250, v250
    s_waitcnt lgkmcnt(4)
    v_mfma_f32_32x32x16_bf16 v[144:159], v[208:211], v[60:63], v[144:159]
    ds_read_b64_tr_b16 v[224:225], v249 offset:5120
    ds_read_b64_tr_b16 v[226:227], v249 offset:5632
    v_fma_f32 v242, v242, v250, v250
    v_fma_f32 v243, v243, v250, v250
    v_fma_f32 v244, v244, v250, v250
    v_mfma_f32_32x32x16_bf16 v[160:175], v[212:215], v[60:63], v[160:175]
    ds_read_b64_tr_b16 v[228:229], v249 offset:5152
    ds_read_b64_tr_b16 v[230:231], v249 offset:5664
    v_fma_f32 v245, v245, v250, v250
    v_fma_f32 v246, v246, v250, v250
    v_fma_f32 v247, v247, v250, v250
    s_waitcnt lgkmcnt(4)
    v_mfma_f32_32x32x16_bf16 v[144:159], v[216:219], v[64:67], v[144:159]
    ds_read_b64_tr_b16 v[208:209], v249 offset:6144
    ds_read_b64_tr_b16 v[210:211], v249 offset:6656
    v_rcp_f32 v240, v240
    v_mfma_f32_32x32x16_bf16 v[160:175], v[220:223], v[64:67], v[160:175]
    ds_read_b64_tr_b16 v[212:213], v249 offset:6176
    ds_read_b64_tr_b16 v[214:215], v249 offset:6688
    v_rcp_f32 v241, v241
    s_waitcnt lgkmcnt(4)
    v_mfma_f32_32x32x16_bf16 v[144:159], v[224:227], v[68:71], v[144:159]
    ds_read_b64_tr_b16 v[216:217], v249 offset:7168
    ds_read_b64_tr_b16 v[218:219], v249 offset:7680
    v_rcp_f32 v242, v242
    v_mul_f32 v176, v176, v240
    v_mfma_f32_32x32x16_bf16 v[160:175], v[228:231], v[68:71], v[160:175]
    ds_read_b64_tr_b16 v[220:221], v249 offset:7200
    ds_read_b64_tr_b16 v[222:223], v249 offset:7712
    v_rcp_f32 v243, v243
    v_mul_f32 v177, v177, v241
    s_waitcnt lgkmcnt(4)
    v_mfma_f32_32x32x16_bf16 v[144:159], v[208:211], v[72:75], v[144:159]
    ds_read_b64_tr_b16 v[224:225], v249 offset:16448
    ds_read_b64_tr_b16 v[226:227], v249 offset:16960
    v_rcp_f32 v244, v244
    v_mul_f32 v178, v178, v242
    v_mfma_f32_32x32x16_bf16 v[160:175], v[212:215], v[72:75], v[160:175]
    ds_read_b64_tr_b16 v[228:229], v249 offset:16480
    ds_read_b64_tr_b16 v[230:231], v249 offset:16992
    v_rcp_f32 v245, v245
    v_mul_f32 v179, v179, v243
    s_waitcnt lgkmcnt(4)
    v_mfma_f32_32x32x16_bf16 v[144:159], v[216:219], v[76:79], v[144:159]
    ds_read_b64_tr_b16 v[208:209], v249 offset:17472
    ds_read_b64_tr_b16 v[210:211], v249 offset:17984
    v_rcp_f32 v246, v246
    v_mul_f32 v180, v180, v244
    v_mfma_f32_32x32x16_bf16 v[160:175], v[220:223], v[76:79], v[160:175]
    ds_read_b64_tr_b16 v[212:213], v249 offset:17504
    ds_read_b64_tr_b16 v[214:215], v249 offset:18016
    v_rcp_f32 v247, v247
    v_mul_f32 v181, v181, v245
    s_waitcnt lgkmcnt(4)
    v_mfma_f32_32x32x16_bf16 v[144:159], v[224:227], v[80:83], v[144:159]
    ds_read_b64_tr_b16 v[216:217], v249 offset:18496
    ds_read_b64_tr_b16 v[218:219], v249 offset:19008
    v_mul_f32 v182, v182, v246
    v_cvt_pk_bf16_f32 v184, v176, v177
    v_mul_f32 v183, v183, v247
    v_mfma_f32_32x32x16_bf16 v[160:175], v[228:231], v[80:83], v[160:175]
    ds_read_b64_tr_b16 v[220:221], v249 offset:18528
    ds_read_b64_tr_b16 v[222:223], v249 offset:19040
    v_cvt_pk_bf16_f32 v185, v178, v179
    v_cvt_pk_bf16_f32 v186, v180, v181
    v_cvt_pk_bf16_f32 v187, v182, v183
    s_waitcnt lgkmcnt(4)
    v_mfma_f32_32x32x16_bf16 v[144:159], v[208:211], v[84:87], v[144:159]
    ds_read_b64_tr_b16 v[224:225], v249 offset:19520
    ds_read_b64_tr_b16 v[226:227], v249 offset:20032
    v_min_u32 v187, -2, v187
    s_cmp_lg_u32 s66, 0
    s_cbranch_scc1 L_wt_141
    buffer_store_dwordx4 v[184:187], v1, s[8:11], s54 offen offset:0
L_wb_142:
    v_mfma_f32_32x32x16_bf16 v[160:175], v[212:215], v[84:87], v[160:175]
    ds_read_b64_tr_b16 v[228:229], v249 offset:19552
    ds_read_b64_tr_b16 v[230:231], v249 offset:20064
    s_waitcnt lgkmcnt(4)
    v_mfma_f32_32x32x16_bf16 v[144:159], v[216:219], v[88:91], v[144:159]
    ds_read_b64_tr_b16 v[208:209], v249 offset:20544
    ds_read_b64_tr_b16 v[210:211], v249 offset:21056
    ds_read_b128 v[232:235], v254 offset:384
    ds_read_b128 v[236:239], v254 offset:416
    ds_read_b128 v[240:243], v254 offset:448
    ds_read_b128 v[244:247], v254 offset:480
    v_mfma_f32_32x32x16_bf16 v[160:175], v[220:223], v[88:91], v[160:175]
    ds_read_b64_tr_b16 v[212:213], v249 offset:20576
    ds_read_b64_tr_b16 v[214:215], v249 offset:21088
    s_waitcnt lgkmcnt(8)
    v_mfma_f32_32x32x16_bf16 v[144:159], v[224:227], v[92:95], v[144:159]
    ds_read_b64_tr_b16 v[216:217], v249 offset:21568
    ds_read_b64_tr_b16 v[218:219], v249 offset:22080
    s_waitcnt lgkmcnt(4)
    v_fma_f32 v192, v232, v248, v192
    v_fma_f32 v193, v233, v248, v193
    v_mfma_f32_32x32x16_bf16 v[160:175], v[228:231], v[92:95], v[160:175]
    ds_read_b64_tr_b16 v[220:221], v249 offset:21600
    ds_read_b64_tr_b16 v[222:223], v249 offset:22112
    v_fma_f32 v194, v234, v248, v194
    v_fma_f32 v195, v235, v248, v195
    v_fma_f32 v196, v236, v248, v196
    s_waitcnt lgkmcnt(4)
    v_mfma_f32_32x32x16_bf16 v[144:159], v[208:211], v[96:99], v[144:159]
    ds_read_b64_tr_b16 v[224:225], v249 offset:22592
    ds_read_b64_tr_b16 v[226:227], v249 offset:23104
    v_fma_f32 v197, v237, v248, v197
    v_fma_f32 v198, v238, v248, v198
    v_fma_f32 v199, v239, v248, v199
    v_mfma_f32_32x32x16_bf16 v[160:175], v[212:215], v[96:99], v[160:175]
    ds_read_b64_tr_b16 v[228:229], v249 offset:22624
    ds_read_b64_tr_b16 v[230:231], v249 offset:23136
    v_fma_f32 v200, v240, v248, v200
    v_fma_f32 v201, v241, v248, v201
    v_fma_f32 v202, v242, v248, v202
    s_waitcnt lgkmcnt(4)
    v_mfma_f32_32x32x16_bf16 v[144:159], v[216:219], v[100:103], v[144:159]
    ds_read_b64_tr_b16 v[208:209], v249 offset:23616
    ds_read_b64_tr_b16 v[210:211], v249 offset:24128
    v_fma_f32 v203, v243, v248, v203
    v_fma_f32 v204, v244, v248, v204
    v_fma_f32 v205, v245, v248, v205
    v_mfma_f32_32x32x16_bf16 v[160:175], v[220:223], v[100:103], v[160:175]
    ds_read_b64_tr_b16 v[212:213], v249 offset:23648
    ds_read_b64_tr_b16 v[214:215], v249 offset:24160
    v_fma_f32 v206, v246, v248, v206
    v_fma_f32 v207, v247, v248, v207
    v_mul_f32 v240, v192, v252
    s_waitcnt lgkmcnt(4)
    v_mfma_f32_32x32x16_bf16 v[144:159], v[224:227], v[104:107], v[144:159]
    ds_read_b64_tr_b16 v[216:217], v249 offset:32896
    ds_read_b64_tr_b16 v[218:219], v249 offset:33408
    v_mul_f32 v241, v193, v252
    v_mul_f32 v242, v194, v252
    v_mul_f32 v243, v195, v252
    v_mfma_f32_32x32x16_bf16 v[160:175], v[228:231], v[104:107], v[160:175]
    ds_read_b64_tr_b16 v[220:221], v249 offset:32928
    ds_read_b64_tr_b16 v[222:223], v249 offset:33440
    v_mul_f32 v244, v196, v252
    v_mul_f32 v245, v197, v252
    v_mul_f32 v246, v198, v252
    s_waitcnt lgkmcnt(4)
    v_mfma_f32_32x32x16_bf16 v[144:159], v[208:211], v[108:111], v[144:159]
    ds_read_b64_tr_b16 v[224:225], v249 offset:33920
    ds_read_b64_tr_b16 v[226:227], v249 offset:34432
    v_mul_f32 v247, v199, v252
    v_exp_f32 v240, v240
    v_mfma_f32_32x32x16_bf16 v[160:175], v[212:215], v[108:111], v[160:175]
    ds_read_b64_tr_b16 v[228:229], v249 offset:33952
    ds_read_b64_tr_b16 v[230:231], v249 offset:34464
    v_mul_f32 v192, v192, v200
    v_exp_f32 v241, v241
    s_waitcnt lgkmcnt(4)
    v_mfma_f32_32x32x16_bf16 v[144:159], v[216:219], v[112:115], v[144:159]
    ds_read_b64_tr_b16 v[208:209], v249 offset:34944
    ds_read_b64_tr_b16 v[210:211], v249 offset:35456
    s_add_u32 s56, s57, 20480
    buffer_load_dwordx4 v[16:19], v1, s[8:11], s56 offen offset:2048 sc1
    v_mul_f32 v193, v193, v201
    v_mfma_f32_32x32x16_bf16 v[160:175], v[220:223], v[112:115], v[160:175]
    ds_read_b64_tr_b16 v[212:213], v249 offset:34976
    ds_read_b64_tr_b16 v[214:215], v249 offset:35488
    s_add_u32 s56, s57, 24576
    buffer_load_dwordx4 v[20:23], v1, s[8:11], s56 offen sc1
    v_exp_f32 v242, v242
    s_waitcnt lgkmcnt(4)
    v_mfma_f32_32x32x16_bf16 v[144:159], v[224:227], v[116:119], v[144:159]
    ds_read_b64_tr_b16 v[216:217], v249 offset:35968
    ds_read_b64_tr_b16 v[218:219], v249 offset:36480
    buffer_load_dwordx4 v[24:27], v1, s[8:11], s56 offen offset:2048 sc1
    v_mul_f32 v194, v194, v202
    v_mfma_f32_32x32x16_bf16 v[160:175], v[228:231], v[116:119], v[160:175]
    ds_read_b64_tr_b16 v[220:221], v249 offset:36000
    ds_read_b64_tr_b16 v[222:223], v249 offset:36512
    s_add_u32 s56, s57, 28672
    buffer_load_dwordx4 v[28:31], v1, s[8:11], s56 offen sc1
    v_exp_f32 v243, v243
    s_waitcnt lgkmcnt(4)
    v_mfma_f32_32x32x16_bf16 v[144:159], v[208:211], v[120:123], v[144:159]
    ds_read_b64_tr_b16 v[224:225], v249 offset:36992
    ds_read_b64_tr_b16 v[226:227], v249 offset:37504
    buffer_load_dwordx4 v[32:35], v1, s[8:11], s56 offen offset:2048 sc1
    v_mul_f32 v195, v195, v203
    v_mfma_f32_32x32x16_bf16 v[160:175], v[212:215], v[120:123], v[160:175]
    ds_read_b64_tr_b16 v[228:229], v249 offset:37024
    ds_read_b64_tr_b16 v[230:231], v249 offset:37536
    v_exp_f32 v244, v244
    v_mul_f32 v196, v196, v204
    s_waitcnt lgkmcnt(4)
    v_mfma_f32_32x32x16_bf16 v[144:159], v[216:219], v[124:127], v[144:159]
    ds_read_b64_tr_b16 v[208:209], v249 offset:38016
    ds_read_b64_tr_b16 v[210:211], v249 offset:38528
    v_exp_f32 v245, v245
    v_mul_f32 v197, v197, v205
    v_mfma_f32_32x32x16_bf16 v[160:175], v[220:223], v[124:127], v[160:175]
    ds_read_b64_tr_b16 v[212:213], v249 offset:38048
    ds_read_b64_tr_b16 v[214:215], v249 offset:38560
    v_exp_f32 v246, v246
    v_mul_f32 v198, v198, v206
    s_waitcnt lgkmcnt(4)
    v_mfma_f32_32x32x16_bf16 v[144:159], v[224:227], v[128:131], v[144:159]
    ds_read_b64_tr_b16 v[216:217], v249 offset:39040
    ds_read_b64_tr_b16 v[218:219], v249 offset:39552
    v_exp_f32 v247, v247
    v_mul_f32 v199, v199, v207
    v_mfma_f32_32x32x16_bf16 v[160:175], v[228:231], v[128:131], v[160:175]
    ds_read_b64_tr_b16 v[220:221], v249 offset:39072
    ds_read_b64_tr_b16 v[222:223], v249 offset:39584
    v_fma_f32 v240, v240, v250, v250
    v_fma_f32 v241, v241, v250, v250
    v_fma_f32 v242, v242, v250, v250
    s_waitcnt lgkmcnt(4)
    v_mfma_f32_32x32x16_bf16 v[144:159], v[208:211], v[132:135], v[144:159]
    ds_read_b64_tr_b16 v[224:225], v249 offset:40064
    ds_read_b64_tr_b16 v[226:227], v249 offset:40576
    v_fma_f32 v243, v243, v250, v250
    v_fma_f32 v244, v244, v250, v250
    v_fma_f32 v245, v245, v250, v250
    v_mfma_f32_32x32x16_bf16 v[160:175], v[212:215], v[132:135], v[160:175]
    ds_read_b64_tr_b16 v[228:229], v249 offset:40096
    ds_read_b64_tr_b16 v[230:231], v249 offset:40608
    v_fma_f32 v246, v246, v250, v250
    v_fma_f32 v247, v247, v250, v250
    s_waitcnt lgkmcnt(4)
    v_mfma_f32_32x32x16_bf16 v[144:159], v[216:219], v[136:139], v[144:159]
    v_rcp_f32 v240, v240
    v_mfma_f32_32x32x16_bf16 v[160:175], v[220:223], v[136:139], v[160:175]
    v_rcp_f32 v241, v241
    s_waitcnt lgkmcnt(0)
    v_mfma_f32_32x32x16_bf16 v[144:159], v[224:227], v[140:143], v[144:159]
    v_rcp_f32 v242, v242
    v_mul_f32 v192, v192, v240
    v_mfma_f32_32x32x16_bf16 v[160:175], v[228:231], v[140:143], v[160:175]
    v_rcp_f32 v243, v243
    v_mul_f32 v193, v193, v241
    v_rcp_f32 v244, v244
    v_mul_f32 v194, v194, v242
    v_rcp_f32 v245, v245
    v_mul_f32 v195, v195, v243
    v_rcp_f32 v246, v246
    v_mul_f32 v196, v196, v244
    v_rcp_f32 v247, v247
    v_mul_f32 v197, v197, v245
    v_mul_f32 v198, v198, v246
    v_cvt_pk_bf16_f32 v200, v192, v193
    v_mul_f32 v199, v199, v247
    v_cvt_pk_bf16_f32 v201, v194, v195
    v_cvt_pk_bf16_f32 v202, v196, v197
    v_cvt_pk_bf16_f32 v203, v198, v199
    v_min_u32 v203, -2, v203
    s_cmp_lg_u32 s66, 0
    s_cbranch_scc1 L_wt_143
    buffer_store_dwordx4 v[200:203], v1, s[8:11], s54 offen offset:1024
L_wb_144:
    ds_read_b128 v[232:235], v254 offset:512
    ds_read_b128 v[236:239], v254 offset:544
    ds_read_b128 v[240:243], v254 offset:576
    ds_read_b128 v[244:247], v254 offset:608
    ds_read_b128 v[176:179], v254 offset:640
    ds_read_b128 v[180:183], v254 offset:672
    ds_read_b128 v[184:187], v254 offset:704
    ds_read_b128 v[188:191], v254 offset:736
    v_add_u32 v249, 65536, v6
    v_add_u32 v251, 131072, v6
    v_add_u32 v253, 65536, v7
    v_add_u32 v255, 131072, v7
    s_barrier
    s_waitcnt lgkmcnt(4)
    v_pk_fma_f32 v[144:145], v[232:233], v[248:249], v[144:145] op_sel_hi:[1,0,1]
    v_pk_fma_f32 v[146:147], v[234:235], v[248:249], v[146:147] op_sel_hi:[1,0,1]
    v_pk_fma_f32 v[148:149], v[236:237], v[248:249], v[148:149] op_sel_hi:[1,0,1]
    v_pk_fma_f32 v[150:151], v[238:239], v[248:249], v[150:151] op_sel_hi:[1,0,1]
    v_pk_fma_f32 v[152:153], v[240:241], v[248:249], v[152:153] op_sel_hi:[1,0,1]
    v_pk_fma_f32 v[154:155], v[242:243], v[248:249], v[154:155] op_sel_hi:[1,0,1]
    v_pk_fma_f32 v[156:157], v[244:245], v[248:249], v[156:157] op_sel_hi:[1,0,1]
    v_pk_fma_f32 v[158:159], v[246:247], v[248:249], v[158:159] op_sel_hi:[1,0,1]
    v_pk_mul_f32 v[232:233], v[144:145], v[252:253] op_sel_hi:[1,0]
    v_pk_mul_f32 v[234:235], v[146:147], v[252:253] op_sel_hi:[1,0]
    v_pk_mul_f32 v[236:237], v[148:149], v[252:253] op_sel_hi:[1,0]
    v_pk_mul_f32 v[238:239], v[150:151], v[252:253] op_sel_hi:[1,0]
    v_exp_f32 v232, v232
    v_exp_f32 v233, v233
    v_exp_f32 v234, v234
    v_exp_f32 v235, v235
    v_exp_f32 v236, v236
    v_exp_f32 v237, v237
    v_exp_f32 v238, v238
    v_exp_f32 v239, v239
    v_pk_mul_f32 v[144:145], v[144:145], v[152:153]
    v_pk_mul_f32 v[146:147], v[146:147], v[154:155]
    v_pk_mul_f32 v[148:149], v[148:149], v[156:157]
    v_pk_mul_f32 v[150:151], v[150:151], v[158:159]
    v_pk_fma_f32 v[232:233], v[232:233], v[250:251], v[250:251] op_sel_hi:[1,0,0]
    v_pk_fma_f32 v[234:235], v[234:235], v[250:251], v[250:251] op_sel_hi:[1,0,0]
    v_pk_fma_f32 v[236:237], v[236:237], v[250:251], v[250:251] op_sel_hi:[1,0,0]
    v_pk_fma_f32 v[238:239], v[238:239], v[250:251], v[250:251] op_sel_hi:[1,0,0]
    v_rcp_f32 v232, v232
    v_rcp_f32 v233, v233
    v_rcp_f32 v234, v234
    v_rcp_f32 v235, v235
    v_rcp_f32 v236, v236
    v_rcp_f32 v237, v237
    v_rcp_f32 v238, v238
    v_rcp_f32 v239, v239
    s_nop 0
    v_pk_mul_f32 v[144:145], v[144:145], v[232:233]
    v_pk_mul_f32 v[146:147], v[146:147], v[234:235]
    v_pk_mul_f32 v[148:149], v[148:149], v[236:237]
    v_pk_mul_f32 v[150:151], v[150:151], v[238:239]
    v_cvt_pk_bf16_f32 v152, v144, v145
    v_cvt_pk_bf16_f32 v153, v146, v147
    v_cvt_pk_bf16_f32 v154, v148, v149
    v_cvt_pk_bf16_f32 v155, v150, v151
    v_min_u32 v155, -2, v155
    s_cmp_lg_u32 s66, 0
    s_cbranch_scc1 L_wt_145
    buffer_store_dwordx4 v[152:155], v1, s[8:11], s55 offen offset:0
L_wb_146:
    s_waitcnt lgkmcnt(0)
    ds_read_b64_tr_b16 v[208:209], v6 offset:49344
    ds_read_b64_tr_b16 v[210:211], v6 offset:50368
    ds_read_b64_tr_b16 v[212:213], v7 offset:49344
    ds_read_b64_tr_b16 v[214:215], v7 offset:50368
    ds_read_b64_tr_b16 v[216:217], v6 offset:53440
    ds_read_b64_tr_b16 v[218:219], v6 offset:54464
    ds_read_b64_tr_b16 v[220:221], v7 offset:53440
    ds_read_b64_tr_b16 v[222:223], v7 offset:54464
    v_pk_fma_f32 v[160:161], v[176:177], v[248:249], v[160:161] op_sel_hi:[1,0,1]
    v_pk_fma_f32 v[162:163], v[178:179], v[248:249], v[162:163] op_sel_hi:[1,0,1]
    v_pk_fma_f32 v[164:165], v[180:181], v[248:249], v[164:165] op_sel_hi:[1,0,1]
    v_pk_fma_f32 v[166:167], v[182:183], v[248:249], v[166:167] op_sel_hi:[1,0,1]
    v_pk_fma_f32 v[168:169], v[184:185], v[248:249], v[168:169] op_sel_hi:[1,0,1]
    v_pk_fma_f32 v[170:171], v[186:187], v[248:249], v[170:171] op_sel_hi:[1,0,1]
    v_pk_fma_f32 v[172:173], v[188:189], v[248:249], v[172:173] op_sel_hi:[1,0,1]
    v_pk_fma_f32 v[174:175], v[190:191], v[248:249], v[174:175] op_sel_hi:[1,0,1]
    v_pk_mul_f32 v[192:193], v[160:161], v[252:253] op_sel_hi:[1,0]
    v_pk_mul_f32 v[194:195], v[162:163], v[252:253] op_sel_hi:[1,0]
    v_pk_mul_f32 v[196:197], v[164:165], v[252:253] op_sel_hi:[1,0]
    v_pk_mul_f32 v[198:199], v[166:167], v[252:253] op_sel_hi:[1,0]
    v_exp_f32 v192, v192
    v_exp_f32 v193, v193
    v_exp_f32 v194, v194
    v_exp_f32 v195, v195
    v_exp_f32 v196, v196
    v_exp_f32 v197, v197
    v_exp_f32 v198, v198
    v_exp_f32 v199, v199
    v_pk_mul_f32 v[160:161], v[160:161], v[168:169]
    v_pk_mul_f32 v[162:163], v[162:163], v[170:171]
    v_pk_mul_f32 v[164:165], v[164:165], v[172:173]
    v_pk_mul_f32 v[166:167], v[166:167], v[174:175]
    v_pk_fma_f32 v[192:193], v[192:193], v[250:251], v[250:251] op_sel_hi:[1,0,0]
    v_pk_fma_f32 v[194:195], v[194:195], v[250:251], v[250:251] op_sel_hi:[1,0,0]
    v_pk_fma_f32 v[196:197], v[196:197], v[250:251], v[250:251] op_sel_hi:[1,0,0]
    v_pk_fma_f32 v[198:199], v[198:199], v[250:251], v[250:251] op_sel_hi:[1,0,0]
    v_rcp_f32 v192, v192
    v_rcp_f32 v193, v193
    v_rcp_f32 v194, v194
    v_rcp_f32 v195, v195
    v_rcp_f32 v196, v196
    v_rcp_f32 v197, v197
    v_rcp_f32 v198, v198
    v_rcp_f32 v199, v199
    s_nop 0
    v_pk_mul_f32 v[160:161], v[160:161], v[192:193]
    v_pk_mul_f32 v[162:163], v[162:163], v[194:195]
    v_pk_mul_f32 v[164:165], v[164:165], v[196:197]
    v_pk_mul_f32 v[166:167], v[166:167], v[198:199]
    v_cvt_pk_bf16_f32 v168, v160, v161
    v_cvt_pk_bf16_f32 v169, v162, v163
    v_cvt_pk_bf16_f32 v170, v164, v165
    v_cvt_pk_bf16_f32 v171, v166, v167
    v_min_u32 v171, -2, v171
    s_cmp_lg_u32 s66, 0
    s_cbranch_scc1 L_wt_147
    buffer_store_dwordx4 v[168:171], v1, s[8:11], s55 offen offset:1024
L_wb_148:
    s_add_u32 s56, s57, 32768
    buffer_load_dwordx4 v[36:39], v1, s[8:11], s56 offen sc1
    buffer_load_dwordx4 v[40:43], v1, s[8:11], s56 offen offset:2048 sc1
    s_add_u32 s56, s57, 36864
    buffer_load_dwordx4 v[44:47], v1, s[8:11], s56 offen sc1
    buffer_load_dwordx4 v[48:51], v1, s[8:11], s56 offen offset:2048 sc1
    s_lshl_b32 s58, s44, 13
    s_add_u32 s59, s58, 65728
    v_add_u32 v232, s59, v1
    s_xor_b32 s58, s58, 0x4000
    s_add_u32 s58, s58, 69824
    v_add_u32 v233, s58, v1
    s_waitcnt vmcnt(8)
    v_max3_u32 v4, v19, v23, v27
    v_max_u32 v4, v4, v31
    v_cmp_eq_u32 vcc, -1, v4
    s_cbranch_vccnz L_slow_149
L_back_150:
    s_waitcnt lgkmcnt(4)
    v_mfma_f32_32x32x16_bf16 v[176:191], v[208:211], v[16:19], 0
    ds_read_b64_tr_b16 v[224:225], v6 offset:57536
    ds_read_b64_tr_b16 v[226:227], v6 offset:58560
    s_add_u32 s56, s57, 40960
    buffer_load_dwordx4 v[52:55], v1, s[8:11], s56 offen sc1
    v_mfma_f32_32x32x16_bf16 v[192:207], v[212:215], v[16:19], 0
    ds_read_b64_tr_b16 v[228:229], v7 offset:57536
    ds_read_b64_tr_b16 v[230:231], v7 offset:58560
    s_waitcnt lgkmcnt(4)
    v_mfma_f32_32x32x16_bf16 v[176:191], v[216:219], v[20:23], v[176:191]
    ds_read_b64_tr_b16 v[208:209], v6 offset:61632
    ds_read_b64_tr_b16 v[210:211], v6 offset:62656
    buffer_load_dwordx4 v[56:59], v1, s[8:11], s56 offen offset:2048 sc1
    v_mfma_f32_32x32x16_bf16 v[192:207], v[220:223], v[20:23], v[192:207]
    ds_read_b64_tr_b16 v[212:213], v7 offset:61632
    ds_read_b64_tr_b16 v[214:215], v7 offset:62656
    s_waitcnt lgkmcnt(4)
    v_mfma_f32_32x32x16_bf16 v[176:191], v[224:227], v[24:27], v[176:191]
    ds_read_b64_tr_b16 v[216:217], v249 offset:192
    ds_read_b64_tr_b16 v[218:219], v249 offset:1216
    s_add_u32 s56, s57, 45056
    buffer_load_dwordx4 v[60:63], v1, s[8:11], s56 offen sc1
    v_mfma_f32_32x32x16_bf16 v[192:207], v[228:231], v[24:27], v[192:207]
    ds_read_b64_tr_b16 v[220:221], v253 offset:192
    ds_read_b64_tr_b16 v[222:223], v253 offset:1216
    s_waitcnt lgkmcnt(4)
    v_mfma_f32_32x32x16_bf16 v[176:191], v[208:211], v[28:31], v[176:191]
    ds_read_b64_tr_b16 v[224:225], v249 offset:4288
    ds_read_b64_tr_b16 v[226:227], v249 offset:5312
    buffer_load_dwordx4 v[64:67], v1, s[8:11], s56 offen offset:2048 sc1
    v_mfma_f32_32x32x16_bf16 v[192:207], v[212:215], v[28:31], v[192:207]
    ds_read_b64_tr_b16 v[228:229], v253 offset:4288
    ds_read_b64_tr_b16 v[230:231], v253 offset:5312
    s_waitcnt vmcnt(5)
    v_max3_u32 v4, v35, v39, v43
    v_max_u32 v4, v4, v47
    v_cmp_eq_u32 vcc, -1, v4
    s_cbranch_vccnz L_slow_153
L_back_154:
    s_waitcnt lgkmcnt(4)
    v_mfma_f32_32x32x16_bf16 v[176:191], v[216:219], v[32:35], v[176:191]
    ds_read_b64_tr_b16 v[208:209], v249 offset:8384
    ds_read_b64_tr_b16 v[210:211], v249 offset:9408
    s_add_u32 s56, s57, 49152
    buffer_load_dwordx4 v[68:71], v1, s[8:11], s56 offen sc1
    v_mfma_f32_32x32x16_bf16 v[192:207], v[220:223], v[32:35], v[192:207]
    ds_read_b64_tr_b16 v[212:213], v253 offset:8384
    ds_read_b64_tr_b16 v[214:215], v253 offset:9408
    s_waitcnt lgkmcnt(4)
    v_mfma_f32_32x32x16_bf16 v[176:191], v[224:227], v[36:39], v[176:191]
    ds_read_b64_tr_b16 v[216:217], v249 offset:12480
    ds_read_b64_tr_b16 v[218:219], v249 offset:13504
    buffer_load_dwordx4 v[72:75], v1, s[8:11], s56 offen offset:2048 sc1
    v_mfma_f32_32x32x16_bf16 v[192:207], v[228:231], v[36:39], v[192:207]
    ds_read_b64_tr_b16 v[220:221], v253 offset:12480
    ds_read_b64_tr_b16 v[222:223], v253 offset:13504
    s_waitcnt lgkmcnt(4)
    v_mfma_f32_32x32x16_bf16 v[176:191], v[208:211], v[40:43], v[176:191]
    ds_read_b64_tr_b16 v[224:225], v249 offset:16576
    ds_read_b64_tr_b16 v[226:227], v249 offset:17600
    s_add_u32 s56, s57, 53248
    buffer_load_dwordx4 v[76:79], v1, s[8:11], s56 offen sc1
    v_lshlrev_b32 v16, 16, v8
    v_and_b32 v17, 0xffff0000, v8
    v_lshlrev_b32 v18, 16, v9
    v_and_b32 v19, 0xffff0000, v9
    v_mfma_f32_32x32x16_bf16 v[192:207], v[212:215], v[40:43], v[192:207]
    ds_read_b64_tr_b16 v[228:229], v253 offset:16576
    ds_read_b64_tr_b16 v[230:231], v253 offset:17600
    v_lshlrev_b32 v20, 16, v10
    v_and_b32 v21, 0xffff0000, v10
    v_lshlrev_b32 v22, 16, v11
    v_and_b32 v23, 0xffff0000, v11
    v_lshlrev_b32 v24, 16, v12
    s_waitcnt lgkmcnt(4)
    v_mfma_f32_32x32x16_bf16 v[176:191], v[216:219], v[44:47], v[176:191]
    ds_read_b64_tr_b16 v[208:209], v249 offset:20672
    ds_read_b64_tr_b16 v[210:211], v249 offset:21696
    buffer_load_dwordx4 v[80:83], v1, s[8:11], s56 offen offset:2048 sc1
    v_and_b32 v25, 0xffff0000, v12
    v_lshlrev_b32 v26, 16, v13
    v_and_b32 v27, 0xffff0000, v13
    v_lshlrev_b32 v28, 16, v14
    v_mfma_f32_32x32x16_bf16 v[192:207], v[220:223], v[44:47], v[192:207]
    ds_read_b64_tr_b16 v[212:213], v253 offset:20672
    ds_read_b64_tr_b16 v[214:215], v253 offset:21696
    v_and_b32 v29, 0xffff0000, v14
    v_lshlrev_b32 v30, 16, v15
    v_and_b32 v31, 0xffff0000, v15
    s_waitcnt vmcnt(5)
    v_max3_u32 v4, v51, v55, v59
    v_max_u32 v4, v4, v63
    v_cmp_eq_u32 vcc, -1, v4
    s_cbranch_vccnz L_slow_157
L_back_158:
    s_waitcnt lgkmcnt(4)
    v_mfma_f32_32x32x16_bf16 v[176:191], v[224:227], v[48:51], v[176:191]
    ds_read_b64_tr_b16 v[216:217], v249 offset:24768
    ds_read_b64_tr_b16 v[218:219], v249 offset:25792
    s_add_u32 s56, s57, 57344
    buffer_load_dwordx4 v[84:87], v1, s[8:11], s56 offen sc1
    v_mfma_f32_32x32x16_bf16 v[192:207], v[228:231], v[48:51], v[192:207]
    ds_read_b64_tr_b16 v[220:221], v253 offset:24768
    ds_read_b64_tr_b16 v[222:223], v253 offset:25792
    s_waitcnt lgkmcnt(4)
    v_mfma_f32_32x32x16_bf16 v[176:191], v[208:211], v[52:55], v[176:191]
    ds_read_b64_tr_b16 v[224:225], v249 offset:28864
    ds_read_b64_tr_b16 v[226:227], v249 offset:29888
    buffer_load_dwordx4 v[88:91], v1, s[8:11], s56 offen offset:2048 sc1
    v_mfma_f32_32x32x16_bf16 v[192:207], v[212:215], v[52:55], v[192:207]
    ds_read_b64_tr_b16 v[228:229], v253 offset:28864
    ds_read_b64_tr_b16 v[230:231], v253 offset:29888
    s_waitcnt lgkmcnt(0)
    s_barrier
    v_mfma_f32_32x32x16_bf16 v[176:191], v[216:219], v[56:59], v[176:191]
    ds_read_b64_tr_b16 v[208:209], v251 offset:512
    ds_read_b64_tr_b16 v[210:211], v251 offset:1536
    s_add_u32 s56, s57, 61440
    buffer_load_dwordx4 v[92:95], v1, s[8:11], s56 offen sc1
    v_mfma_f32_32x32x16_bf16 v[192:207], v[220:223], v[56:59], v[192:207]
    ds_read_b64_tr_b16 v[212:213], v255 offset:512
    ds_read_b64_tr_b16 v[214:215], v255 offset:1536
    v_mfma_f32_32x32x16_bf16 v[176:191], v[224:227], v[60:63], v[176:191]
    ds_read_b64_tr_b16 v[216:217], v251 offset:4608
    ds_read_b64_tr_b16 v[218:219], v251 offset:5632
    buffer_load_dwordx4 v[96:99], v1, s[8:11], s56 offen offset:2048 sc1
    v_mfma_f32_32x32x16_bf16 v[192:207], v[228:231], v[60:63], v[192:207]
    ds_read_b64_tr_b16 v[220:221], v255 offset:4608
    ds_read_b64_tr_b16 v[222:223], v255 offset:5632
    s_waitcnt vmcnt(5)
    v_max3_u32 v4, v67, v71, v75
    v_max_u32 v4, v4, v79
    v_cmp_eq_u32 vcc, -1, v4
    s_cbranch_vccnz L_slow_161
L_back_162:
    s_waitcnt lgkmcnt(4)
    v_mfma_f32_32x32x16_bf16 v[176:191], v[208:211], v[64:67], v[176:191]
    ds_read_b64_tr_b16 v[224:225], v251 offset:8704
    ds_read_b64_tr_b16 v[226:227], v251 offset:9728
    s_add_u32 s56, s57, 65536
    buffer_load_dwordx4 v[100:103], v1, s[8:11], s56 offen sc1
    v_mfma_f32_32x32x16_bf16 v[192:207], v[212:215], v[64:67], v[192:207]
    ds_read_b64_tr_b16 v[228:229], v255 offset:8704
    ds_read_b64_tr_b16 v[230:231], v255 offset:9728
    s_waitcnt lgkmcnt(4)
    v_mfma_f32_32x32x16_bf16 v[176:191], v[216:219], v[68:71], v[176:191]
    ds_read_b64_tr_b16 v[208:209], v251 offset:12800
    ds_read_b64_tr_b16 v[210:211], v251 offset:13824
    buffer_load_dwordx4 v[104:107], v1, s[8:11], s56 offen offset:2048 sc1
    v_mfma_f32_32x32x16_bf16 v[192:207], v[220:223], v[68:71], v[192:207]
    ds_read_b64_tr_b16 v[212:213], v255 offset:12800
    ds_read_b64_tr_b16 v[214:215], v255 offset:13824
    s_waitcnt lgkmcnt(4)
    v_mfma_f32_32x32x16_bf16 v[176:191], v[224:227], v[72:75], v[176:191]
    ds_read_b64_tr_b16 v[216:217], v6 offset:0
    ds_read_b64_tr_b16 v[218:219], v6 offset:1024
    s_add_u32 s56, s57, 69632
    buffer_load_dwordx4 v[108:111], v1, s[8:11], s56 offen sc1
    v_mfma_f32_32x32x16_bf16 v[192:207], v[228:231], v[72:75], v[192:207]
    ds_read_b64_tr_b16 v[220:221], v7 offset:0
    ds_read_b64_tr_b16 v[222:223], v7 offset:1024
    s_waitcnt lgkmcnt(4)
    v_mfma_f32_32x32x16_bf16 v[176:191], v[208:211], v[76:79], v[176:191]
    ds_read_b64_tr_b16 v[224:225], v6 offset:4096
    ds_read_b64_tr_b16 v[226:227], v6 offset:5120
    buffer_load_dwordx4 v[112:115], v1, s[8:11], s56 offen offset:2048 sc1
    v_mfma_f32_32x32x16_bf16 v[192:207], v[212:215], v[76:79], v[192:207]
    ds_read_b64_tr_b16 v[228:229], v7 offset:4096
    ds_read_b64_tr_b16 v[230:231], v7 offset:5120
    s_waitcnt vmcnt(5)
    v_max3_u32 v4, v83, v87, v91
    v_max_u32 v4, v4, v95
    v_cmp_eq_u32 vcc, -1, v4
    s_cbranch_vccnz L_slow_165
L_back_166:
    s_waitcnt lgkmcnt(4)
    v_mfma_f32_32x32x16_bf16 v[176:191], v[216:219], v[80:83], v[176:191]
    ds_read_b64_tr_b16 v[208:209], v6 offset:8192
    ds_read_b64_tr_b16 v[210:211], v6 offset:9216
    s_add_u32 s56, s57, 73728
    buffer_load_dwordx4 v[116:119], v1, s[8:11], s56 offen sc1
    v_mfma_f32_32x32x16_bf16 v[192:207], v[220:223], v[80:83], v[192:207]
    ds_read_b64_tr_b16 v[212:213], v7 offset:8192
    ds_read_b64_tr_b16 v[214:215], v7 offset:9216
    s_waitcnt lgkmcnt(4)
    v_mfma_f32_32x32x16_bf16 v[176:191], v[224:227], v[84:87], v[176:191]
    ds_read_b64_tr_b16 v[216:217], v6 offset:12288
    ds_read_b64_tr_b16 v[218:219], v6 offset:13312
    buffer_load_dwordx4 v[120:123], v1, s[8:11], s56 offen offset:2048 sc1
    v_mfma_f32_32x32x16_bf16 v[192:207], v[228:231], v[84:87], v[192:207]
    ds_read_b64_tr_b16 v[220:221], v7 offset:12288
    ds_read_b64_tr_b16 v[222:223], v7 offset:13312
    s_waitcnt lgkmcnt(4)
    v_mfma_f32_32x32x16_bf16 v[176:191], v[208:211], v[88:91], v[176:191]
    ds_read_b64_tr_b16 v[224:225], v6 offset:16384
    ds_read_b64_tr_b16 v[226:227], v6 offset:17408
    s_add_u32 s56, s57, 77824
    buffer_load_dwordx4 v[124:127], v1, s[8:11], s56 offen sc1
    v_mfma_f32_32x32x16_bf16 v[192:207], v[212:215], v[88:91], v[192:207]
    ds_read_b64_tr_b16 v[228:229], v7 offset:16384
    ds_read_b64_tr_b16 v[230:231], v7 offset:17408
    s_waitcnt lgkmcnt(4)
    v_mfma_f32_32x32x16_bf16 v[176:191], v[216:219], v[92:95], v[176:191]
    ds_read_b64_tr_b16 v[208:209], v6 offset:20480
    ds_read_b64_tr_b16 v[210:211], v6 offset:21504
    buffer_load_dwordx4 v[128:131], v1, s[8:11], s56 offen offset:2048 sc1
    v_mfma_f32_32x32x16_bf16 v[192:207], v[220:223], v[92:95], v[192:207]
    ds_read_b64_tr_b16 v[212:213], v7 offset:20480
    ds_read_b64_tr_b16 v[214:215], v7 offset:21504
    s_waitcnt vmcnt(5)
    v_max3_u32 v4, v99, v103, v107
    v_max_u32 v4, v4, v111
    v_cmp_eq_u32 vcc, -1, v4
    s_cbranch_vccnz L_slow_169
L_back_170:
    s_waitcnt lgkmcnt(4)
    v_mfma_f32_32x32x16_bf16 v[176:191], v[224:227], v[96:99], v[176:191]
    ds_read_b64_tr_b16 v[216:217], v6 offset:24576
    ds_read_b64_tr_b16 v[218:219], v6 offset:25600
    s_add_u32 s56, s57, 81920
    buffer_load_dwordx4 v[132:135], v1, s[8:11], s56 offen sc1
    v_mfma_f32_32x32x16_bf16 v[192:207], v[228:231], v[96:99], v[192:207]
    ds_read_b64_tr_b16 v[220:221], v7 offset:24576
    ds_read_b64_tr_b16 v[222:223], v7 offset:25600
    s_waitcnt lgkmcnt(4)
    v_mfma_f32_32x32x16_bf16 v[176:191], v[208:211], v[100:103], v[176:191]
    ds_read_b64_tr_b16 v[224:225], v6 offset:28672
    ds_read_b64_tr_b16 v[226:227], v6 offset:29696
    buffer_load_dwordx4 v[136:139], v1, s[8:11], s56 offen offset:2048 sc1
    v_mfma_f32_32x32x16_bf16 v[192:207], v[212:215], v[100:103], v[192:207]
    ds_read_b64_tr_b16 v[228:229], v7 offset:28672
    ds_read_b64_tr_b16 v[230:231], v7 offset:29696
    s_waitcnt lgkmcnt(4)
    v_mfma_f32_32x32x16_bf16 v[176:191], v[216:219], v[104:107], v[176:191]
    ds_read_b64_tr_b16 v[208:209], v6 offset:32768
    ds_read_b64_tr_b16 v[210:211], v6 offset:33792
    s_add_u32 s56, s57, 86016
    buffer_load_dwordx4 v[140:143], v1, s[8:11], s56 offen sc1
    v_mfma_f32_32x32x16_bf16 v[192:207], v[220:223], v[104:107], v[192:207]
    ds_read_b64_tr_b16 v[212:213], v7 offset:32768
    ds_read_b64_tr_b16 v[214:215], v7 offset:33792
    s_waitcnt lgkmcnt(4)
    v_mfma_f32_32x32x16_bf16 v[176:191], v[224:227], v[108:111], v[176:191]
    ds_read_b64_tr_b16 v[216:217], v6 offset:36864
    ds_read_b64_tr_b16 v[218:219], v6 offset:37888
    v_mfma_f32_32x32x16_bf16 v[192:207], v[228:231], v[108:111], v[192:207]
    ds_read_b64_tr_b16 v[220:221], v7 offset:36864
    ds_read_b64_tr_b16 v[222:223], v7 offset:37888
    s_waitcnt vmcnt(4)
    v_max3_u32 v4, v115, v119, v123
    v_max_u32 v4, v4, v127
    v_cmp_eq_u32 vcc, -1, v4
    s_cbranch_vccnz L_slow_173
L_back_174:
    s_waitcnt lgkmcnt(4)
    v_mfma_f32_32x32x16_bf16 v[176:191], v[208:211], v[112:115], v[176:191]
    ds_read_b64_tr_b16 v[224:225], v6 offset:40960
    ds_read_b64_tr_b16 v[226:227], v6 offset:41984
    v_mfma_f32_32x32x16_bf16 v[192:207], v[212:215], v[112:115], v[192:207]
    ds_read_b64_tr_b16 v[228:229], v7 offset:40960
    ds_read_b64_tr_b16 v[230:231], v7 offset:41984
    s_waitcnt lgkmcnt(4)
    v_mfma_f32_32x32x16_bf16 v[176:191], v[216:219], v[116:119], v[176:191]
    ds_read_b64_tr_b16 v[208:209], v6 offset:45056
    ds_read_b64_tr_b16 v[210:211], v6 offset:46080
    v_mfma_f32_32x32x16_bf16 v[192:207], v[220:223], v[116:119], v[192:207]
    ds_read_b64_tr_b16 v[212:213], v7 offset:45056
    ds_read_b64_tr_b16 v[214:215], v7 offset:46080
    s_barrier
    s_waitcnt lgkmcnt(4)
    v_mfma_f32_32x32x16_bf16 v[176:191], v[224:227], v[120:123], v[176:191]
    ds_read_b64_tr_b16 v[216:217], v6 offset:49344
    ds_read_b64_tr_b16 v[218:219], v6 offset:50368
    ds_read_b128 v[144:147], v232 offset:0
    ds_read_b128 v[148:151], v232 offset:1024
    v_mfma_f32_32x32x16_bf16 v[192:207], v[228:231], v[120:123], v[192:207]
    ds_read_b64_tr_b16 v[220:221], v7 offset:49344
    ds_read_b64_tr_b16 v[222:223], v7 offset:50368
    ds_read_b128 v[152:155], v232 offset:2048
    ds_read_b128 v[156:159], v232 offset:3072
    s_waitcnt lgkmcnt(8)
    v_mfma_f32_32x32x16_bf16 v[176:191], v[208:211], v[124:127], v[176:191]
    ds_read_b64_tr_b16 v[224:225], v6 offset:53440
    ds_read_b64_tr_b16 v[226:227], v6 offset:54464
    ds_read_b128 v[160:163], v233 offset:0
    ds_read_b128 v[164:167], v233 offset:1024
    v_mfma_f32_32x32x16_bf16 v[192:207], v[212:215], v[124:127], v[192:207]
    ds_read_b64_tr_b16 v[228:229], v7 offset:53440
    ds_read_b64_tr_b16 v[230:231], v7 offset:54464
    ds_read_b128 v[168:171], v233 offset:2048
    ds_read_b128 v[172:175], v233 offset:3072
    s_waitcnt vmcnt(0)
    v_max3_u32 v4, v131, v135, v139
    v_max_u32 v4, v4, v143
    v_cmp_eq_u32 vcc, -1, v4
    s_cbranch_vccnz L_slow_177
L_back_178:
    s_waitcnt lgkmcnt(10)
    v_mfma_f32_32x32x16_bf16 v[176:191], v[216:219], v[128:131], v[176:191]
    ds_read_b64_tr_b16 v[208:209], v6 offset:57536
    ds_read_b64_tr_b16 v[210:211], v6 offset:58560
    s_waitcnt lgkmcnt(10)
    v_add_f32 v16, v16, v144
    v_add_f32 v17, v17, v145
    v_add_f32 v18, v18, v146
    v_add_f32 v19, v19, v147
    v_add_f32 v20, v20, v148
    v_mfma_f32_32x32x16_bf16 v[192:207], v[220:223], v[128:131], v[192:207]
    ds_read_b64_tr_b16 v[212:213], v7 offset:57536
    ds_read_b64_tr_b16 v[214:215], v7 offset:58560
    v_add_f32 v21, v21, v149
    v_add_f32 v22, v22, v150
    v_add_f32 v23, v23, v151
    v_add_f32 v24, v24, v152
    v_add_f32 v25, v25, v153
    s_waitcnt lgkmcnt(6)
    v_mfma_f32_32x32x16_bf16 v[176:191], v[224:227], v[132:135], v[176:191]
    ds_read_b64_tr_b16 v[216:217], v6 offset:61632
    ds_read_b64_tr_b16 v[218:219], v6 offset:62656
    v_add_f32 v26, v26, v154
    v_add_f32 v27, v27, v155
    v_add_f32 v28, v28, v156
    v_add_f32 v29, v29, v157
    v_add_f32 v30, v30, v158
    v_mfma_f32_32x32x16_bf16 v[192:207], v[228:231], v[132:135], v[192:207]
    ds_read_b64_tr_b16 v[220:221], v7 offset:61632
    ds_read_b64_tr_b16 v[222:223], v7 offset:62656
    v_add_f32 v31, v31, v159
    s_waitcnt lgkmcnt(8)
    v_add_f32 v16, v16, v160
    v_add_f32 v17, v17, v161
    v_add_f32 v18, v18, v162
    v_add_f32 v19, v19, v163
    s_waitcnt lgkmcnt(4)
    v_mfma_f32_32x32x16_bf16 v[176:191], v[208:211], v[136:139], v[176:191]
    v_add_f32 v20, v20, v164
    v_add_f32 v21, v21, v165
    v_add_f32 v22, v22, v166
    v_add_f32 v23, v23, v167
    v_add_f32 v24, v24, v168
    v_mfma_f32_32x32x16_bf16 v[192:207], v[212:215], v[136:139], v[192:207]
    v_add_f32 v25, v25, v169
    v_add_f32 v26, v26, v170
    v_add_f32 v27, v27, v171
    v_add_f32 v28, v28, v172
    v_add_f32 v29, v29, v173
    s_waitcnt lgkmcnt(0)
    v_mfma_f32_32x32x16_bf16 v[176:191], v[216:219], v[140:143], v[176:191]
    v_add_f32 v30, v30, v174
    v_add_f32 v31, v31, v175
    v_mfma_f32_32x32x16_bf16 v[192:207], v[220:223], v[140:143], v[192:207]
    s_lshl_b32 s59, s44, 12
    s_add_u32 s58, s59, 98496
    v_add_u32 v48, s58, v1
    s_xor_b32 s59, s59, 0x2000
    s_add_u32 s59, s59, 98496
    v_add_u32 v49, s59, v1
    s_nop 7
    ds_write_b128 v48, v[192:195] offset:0
    ds_write_b128 v48, v[196:199] offset:1024
    ds_write_b128 v48, v[200:203] offset:2048
    ds_write_b128 v48, v[204:207] offset:3072
    s_waitcnt lgkmcnt(0)
    s_barrier
    ds_read_b128 v[192:195], v49 offset:0
    ds_read_b128 v[196:199], v49 offset:1024
    ds_read_b128 v[200:203], v49 offset:2048
    ds_read_b128 v[204:207], v49 offset:3072
    v_pk_add_f32 v[176:177], v[176:177], v[16:17]
    v_pk_add_f32 v[178:179], v[178:179], v[18:19]
    v_pk_add_f32 v[180:181], v[180:181], v[20:21]
    v_pk_add_f32 v[182:183], v[182:183], v[22:23]
    v_pk_add_f32 v[184:185], v[184:185], v[24:25]
    v_pk_add_f32 v[186:187], v[186:187], v[26:27]
    v_pk_add_f32 v[188:189], v[188:189], v[28:29]
    v_pk_add_f32 v[190:191], v[190:191], v[30:31]
    v_and_b32 v48, 31, v0
    v_lshlrev_b32 v49, 10, v48
    v_lshrrev_b32 v48, 5, v0
    v_lshl_add_u32 v49, v48, 4, v49
    s_lshl_b32 s58, s60, 15
    s_lshl_b32 s59, s62, 6
    s_add_u32 s58, s58, s59
    s_waitcnt lgkmcnt(3)
    v_pk_add_f32 v[176:177], v[176:177], v[192:193]
    v_pk_add_f32 v[178:179], v[178:179], v[194:195]
    s_waitcnt lgkmcnt(2)
    v_pk_add_f32 v[180:181], v[180:181], v[196:197]
    v_pk_add_f32 v[182:183], v[182:183], v[198:199]
    s_waitcnt lgkmcnt(1)
    v_pk_add_f32 v[184:185], v[184:185], v[200:201]
    v_pk_add_f32 v[186:187], v[186:187], v[202:203]
    s_waitcnt lgkmcnt(0)
    v_pk_add_f32 v[188:189], v[188:189], v[204:205]
    v_pk_add_f32 v[190:191], v[190:191], v[206:207]
    v_cvt_pk_bf16_f32 v8, v176, v177
    v_cvt_pk_bf16_f32 v9, v178, v179
    v_cvt_pk_bf16_f32 v10, v180, v181
    v_cvt_pk_bf16_f32 v11, v182, v183
    v_cvt_pk_bf16_f32 v12, v184, v185
    v_cvt_pk_bf16_f32 v13, v186, v187
    v_cvt_pk_bf16_f32 v14, v188, v189
    v_cvt_pk_bf16_f32 v15, v190, v191
    s_nop 1
    v_permlane32_swap_b32 v8, v10
    v_permlane32_swap_b32 v9, v11
    v_permlane32_swap_b32 v12, v14
    v_permlane32_swap_b32 v13, v15
    s_nop 1
    buffer_store_dwordx4 v[8:11], v49, s[36:39], s58 offen offset:0
    buffer_store_dwordx4 v[12:15], v49, s[36:39], s58 offen offset:32
    s_endpgm
L_ool:
L_slow_1:
    s_waitcnt vmcnt(0)
L_rl_3:
    v_cmp_eq_u32 vcc, -1, v131
    s_cbranch_vccz L_sk_181
    s_xor_b32 s3, s54, 0
    buffer_load_dwordx4 v[128:131], v8, s[8:11], s3 offen sc1
L_sk_181:
    v_cmp_eq_u32 vcc, -1, v135
    s_cbranch_vccz L_sk_182
    s_xor_b32 s3, s54, 0
    buffer_load_dwordx4 v[132:135], v9, s[8:11], s3 offen sc1
L_sk_182:
    v_cmp_eq_u32 vcc, -1, v139
    s_cbranch_vccz L_sk_183
    s_xor_b32 s3, s54, 4096
    buffer_load_dwordx4 v[136:139], v8, s[8:11], s3 offen sc1
L_sk_183:
    v_cmp_eq_u32 vcc, -1, v143
    s_cbranch_vccz L_sk_184
    s_xor_b32 s3, s54, 4096
    buffer_load_dwordx4 v[140:143], v9, s[8:11], s3 offen sc1
L_sk_184:
    s_waitcnt vmcnt(0)
    s_sub_u32 s47, s47, 1
    s_cbranch_scc1 L_gu_4
    v_max3_u32 v2, v131, v135, v139
    v_max_u32 v2, v2, v143
    v_cmp_eq_u32 vcc, -1, v2
    s_cbranch_vccnz L_rl_3
    s_branch L_back_2
L_gu_4:
    s_mov_b32 s47, 0
    s_branch L_back_2
L_slow_5:
    s_waitcnt vmcnt(0)
L_rl_7:
    v_cmp_eq_u32 vcc, -1, v147
    s_cbranch_vccz L_sk_185
    s_xor_b32 s3, s54, 8192
    buffer_load_dwordx4 v[144:147], v8, s[8:11], s3 offen sc1
L_sk_185:
    v_cmp_eq_u32 vcc, -1, v151
    s_cbranch_vccz L_sk_186
    s_xor_b32 s3, s54, 8192
    buffer_load_dwordx4 v[148:151], v9, s[8:11], s3 offen sc1
L_sk_186:
    v_cmp_eq_u32 vcc, -1, v155
    s_cbranch_vccz L_sk_187
    s_xor_b32 s3, s54, 12288
    buffer_load_dwordx4 v[152:155], v8, s[8:11], s3 offen sc1
L_sk_187:
    v_cmp_eq_u32 vcc, -1, v159
    s_cbranch_vccz L_sk_188
    s_xor_b32 s3, s54, 12288
    buffer_load_dwordx4 v[156:159], v9, s[8:11], s3 offen sc1
L_sk_188:
    v_cmp_eq_u32 vcc, -1, v163
    s_cbranch_vccz L_sk_189
    s_xor_b32 s3, s54, 16384
    buffer_load_dwordx4 v[160:163], v8, s[8:11], s3 offen sc1
L_sk_189:
    v_cmp_eq_u32 vcc, -1, v167
    s_cbranch_vccz L_sk_190
    s_xor_b32 s3, s54, 16384
    buffer_load_dwordx4 v[164:167], v9, s[8:11], s3 offen sc1
L_sk_190:
    v_cmp_eq_u32 vcc, -1, v171
    s_cbranch_vccz L_sk_191
    s_xor_b32 s3, s54, 20480
    buffer_load_dwordx4 v[168:171], v8, s[8:11], s3 offen sc1
L_sk_191:
    v_cmp_eq_u32 vcc, -1, v175
    s_cbranch_vccz L_sk_192
    s_xor_b32 s3, s54, 20480
    buffer_load_dwordx4 v[172:175], v9, s[8:11], s3 offen sc1
L_sk_192:
    v_cmp_eq_u32 vcc, -1, v179
    s_cbranch_vccz L_sk_193
    s_xor_b32 s3, s54, 24576
    buffer_load_dwordx4 v[176:179], v8, s[8:11], s3 offen sc1
L_sk_193:
    v_cmp_eq_u32 vcc, -1, v183
    s_cbranch_vccz L_sk_194
    s_xor_b32 s3, s54, 24576
    buffer_load_dwordx4 v[180:183], v9, s[8:11], s3 offen sc1
L_sk_194:
    v_cmp_eq_u32 vcc, -1, v187
    s_cbranch_vccz L_sk_195
    s_xor_b32 s3, s54, 28672
    buffer_load_dwordx4 v[184:187], v8, s[8:11], s3 offen sc1
L_sk_195:
    v_cmp_eq_u32 vcc, -1, v191
    s_cbranch_vccz L_sk_196
    s_xor_b32 s3, s54, 28672
    buffer_load_dwordx4 v[188:191], v9, s[8:11], s3 offen sc1
L_sk_196:
    v_cmp_eq_u32 vcc, -1, v195
    s_cbranch_vccz L_sk_197
    s_xor_b32 s3, s54, 32768
    buffer_load_dwordx4 v[192:195], v8, s[8:11], s3 offen sc1
L_sk_197:
    v_cmp_eq_u32 vcc, -1, v199
    s_cbranch_vccz L_sk_198
    s_xor_b32 s3, s54, 32768
    buffer_load_dwordx4 v[196:199], v9, s[8:11], s3 offen sc1
L_sk_198:
    v_cmp_eq_u32 vcc, -1, v203
    s_cbranch_vccz L_sk_199
    s_xor_b32 s3, s54, 36864
    buffer_load_dwordx4 v[200:203], v8, s[8:11], s3 offen sc1
L_sk_199:
    v_cmp_eq_u32 vcc, -1, v207
    s_cbranch_vccz L_sk_200
    s_xor_b32 s3, s54, 36864
    buffer_load_dwordx4 v[204:207], v9, s[8:11], s3 offen sc1
L_sk_200:
    s_waitcnt vmcnt(0)
    s_sub_u32 s47, s47, 1
    s_cbranch_scc1 L_gu_8
    v_max3_u32 v2, v147, v151, v155
    v_max_u32 v2, v2, v159
    v_cmp_eq_u32 vcc, -1, v2
    s_cbranch_vccnz L_rl_7
    s_branch L_back_6
L_gu_8:
    s_mov_b32 s47, 0
    s_branch L_back_6
L_slow_9:
    s_waitcnt vmcnt(0)
L_rl_11:
    v_cmp_eq_u32 vcc, -1, v163
    s_cbranch_vccz L_sk_201
    s_xor_b32 s3, s54, 16384
    buffer_load_dwordx4 v[160:163], v8, s[8:11], s3 offen sc1
L_sk_201:
    v_cmp_eq_u32 vcc, -1, v167
    s_cbranch_vccz L_sk_202
    s_xor_b32 s3, s54, 16384
    buffer_load_dwordx4 v[164:167], v9, s[8:11], s3 offen sc1
L_sk_202:
    v_cmp_eq_u32 vcc, -1, v171
    s_cbranch_vccz L_sk_203
    s_xor_b32 s3, s54, 20480
    buffer_load_dwordx4 v[168:171], v8, s[8:11], s3 offen sc1
L_sk_203:
    v_cmp_eq_u32 vcc, -1, v175
    s_cbranch_vccz L_sk_204
    s_xor_b32 s3, s54, 20480
    buffer_load_dwordx4 v[172:175], v9, s[8:11], s3 offen sc1
L_sk_204:
    v_cmp_eq_u32 vcc, -1, v179
    s_cbranch_vccz L_sk_205
    s_xor_b32 s3, s54, 24576
    buffer_load_dwordx4 v[176:179], v8, s[8:11], s3 offen sc1
L_sk_205:
    v_cmp_eq_u32 vcc, -1, v183
    s_cbranch_vccz L_sk_206
    s_xor_b32 s3, s54, 24576
    buffer_load_dwordx4 v[180:183], v9, s[8:11], s3 offen sc1
L_sk_206:
    v_cmp_eq_u32 vcc, -1, v187
    s_cbranch_vccz L_sk_207
    s_xor_b32 s3, s54, 28672
    buffer_load_dwordx4 v[184:187], v8, s[8:11], s3 offen sc1
L_sk_207:
    v_cmp_eq_u32 vcc, -1, v191
    s_cbranch_vccz L_sk_208
    s_xor_b32 s3, s54, 28672
    buffer_load_dwordx4 v[188:191], v9, s[8:11], s3 offen sc1
L_sk_208:
    v_cmp_eq_u32 vcc, -1, v195
    s_cbranch_vccz L_sk_209
    s_xor_b32 s3, s54, 32768
    buffer_load_dwordx4 v[192:195], v8, s[8:11], s3 offen sc1
L_sk_209:
    v_cmp_eq_u32 vcc, -1, v199
    s_cbranch_vccz L_sk_210
    s_xor_b32 s3, s54, 32768
    buffer_load_dwordx4 v[196:199], v9, s[8:11], s3 offen sc1
L_sk_210:
    v_cmp_eq_u32 vcc, -1, v203
    s_cbranch_vccz L_sk_211
    s_xor_b32 s3, s54, 36864
    buffer_load_dwordx4 v[200:203], v8, s[8:11], s3 offen sc1
L_sk_211:
    v_cmp_eq_u32 vcc, -1, v207
    s_cbranch_vccz L_sk_212
    s_xor_b32 s3, s54, 36864
    buffer_load_dwordx4 v[204:207], v9, s[8:11], s3 offen sc1
L_sk_212:
    v_cmp_eq_u32 vcc, -1, v211
    s_cbranch_vccz L_sk_213
    s_xor_b32 s3, s54, 40960
    buffer_load_dwordx4 v[208:211], v8, s[8:11], s3 offen sc1
L_sk_213:
    v_cmp_eq_u32 vcc, -1, v215
    s_cbranch_vccz L_sk_214
    s_xor_b32 s3, s54, 40960
    buffer_load_dwordx4 v[212:215], v9, s[8:11], s3 offen sc1
L_sk_214:
    v_cmp_eq_u32 vcc, -1, v219
    s_cbranch_vccz L_sk_215
    s_xor_b32 s3, s54, 45056
    buffer_load_dwordx4 v[216:219], v8, s[8:11], s3 offen sc1
L_sk_215:
    v_cmp_eq_u32 vcc, -1, v223
    s_cbranch_vccz L_sk_216
    s_xor_b32 s3, s54, 45056
    buffer_load_dwordx4 v[220:223], v9, s[8:11], s3 offen sc1
L_sk_216:
    v_cmp_eq_u32 vcc, -1, v227
    s_cbranch_vccz L_sk_217
    s_xor_b32 s3, s54, 49152
    buffer_load_dwordx4 v[224:227], v8, s[8:11], s3 offen sc1
L_sk_217:
    v_cmp_eq_u32 vcc, -1, v231
    s_cbranch_vccz L_sk_218
    s_xor_b32 s3, s54, 49152
    buffer_load_dwordx4 v[228:231], v9, s[8:11], s3 offen sc1
L_sk_218:
    v_cmp_eq_u32 vcc, -1, v235
    s_cbranch_vccz L_sk_219
    s_xor_b32 s3, s54, 53248
    buffer_load_dwordx4 v[232:235], v8, s[8:11], s3 offen sc1
L_sk_219:
    v_cmp_eq_u32 vcc, -1, v239
    s_cbranch_vccz L_sk_220
    s_xor_b32 s3, s54, 53248
    buffer_load_dwordx4 v[236:239], v9, s[8:11], s3 offen sc1
L_sk_220:
    v_cmp_eq_u32 vcc, -1, v243
    s_cbranch_vccz L_sk_221
    s_xor_b32 s3, s54, 57344
    buffer_load_dwordx4 v[240:243], v8, s[8:11], s3 offen sc1
L_sk_221:
    v_cmp_eq_u32 vcc, -1, v247
    s_cbranch_vccz L_sk_222
    s_xor_b32 s3, s54, 57344
    buffer_load_dwordx4 v[244:247], v9, s[8:11], s3 offen sc1
L_sk_222:
    v_cmp_eq_u32 vcc, -1, v251
    s_cbranch_vccz L_sk_223
    s_xor_b32 s3, s54, 61440
    buffer_load_dwordx4 v[248:251], v8, s[8:11], s3 offen sc1
L_sk_223:
    v_cmp_eq_u32 vcc, -1, v255
    s_cbranch_vccz L_sk_224
    s_xor_b32 s3, s54, 61440
    buffer_load_dwordx4 v[252:255], v9, s[8:11], s3 offen sc1
L_sk_224:
    s_waitcnt vmcnt(0)
    s_sub_u32 s47, s47, 1
    s_cbranch_scc1 L_gu_12
    v_max3_u32 v2, v163, v167, v171
    v_max_u32 v2, v2, v175
    v_cmp_eq_u32 vcc, -1, v2
    s_cbranch_vccnz L_rl_11
    s_branch L_back_10
L_gu_12:
    s_mov_b32 s47, 0
    s_branch L_back_10
L_wt_13:
    buffer_store_dwordx4 v[4:7], v1, s[8:11], s62 offen offset:0 sc1
    buffer_store_dwordx4 v[4:7], v1, s[8:11], s62 offen offset:1024 sc1
    s_mov_b64 exec, 0xffff
    buffer_store_dwordx4 v[4:7], v1, s[8:11], s61 offen offset:0 sc1
    s_mov_b64 exec, -1
    s_branch L_wb_14
L_wt_15:
    buffer_store_dwordx4 v[4:7], v1, s[8:11], s63 offen offset:0 sc1
    buffer_store_dwordx4 v[4:7], v1, s[8:11], s63 offen offset:1024 sc1
    buffer_store_dwordx4 v[4:7], v1, s[8:11], s64 offen offset:0 sc1
    buffer_store_dwordx4 v[4:7], v1, s[8:11], s64 offen offset:1024 sc1
    buffer_store_dwordx4 v[4:7], v1, s[8:11], s65 offen offset:0 sc1
    buffer_store_dwordx4 v[4:7], v1, s[8:11], s65 offen offset:1024 sc1
    s_branch L_wb_16
L_slow_17:
    s_waitcnt vmcnt(0)
L_rl_19:
    v_cmp_eq_u32 vcc, -1, v179
    s_cbranch_vccz L_sk_225
    s_xor_b32 s3, s54, 24576
    buffer_load_dwordx4 v[176:179], v8, s[8:11], s3 offen sc1
L_sk_225:
    v_cmp_eq_u32 vcc, -1, v183
    s_cbranch_vccz L_sk_226
    s_xor_b32 s3, s54, 24576
    buffer_load_dwordx4 v[180:183], v9, s[8:11], s3 offen sc1
L_sk_226:
    v_cmp_eq_u32 vcc, -1, v187
    s_cbranch_vccz L_sk_227
    s_xor_b32 s3, s54, 28672
    buffer_load_dwordx4 v[184:187], v8, s[8:11], s3 offen sc1
L_sk_227:
    v_cmp_eq_u32 vcc, -1, v191
    s_cbranch_vccz L_sk_228
    s_xor_b32 s3, s54, 28672
    buffer_load_dwordx4 v[188:191], v9, s[8:11], s3 offen sc1
L_sk_228:
    v_cmp_eq_u32 vcc, -1, v195
    s_cbranch_vccz L_sk_229
    s_xor_b32 s3, s54, 32768
    buffer_load_dwordx4 v[192:195], v8, s[8:11], s3 offen sc1
L_sk_229:
    v_cmp_eq_u32 vcc, -1, v199
    s_cbranch_vccz L_sk_230
    s_xor_b32 s3, s54, 32768
    buffer_load_dwordx4 v[196:199], v9, s[8:11], s3 offen sc1
L_sk_230:
    v_cmp_eq_u32 vcc, -1, v203
    s_cbranch_vccz L_sk_231
    s_xor_b32 s3, s54, 36864
    buffer_load_dwordx4 v[200:203], v8, s[8:11], s3 offen sc1
L_sk_231:
    v_cmp_eq_u32 vcc, -1, v207
    s_cbranch_vccz L_sk_232
    s_xor_b32 s3, s54, 36864
    buffer_load_dwordx4 v[204:207], v9, s[8:11], s3 offen sc1
L_sk_232:
    v_cmp_eq_u32 vcc, -1, v211
    s_cbranch_vccz L_sk_233
    s_xor_b32 s3, s54, 40960
    buffer_load_dwordx4 v[208:211], v8, s[8:11], s3 offen sc1
L_sk_233:
    v_cmp_eq_u32 vcc, -1, v215
    s_cbranch_vccz L_sk_234
    s_xor_b32 s3, s54, 40960
    buffer_load_dwordx4 v[212:215], v9, s[8:11], s3 offen sc1
L_sk_234:
    v_cmp_eq_u32 vcc, -1, v219
    s_cbranch_vccz L_sk_235
    s_xor_b32 s3, s54, 45056
    buffer_load_dwordx4 v[216:219], v8, s[8:11], s3 offen sc1
L_sk_235:
    v_cmp_eq_u32 vcc, -1, v223
    s_cbranch_vccz L_sk_236
    s_xor_b32 s3, s54, 45056
    buffer_load_dwordx4 v[220:223], v9, s[8:11], s3 offen sc1
L_sk_236:
    v_cmp_eq_u32 vcc, -1, v227
    s_cbranch_vccz L_sk_237
    s_xor_b32 s3, s54, 49152
    buffer_load_dwordx4 v[224:227], v8, s[8:11], s3 offen sc1
L_sk_237:
    v_cmp_eq_u32 vcc, -1, v231
    s_cbranch_vccz L_sk_238
    s_xor_b32 s3, s54, 49152
    buffer_load_dwordx4 v[228:231], v9, s[8:11], s3 offen sc1
L_sk_238:
    v_cmp_eq_u32 vcc, -1, v235
    s_cbranch_vccz L_sk_239
    s_xor_b32 s3, s54, 53248
    buffer_load_dwordx4 v[232:235], v8, s[8:11], s3 offen sc1
L_sk_239:
    v_cmp_eq_u32 vcc, -1, v239
    s_cbranch_vccz L_sk_240
    s_xor_b32 s3, s54, 53248
    buffer_load_dwordx4 v[236:239], v9, s[8:11], s3 offen sc1
L_sk_240:
    v_cmp_eq_u32 vcc, -1, v243
    s_cbranch_vccz L_sk_241
    s_xor_b32 s3, s54, 57344
    buffer_load_dwordx4 v[240:243], v8, s[8:11], s3 offen sc1
L_sk_241:
    v_cmp_eq_u32 vcc, -1, v247
    s_cbranch_vccz L_sk_242
    s_xor_b32 s3, s54, 57344
    buffer_load_dwordx4 v[244:247], v9, s[8:11], s3 offen sc1
L_sk_242:
    v_cmp_eq_u32 vcc, -1, v251
    s_cbranch_vccz L_sk_243
    s_xor_b32 s3, s54, 61440
    buffer_load_dwordx4 v[248:251], v8, s[8:11], s3 offen sc1
L_sk_243:
    v_cmp_eq_u32 vcc, -1, v255
    s_cbranch_vccz L_sk_244
    s_xor_b32 s3, s54, 61440
    buffer_load_dwordx4 v[252:255], v9, s[8:11], s3 offen sc1
L_sk_244:
    s_waitcnt vmcnt(0)
    s_sub_u32 s47, s47, 1
    s_cbranch_scc1 L_gu_20
    v_max3_u32 v2, v179, v183, v187
    v_max_u32 v2, v2, v191
    v_cmp_eq_u32 vcc, -1, v2
    s_cbranch_vccnz L_rl_19
    s_branch L_back_18
L_gu_20:
    s_mov_b32 s47, 0
    s_branch L_back_18
L_slow_21:
    s_waitcnt vmcnt(0)
L_rl_23:
    v_cmp_eq_u32 vcc, -1, v195
    s_cbranch_vccz L_sk_245
    s_xor_b32 s3, s54, 32768
    buffer_load_dwordx4 v[192:195], v8, s[8:11], s3 offen sc1
L_sk_245:
    v_cmp_eq_u32 vcc, -1, v199
    s_cbranch_vccz L_sk_246
    s_xor_b32 s3, s54, 32768
    buffer_load_dwordx4 v[196:199], v9, s[8:11], s3 offen sc1
L_sk_246:
    v_cmp_eq_u32 vcc, -1, v203
    s_cbranch_vccz L_sk_247
    s_xor_b32 s3, s54, 36864
    buffer_load_dwordx4 v[200:203], v8, s[8:11], s3 offen sc1
L_sk_247:
    v_cmp_eq_u32 vcc, -1, v207
    s_cbranch_vccz L_sk_248
    s_xor_b32 s3, s54, 36864
    buffer_load_dwordx4 v[204:207], v9, s[8:11], s3 offen sc1
L_sk_248:
    v_cmp_eq_u32 vcc, -1, v211
    s_cbranch_vccz L_sk_249
    s_xor_b32 s3, s54, 40960
    buffer_load_dwordx4 v[208:211], v8, s[8:11], s3 offen sc1
L_sk_249:
    v_cmp_eq_u32 vcc, -1, v215
    s_cbranch_vccz L_sk_250
    s_xor_b32 s3, s54, 40960
    buffer_load_dwordx4 v[212:215], v9, s[8:11], s3 offen sc1
L_sk_250:
    v_cmp_eq_u32 vcc, -1, v219
    s_cbranch_vccz L_sk_251
    s_xor_b32 s3, s54, 45056
    buffer_load_dwordx4 v[216:219], v8, s[8:11], s3 offen sc1
L_sk_251:
    v_cmp_eq_u32 vcc, -1, v223
    s_cbranch_vccz L_sk_252
    s_xor_b32 s3, s54, 45056
    buffer_load_dwordx4 v[220:223], v9, s[8:11], s3 offen sc1
L_sk_252:
    v_cmp_eq_u32 vcc, -1, v227
    s_cbranch_vccz L_sk_253
    s_xor_b32 s3, s54, 49152
    buffer_load_dwordx4 v[224:227], v8, s[8:11], s3 offen sc1
L_sk_253:
    v_cmp_eq_u32 vcc, -1, v231
    s_cbranch_vccz L_sk_254
    s_xor_b32 s3, s54, 49152
    buffer_load_dwordx4 v[228:231], v9, s[8:11], s3 offen sc1
L_sk_254:
    v_cmp_eq_u32 vcc, -1, v235
    s_cbranch_vccz L_sk_255
    s_xor_b32 s3, s54, 53248
    buffer_load_dwordx4 v[232:235], v8, s[8:11], s3 offen sc1
L_sk_255:
    v_cmp_eq_u32 vcc, -1, v239
    s_cbranch_vccz L_sk_256
    s_xor_b32 s3, s54, 53248
    buffer_load_dwordx4 v[236:239], v9, s[8:11], s3 offen sc1
L_sk_256:
    v_cmp_eq_u32 vcc, -1, v243
    s_cbranch_vccz L_sk_257
    s_xor_b32 s3, s54, 57344
    buffer_load_dwordx4 v[240:243], v8, s[8:11], s3 offen sc1
L_sk_257:
    v_cmp_eq_u32 vcc, -1, v247
    s_cbranch_vccz L_sk_258
    s_xor_b32 s3, s54, 57344
    buffer_load_dwordx4 v[244:247], v9, s[8:11], s3 offen sc1
L_sk_258:
    v_cmp_eq_u32 vcc, -1, v251
    s_cbranch_vccz L_sk_259
    s_xor_b32 s3, s54, 61440
    buffer_load_dwordx4 v[248:251], v8, s[8:11], s3 offen sc1
L_sk_259:
    v_cmp_eq_u32 vcc, -1, v255
    s_cbranch_vccz L_sk_260
    s_xor_b32 s3, s54, 61440
    buffer_load_dwordx4 v[252:255], v9, s[8:11], s3 offen sc1
L_sk_260:
    s_waitcnt vmcnt(0)
    s_sub_u32 s47, s47, 1
    s_cbranch_scc1 L_gu_24
    v_max3_u32 v2, v195, v199, v203
    v_max_u32 v2, v2, v207
    v_cmp_eq_u32 vcc, -1, v2
    s_cbranch_vccnz L_rl_23
    s_branch L_back_22
L_gu_24:
    s_mov_b32 s47, 0
    s_branch L_back_22
L_slow_25:
    s_waitcnt vmcnt(0)
L_rl_27:
    v_cmp_eq_u32 vcc, -1, v211
    s_cbranch_vccz L_sk_261
    s_xor_b32 s3, s54, 40960
    buffer_load_dwordx4 v[208:211], v8, s[8:11], s3 offen sc1
L_sk_261:
    v_cmp_eq_u32 vcc, -1, v215
    s_cbranch_vccz L_sk_262
    s_xor_b32 s3, s54, 40960
    buffer_load_dwordx4 v[212:215], v9, s[8:11], s3 offen sc1
L_sk_262:
    v_cmp_eq_u32 vcc, -1, v219
    s_cbranch_vccz L_sk_263
    s_xor_b32 s3, s54, 45056
    buffer_load_dwordx4 v[216:219], v8, s[8:11], s3 offen sc1
L_sk_263:
    v_cmp_eq_u32 vcc, -1, v223
    s_cbranch_vccz L_sk_264
    s_xor_b32 s3, s54, 45056
    buffer_load_dwordx4 v[220:223], v9, s[8:11], s3 offen sc1
L_sk_264:
    v_cmp_eq_u32 vcc, -1, v227
    s_cbranch_vccz L_sk_265
    s_xor_b32 s3, s54, 49152
    buffer_load_dwordx4 v[224:227], v8, s[8:11], s3 offen sc1
L_sk_265:
    v_cmp_eq_u32 vcc, -1, v231
    s_cbranch_vccz L_sk_266
    s_xor_b32 s3, s54, 49152
    buffer_load_dwordx4 v[228:231], v9, s[8:11], s3 offen sc1
L_sk_266:
    v_cmp_eq_u32 vcc, -1, v235
    s_cbranch_vccz L_sk_267
    s_xor_b32 s3, s54, 53248
    buffer_load_dwordx4 v[232:235], v8, s[8:11], s3 offen sc1
L_sk_267:
    v_cmp_eq_u32 vcc, -1, v239
    s_cbranch_vccz L_sk_268
    s_xor_b32 s3, s54, 53248
    buffer_load_dwordx4 v[236:239], v9, s[8:11], s3 offen sc1
L_sk_268:
    v_cmp_eq_u32 vcc, -1, v243
    s_cbranch_vccz L_sk_269
    s_xor_b32 s3, s54, 57344
    buffer_load_dwordx4 v[240:243], v8, s[8:11], s3 offen sc1
L_sk_269:
    v_cmp_eq_u32 vcc, -1, v247
    s_cbranch_vccz L_sk_270
    s_xor_b32 s3, s54, 57344
    buffer_load_dwordx4 v[244:247], v9, s[8:11], s3 offen sc1
L_sk_270:
    v_cmp_eq_u32 vcc, -1, v251
    s_cbranch_vccz L_sk_271
    s_xor_b32 s3, s54, 61440
    buffer_load_dwordx4 v[248:251], v8, s[8:11], s3 offen sc1
L_sk_271:
    v_cmp_eq_u32 vcc, -1, v255
    s_cbranch_vccz L_sk_272
    s_xor_b32 s3, s54, 61440
    buffer_load_dwordx4 v[252:255], v9, s[8:11], s3 offen sc1
L_sk_272:
    s_waitcnt vmcnt(0)
    s_sub_u32 s47, s47, 1
    s_cbranch_scc1 L_gu_28
    v_max3_u32 v2, v211, v215, v219
    v_max_u32 v2, v2, v223
    v_cmp_eq_u32 vcc, -1, v2
    s_cbranch_vccnz L_rl_27
    s_branch L_back_26
L_gu_28:
    s_mov_b32 s47, 0
    s_branch L_back_26
L_slow_30:
    s_waitcnt vmcnt(0)
L_rl_32:
    v_cmp_eq_u32 vcc, -1, v227
    s_cbranch_vccz L_sk_273
    s_xor_b32 s3, s54, 49152
    buffer_load_dwordx4 v[224:227], v8, s[8:11], s3 offen sc1
L_sk_273:
    v_cmp_eq_u32 vcc, -1, v231
    s_cbranch_vccz L_sk_274
    s_xor_b32 s3, s54, 49152
    buffer_load_dwordx4 v[228:231], v9, s[8:11], s3 offen sc1
L_sk_274:
    v_cmp_eq_u32 vcc, -1, v235
    s_cbranch_vccz L_sk_275
    s_xor_b32 s3, s54, 53248
    buffer_load_dwordx4 v[232:235], v8, s[8:11], s3 offen sc1
L_sk_275:
    v_cmp_eq_u32 vcc, -1, v239
    s_cbranch_vccz L_sk_276
    s_xor_b32 s3, s54, 53248
    buffer_load_dwordx4 v[236:239], v9, s[8:11], s3 offen sc1
L_sk_276:
    v_cmp_eq_u32 vcc, -1, v243
    s_cbranch_vccz L_sk_277
    s_xor_b32 s3, s54, 57344
    buffer_load_dwordx4 v[240:243], v8, s[8:11], s3 offen sc1
L_sk_277:
    v_cmp_eq_u32 vcc, -1, v247
    s_cbranch_vccz L_sk_278
    s_xor_b32 s3, s54, 57344
    buffer_load_dwordx4 v[244:247], v9, s[8:11], s3 offen sc1
L_sk_278:
    v_cmp_eq_u32 vcc, -1, v251
    s_cbranch_vccz L_sk_279
    s_xor_b32 s3, s54, 61440
    buffer_load_dwordx4 v[248:251], v8, s[8:11], s3 offen sc1
L_sk_279:
    v_cmp_eq_u32 vcc, -1, v255
    s_cbranch_vccz L_sk_280
    s_xor_b32 s3, s54, 61440
    buffer_load_dwordx4 v[252:255], v9, s[8:11], s3 offen sc1
L_sk_280:
    s_waitcnt vmcnt(0)
    s_sub_u32 s47, s47, 1
    s_cbranch_scc1 L_gu_33
    v_max3_u32 v2, v227, v231, v235
    v_max_u32 v2, v2, v239
    v_cmp_eq_u32 vcc, -1, v2
    s_cbranch_vccnz L_rl_32
    s_branch L_back_31
L_gu_33:
    s_mov_b32 s47, 0
    s_branch L_back_31
L_slow_34:
    s_waitcnt vmcnt(0)
L_rl_36:
    v_cmp_eq_u32 vcc, -1, v243
    s_cbranch_vccz L_sk_281
    s_xor_b32 s3, s54, 57344
    buffer_load_dwordx4 v[240:243], v8, s[8:11], s3 offen sc1
L_sk_281:
    v_cmp_eq_u32 vcc, -1, v247
    s_cbranch_vccz L_sk_282
    s_xor_b32 s3, s54, 57344
    buffer_load_dwordx4 v[244:247], v9, s[8:11], s3 offen sc1
L_sk_282:
    v_cmp_eq_u32 vcc, -1, v251
    s_cbranch_vccz L_sk_283
    s_xor_b32 s3, s54, 61440
    buffer_load_dwordx4 v[248:251], v8, s[8:11], s3 offen sc1
L_sk_283:
    v_cmp_eq_u32 vcc, -1, v255
    s_cbranch_vccz L_sk_284
    s_xor_b32 s3, s54, 61440
    buffer_load_dwordx4 v[252:255], v9, s[8:11], s3 offen sc1
L_sk_284:
    s_waitcnt vmcnt(0)
    s_sub_u32 s47, s47, 1
    s_cbranch_scc1 L_gu_37
    v_max3_u32 v2, v243, v247, v251
    v_max_u32 v2, v2, v255
    v_cmp_eq_u32 vcc, -1, v2
    s_cbranch_vccnz L_rl_36
    s_branch L_back_35
L_gu_37:
    s_mov_b32 s47, 0
    s_branch L_back_35
L_fs_38:
    buffer_load_dwordx2 v[18:19], v17, s[8:11], 0 offen sc1
    s_waitcnt vmcnt(0)
    s_sub_u32 s47, s47, 1
    s_cbranch_scc1 L_fg_40
    v_cmp_ne_u64 vcc, s[4:5], v[18:19]
    s_cbranch_vccnz L_fs_38
    s_branch L_fb_39
L_fg_40:
    s_mov_b32 s47, 0
    s_branch L_fb_39
L_slow_42:
    s_waitcnt vmcnt(0)
L_rl_44:
    v_cmp_eq_u32 vcc, -1, v131
    s_cbranch_vccz L_sk_285
    s_add_u32 s3, s53, 0
    buffer_load_dwordx4 v[128:131], v1, s[8:11], s3 offen sc1
L_sk_285:
    v_cmp_eq_u32 vcc, -1, v135
    s_cbranch_vccz L_sk_286
    s_add_u32 s3, s53, 2048
    buffer_load_dwordx4 v[132:135], v1, s[8:11], s3 offen sc1
L_sk_286:
    v_cmp_eq_u32 vcc, -1, v139
    s_cbranch_vccz L_sk_287
    s_add_u32 s3, s53, 4096
    buffer_load_dwordx4 v[136:139], v1, s[8:11], s3 offen sc1
L_sk_287:
    v_cmp_eq_u32 vcc, -1, v143
    s_cbranch_vccz L_sk_288
    s_add_u32 s3, s53, 6144
    buffer_load_dwordx4 v[140:143], v1, s[8:11], s3 offen sc1
L_sk_288:
    v_cmp_eq_u32 vcc, -1, v147
    s_cbranch_vccz L_sk_289
    s_add_u32 s3, s53, 8192
    buffer_load_dwordx4 v[144:147], v1, s[8:11], s3 offen sc1
L_sk_289:
    v_cmp_eq_u32 vcc, -1, v151
    s_cbranch_vccz L_sk_290
    s_add_u32 s3, s53, 10240
    buffer_load_dwordx4 v[148:151], v1, s[8:11], s3 offen sc1
L_sk_290:
    v_cmp_eq_u32 vcc, -1, v155
    s_cbranch_vccz L_sk_291
    s_add_u32 s3, s53, 12288
    buffer_load_dwordx4 v[152:155], v1, s[8:11], s3 offen sc1
L_sk_291:
    v_cmp_eq_u32 vcc, -1, v159
    s_cbranch_vccz L_sk_292
    s_add_u32 s3, s53, 14336
    buffer_load_dwordx4 v[156:159], v1, s[8:11], s3 offen sc1
L_sk_292:
    v_cmp_eq_u32 vcc, -1, v195
    s_cbranch_vccz L_sk_293
    s_add_u32 s3, s53, 16384
    buffer_load_dwordx4 v[192:195], v1, s[8:11], s3 offen sc1
L_sk_293:
    v_cmp_eq_u32 vcc, -1, v199
    s_cbranch_vccz L_sk_294
    s_add_u32 s3, s53, 18432
    buffer_load_dwordx4 v[196:199], v1, s[8:11], s3 offen sc1
L_sk_294:
    v_cmp_eq_u32 vcc, -1, v203
    s_cbranch_vccz L_sk_295
    s_add_u32 s3, s53, 20480
    buffer_load_dwordx4 v[200:203], v1, s[8:11], s3 offen sc1
L_sk_295:
    s_waitcnt vmcnt(0)
    s_sub_u32 s47, s47, 1
    s_cbranch_scc1 L_gu_45
    v_max3_u32 v2, v131, v135, v139
    v_max_u32 v2, v2, v143
    v_cmp_eq_u32 vcc, -1, v2
    s_cbranch_vccnz L_rl_44
    s_branch L_back_43
L_gu_45:
    s_mov_b32 s47, 0
    s_branch L_back_43
L_slow_46:
    s_waitcnt vmcnt(0)
L_rl_48:
    v_cmp_eq_u32 vcc, -1, v147
    s_cbranch_vccz L_sk_296
    s_add_u32 s3, s53, 8192
    buffer_load_dwordx4 v[144:147], v1, s[8:11], s3 offen sc1
L_sk_296:
    v_cmp_eq_u32 vcc, -1, v151
    s_cbranch_vccz L_sk_297
    s_add_u32 s3, s53, 10240
    buffer_load_dwordx4 v[148:151], v1, s[8:11], s3 offen sc1
L_sk_297:
    v_cmp_eq_u32 vcc, -1, v155
    s_cbranch_vccz L_sk_298
    s_add_u32 s3, s53, 12288
    buffer_load_dwordx4 v[152:155], v1, s[8:11], s3 offen sc1
L_sk_298:
    v_cmp_eq_u32 vcc, -1, v159
    s_cbranch_vccz L_sk_299
    s_add_u32 s3, s53, 14336
    buffer_load_dwordx4 v[156:159], v1, s[8:11], s3 offen sc1
L_sk_299:
    v_cmp_eq_u32 vcc, -1, v195
    s_cbranch_vccz L_sk_300
    s_add_u32 s3, s53, 16384
    buffer_load_dwordx4 v[192:195], v1, s[8:11], s3 offen sc1
L_sk_300:
    v_cmp_eq_u32 vcc, -1, v199
    s_cbranch_vccz L_sk_301
    s_add_u32 s3, s53, 18432
    buffer_load_dwordx4 v[196:199], v1, s[8:11], s3 offen sc1
L_sk_301:
    v_cmp_eq_u32 vcc, -1, v203
    s_cbranch_vccz L_sk_302
    s_add_u32 s3, s53, 20480
    buffer_load_dwordx4 v[200:203], v1, s[8:11], s3 offen sc1
L_sk_302:
    s_waitcnt vmcnt(0)
    s_sub_u32 s47, s47, 1
    s_cbranch_scc1 L_gu_49
    v_max3_u32 v2, v147, v151, v155
    v_max_u32 v2, v2, v159
    v_cmp_eq_u32 vcc, -1, v2
    s_cbranch_vccnz L_rl_48
    s_branch L_back_47
L_gu_49:
    s_mov_b32 s47, 0
    s_branch L_back_47
L_slow_50:
    s_waitcnt vmcnt(0)
L_rl_52:
    v_cmp_eq_u32 vcc, -1, v195
    s_cbranch_vccz L_sk_303
    s_add_u32 s3, s53, 16384
    buffer_load_dwordx4 v[192:195], v1, s[8:11], s3 offen sc1
L_sk_303:
    v_cmp_eq_u32 vcc, -1, v199
    s_cbranch_vccz L_sk_304
    s_add_u32 s3, s53, 18432
    buffer_load_dwordx4 v[196:199], v1, s[8:11], s3 offen sc1
L_sk_304:
    v_cmp_eq_u32 vcc, -1, v203
    s_cbranch_vccz L_sk_305
    s_add_u32 s3, s53, 20480
    buffer_load_dwordx4 v[200:203], v1, s[8:11], s3 offen sc1
L_sk_305:
    s_waitcnt vmcnt(0)
    s_sub_u32 s47, s47, 1
    s_cbranch_scc1 L_gu_53
    v_max3_u32 v2, v195, v199, v203
    v_cmp_eq_u32 vcc, -1, v2
    s_cbranch_vccnz L_rl_52
    s_branch L_back_51
L_gu_53:
    s_mov_b32 s47, 0
    s_branch L_back_51
L_gs_58:
    v_xor_b32 v5, s5, v5
    v_xor_b32 v4, s4, v4
    v_lshrrev_b32 v5, 4, v5
    v_or_b32 v4, v4, v5
    v_cmp_ne_u32 vcc, 0, v4
    s_cbranch_vccnz L_gr_62
    s_mov_b32 s66, 1
    buffer_store_dwordx4 v[140:143], v1, s[8:11], s51 offen sc1
    buffer_store_dwordx4 v[140:143], v1, s[8:11], s52 offen sc1
    buffer_store_dwordx4 v[140:143], v1, s[8:11], s53 offen sc1
    buffer_store_dwordx4 v[140:143], v1, s[8:11], s54 offen sc1
    buffer_store_dwordx4 v[140:143], v248, s[8:11], s55 offen offset:0 sc1
    buffer_store_dwordx4 v[140:143], v248, s[8:11], s55 offen offset:512 sc1
    s_waitcnt vmcnt(0)
    s_lshl_b32 s58, s45, 5
    s_add_u32 s58, s58, s46
    s_lshl_b32 s58, s58, 2
    s_add_u32 s58, s58, s44
    s_mul_i32 s58, s58, 16
    s_add_u32 s58, s58, 12288
    s_mov_b64 exec, 1
    v_mov_b32 v4, s4
    v_mov_b32 v5, s5
    buffer_store_dwordx2 v[4:5], off, s[8:11], s58 sc1
    s_mov_b64 exec, -1
    s_mul_i32 s58, s45, 2048
    s_add_u32 s58, s58, 12288
    s_add_u32 s59, s58, 1024
    v_mul_u32_u24 v6, 16, v0
L_g2_61:
    buffer_load_dwordx2 v[4:5], v6, s[8:11], s58 offen sc1
    buffer_load_dwordx2 v[2:3], v6, s[8:11], s59 offen sc1
    s_waitcnt vmcnt(0)
    s_sub_u32 s47, s47, 1
    s_cbranch_scc1 L_gg_60
    v_cmp_ne_u64 vcc, s[4:5], v[4:5]
    s_cbranch_vccnz L_g2_61
    v_cmp_ne_u64 vcc, s[4:5], v[2:3]
    s_cbranch_vccnz L_g2_61
    s_branch L_gb_59
L_gr_62:
    buffer_load_dwordx2 v[4:5], v6, s[8:11], 0 offen sc1
    s_waitcnt vmcnt(0)
    s_sub_u32 s47, s47, 1
    s_cbranch_scc1 L_gg_60
    v_cmp_ne_u64 vcc, s[6:7], v[4:5]
    s_cbranch_vccnz L_gs_58
    s_branch L_gb_59
L_gg_60:
    s_mov_b32 s47, 0
    s_branch L_gb_59
L_wt_63:
    buffer_store_dwordx4 v[228:231], v1, s[8:11], s53 offen sc1
    buffer_store_dwordx4 v[232:235], v1, s[8:11], s54 offen sc1
    s_branch L_wb_64
L_wt_65:
    buffer_store_dwordx4 v[236:239], v248, s[8:11], s55 offen offset:0 sc1
    buffer_store_dwordx4 v[240:243], v248, s[8:11], s55 offen offset:512 sc1
    s_branch L_wb_66
L_wt_67:
    buffer_store_dwordx4 v[220:223], v1, s[8:11], s51 offen sc1
    buffer_store_dwordx4 v[224:227], v1, s[8:11], s52 offen sc1
    s_branch L_wb_68
L_slow_69:
    s_waitcnt vmcnt(0)
L_rl_71:
    v_cmp_eq_u32 vcc, -1, v27
    s_cbranch_vccz L_sk_306
    s_add_u32 s3, s54, 0
    buffer_load_dwordx4 v[24:27], v1, s[8:11], s3 offen sc1
L_sk_306:
    v_cmp_eq_u32 vcc, -1, v31
    s_cbranch_vccz L_sk_307
    s_add_u32 s3, s54, 1024
    buffer_load_dwordx4 v[28:31], v1, s[8:11], s3 offen sc1
L_sk_307:
    s_waitcnt vmcnt(0)
    s_sub_u32 s47, s47, 1
    s_cbranch_scc1 L_gu_72
    v_max_u32 v4, v27, v31
    v_cmp_eq_u32 vcc, -1, v4
    s_cbranch_vccnz L_rl_71
    s_branch L_back_70
L_gu_72:
    s_mov_b32 s47, 0
    s_branch L_back_70
L_fb_a:
    v_and_b32 v18, 0x33, v0
    v_bfe_u32 v19, v0, 2, 1
    v_lshl_or_b32 v18, v19, 3, v18
    v_bfe_u32 v19, v0, 3, 1
    v_lshl_or_b32 v18, v19, 2, v18
    v_lshlrev_b32 v18, 4, v18
    s_lshl_b32 s57, s48, 16
    s_add_u32 s57, s57, 3145728
    s_mov_b32 s58, s57
    v_mov_b32 v48, 0xff800000
    s_mov_b32 s52, 0
L_fb1_a:
    buffer_load_dwordx4 v[128:131], v18, s[8:11], s58 offen sc1
    s_waitcnt vmcnt(0)
    v_mfma_f32_32x32x16_bf16 v[96:111], v[128:131], v[24:27], 0
    s_nop 7
    s_nop 7
    v_max3_f32 v48, v96, v97, v48
    v_max3_f32 v48, v98, v99, v48
    v_max3_f32 v48, v100, v101, v48
    v_max3_f32 v48, v102, v103, v48
    v_max3_f32 v48, v104, v105, v48
    v_max3_f32 v48, v106, v107, v48
    v_max3_f32 v48, v108, v109, v48
    v_max3_f32 v48, v110, v111, v48
    s_add_u32 s58, s58, 1024
    s_add_u32 s52, s52, 1
    s_cmp_lt_u32 s52, 64
    s_cbranch_scc1 L_fb1_a
    v_mov_b32 v49, v48
    s_nop 1
    v_permlane32_swap_b32 v48, v49
    s_nop 1
    v_max_f32 v48, v48, v49
    v_sub_f32 v48, 0, v48
    v_mov_b32 v32, v48
    v_mov_b32 v64, 0
    v_mov_b32 v33, v48
    v_mov_b32 v65, 0
    v_mov_b32 v34, v48
    v_mov_b32 v66, 0
    v_mov_b32 v35, v48
    v_mov_b32 v67, 0
    v_mov_b32 v36, v48
    v_mov_b32 v68, 0
    v_mov_b32 v37, v48
    v_mov_b32 v69, 0
    v_mov_b32 v38, v48
    v_mov_b32 v70, 0
    v_mov_b32 v39, v48
    v_mov_b32 v71, 0
    v_mov_b32 v40, v48
    v_mov_b32 v72, 0
    v_mov_b32 v41, v48
    v_mov_b32 v73, 0
    v_mov_b32 v42, v48
    v_mov_b32 v74, 0
    v_mov_b32 v43, v48
    v_mov_b32 v75, 0
    v_mov_b32 v44, v48
    v_mov_b32 v76, 0
    v_mov_b32 v45, v48
    v_mov_b32 v77, 0
    v_mov_b32 v46, v48
    v_mov_b32 v78, 0
    v_mov_b32 v47, v48
    v_mov_b32 v79, 0
    v_mov_b32 v136, 0x3f803f80
    v_mov_b32 v137, 0x3f803f80
    v_mov_b32 v138, 0x3f803f80
    v_mov_b32 v139, 0x3f803f80
    v_mov_b32 v140, 0x3f803f80
    v_mov_b32 v141, 0x3f803f80
    v_mov_b32 v142, 0x3f803f80
    v_mov_b32 v143, 0x3f803f80
    s_mov_b32 s58, s57
    s_mov_b32 s52, 0
    s_mov_b32 s64, 0x0000ffff
    s_mov_b32 s65, 0x0000ffff
L_fb2_a:
    s_add_u32 s59, s58, 0x200000
    buffer_load_dwordx4 v[128:131], v18, s[8:11], s58 offen sc1
    s_mov_b64 exec, s[64:65]
    buffer_load_dwordx4 v[136:139], v17, s[8:11], s59 offen sc1
    buffer_load_dwordx4 v[140:143], v17, s[8:11], s59 offen offset:512 sc1
    s_mov_b64 exec, -1
    s_waitcnt vmcnt(0)
    v_mfma_f32_32x32x16_bf16 v[96:111], v[128:131], v[24:27], v[32:47]
    s_nop 7
    s_nop 7
    v_exp_f32 v96, v96
    v_exp_f32 v97, v97
    v_exp_f32 v98, v98
    v_exp_f32 v99, v99
    v_exp_f32 v100, v100
    v_exp_f32 v101, v101
    v_exp_f32 v102, v102
    v_exp_f32 v103, v103
    v_exp_f32 v104, v104
    v_exp_f32 v105, v105
    v_exp_f32 v106, v106
    v_exp_f32 v107, v107
    v_exp_f32 v108, v108
    v_exp_f32 v109, v109
    v_exp_f32 v110, v110
    v_exp_f32 v111, v111
    s_nop 1
    v_smfmac_f32_32x32x32_bf16 v[64:79], v[136:139], v[96:103], v16
    v_smfmac_f32_32x32x32_bf16 v[64:79], v[140:143], v[104:111], v16
    s_nop 7
    s_add_u32 s58, s58, 1024
    s_add_u32 s52, s52, 1
    s_cmp_lt_u32 s52, 64
    s_cbranch_scc1 L_fb2_a
    s_nop 7
    s_nop 7
    s_branch L_fz_a
L_fb_b:
    v_and_b32 v18, 0x33, v0
    v_bfe_u32 v19, v0, 2, 1
    v_lshl_or_b32 v18, v19, 3, v18
    v_bfe_u32 v19, v0, 3, 1
    v_lshl_or_b32 v18, v19, 2, v18
    v_lshlrev_b32 v18, 4, v18
    s_lshl_b32 s57, s48, 16
    s_add_u32 s57, s57, 3145728
    s_mov_b32 s58, s57
    v_mov_b32 v48, 0xff800000
    s_mov_b32 s52, 0
L_fb1_b:
    buffer_load_dwordx4 v[128:131], v18, s[8:11], s58 offen sc1
    s_waitcnt vmcnt(0)
    v_mfma_f32_32x32x16_bf16 v[96:111], v[128:131], v[28:31], 0
    s_nop 7
    s_nop 7
    v_max3_f32 v48, v96, v97, v48
    v_max3_f32 v48, v98, v99, v48
    v_max3_f32 v48, v100, v101, v48
    v_max3_f32 v48, v102, v103, v48
    v_max3_f32 v48, v104, v105, v48
    v_max3_f32 v48, v106, v107, v48
    v_max3_f32 v48, v108, v109, v48
    v_max3_f32 v48, v110, v111, v48
    s_add_u32 s58, s58, 1024
    s_add_u32 s52, s52, 1
    s_cmp_lt_u32 s52, 64
    s_cbranch_scc1 L_fb1_b
    v_mov_b32 v49, v48
    s_nop 1
    v_permlane32_swap_b32 v48, v49
    s_nop 1
    v_max_f32 v48, v48, v49
    v_sub_f32 v48, 0, v48
    v_mov_b32 v32, v48
    v_mov_b32 v80, 0
    v_mov_b32 v33, v48
    v_mov_b32 v81, 0
    v_mov_b32 v34, v48
    v_mov_b32 v82, 0
    v_mov_b32 v35, v48
    v_mov_b32 v83, 0
    v_mov_b32 v36, v48
    v_mov_b32 v84, 0
    v_mov_b32 v37, v48
    v_mov_b32 v85, 0
    v_mov_b32 v38, v48
    v_mov_b32 v86, 0
    v_mov_b32 v39, v48
    v_mov_b32 v87, 0
    v_mov_b32 v40, v48
    v_mov_b32 v88, 0
    v_mov_b32 v41, v48
    v_mov_b32 v89, 0
    v_mov_b32 v42, v48
    v_mov_b32 v90, 0
    v_mov_b32 v43, v48
    v_mov_b32 v91, 0
    v_mov_b32 v44, v48
    v_mov_b32 v92, 0
    v_mov_b32 v45, v48
    v_mov_b32 v93, 0
    v_mov_b32 v46, v48
    v_mov_b32 v94, 0
    v_mov_b32 v47, v48
    v_mov_b32 v95, 0
    v_mov_b32 v136, 0x3f803f80
    v_mov_b32 v137, 0x3f803f80
    v_mov_b32 v138, 0x3f803f80
    v_mov_b32 v139, 0x3f803f80
    v_mov_b32 v140, 0x3f803f80
    v_mov_b32 v141, 0x3f803f80
    v_mov_b32 v142, 0x3f803f80
    v_mov_b32 v143, 0x3f803f80
    s_mov_b32 s58, s57
    s_mov_b32 s52, 0
    s_mov_b32 s64, 0x0000ffff
    s_mov_b32 s65, 0x0000ffff
L_fb2_b:
    s_add_u32 s59, s58, 0x200000
    buffer_load_dwordx4 v[128:131], v18, s[8:11], s58 offen sc1
    s_mov_b64 exec, s[64:65]
    buffer_load_dwordx4 v[136:139], v17, s[8:11], s59 offen sc1
    buffer_load_dwordx4 v[140:143], v17, s[8:11], s59 offen offset:512 sc1
    s_mov_b64 exec, -1
    s_waitcnt vmcnt(0)
    v_mfma_f32_32x32x16_bf16 v[96:111], v[128:131], v[28:31], v[32:47]
    s_nop 7
    s_nop 7
    v_exp_f32 v96, v96
    v_exp_f32 v97, v97
    v_exp_f32 v98, v98
    v_exp_f32 v99, v99
    v_exp_f32 v100, v100
    v_exp_f32 v101, v101
    v_exp_f32 v102, v102
    v_exp_f32 v103, v103
    v_exp_f32 v104, v104
    v_exp_f32 v105, v105
    v_exp_f32 v106, v106
    v_exp_f32 v107, v107
    v_exp_f32 v108, v108
    v_exp_f32 v109, v109
    v_exp_f32 v110, v110
    v_exp_f32 v111, v111
    s_nop 1
    v_smfmac_f32_32x32x32_bf16 v[80:95], v[136:139], v[96:103], v16
    v_smfmac_f32_32x32x32_bf16 v[80:95], v[140:143], v[104:111], v16
    s_nop 7
    s_add_u32 s58, s58, 1024
    s_add_u32 s52, s52, 1
    s_cmp_lt_u32 s52, 64
    s_cbranch_scc1 L_fb2_b
    s_nop 7
    s_nop 7
    s_branch L_fz_b
L_slow_73:
    s_waitcnt vmcnt(0)
L_rl_75:
    v_cmp_eq_u32 vcc, -1, v163
    s_cbranch_vccz L_sk_308
    s_add_u32 s3, s48, 0
    buffer_load_dwordx4 v[160:163], v1, s[8:11], s3 offen sc1
L_sk_308:
    v_cmp_eq_u32 vcc, -1, v167
    s_cbranch_vccz L_sk_309
    s_add_u32 s3, s48, 2048
    buffer_load_dwordx4 v[164:167], v1, s[8:11], s3 offen sc1
L_sk_309:
    v_cmp_eq_u32 vcc, -1, v171
    s_cbranch_vccz L_sk_310
    s_add_u32 s3, s48, 4096
    buffer_load_dwordx4 v[168:171], v1, s[8:11], s3 offen sc1
L_sk_310:
    v_cmp_eq_u32 vcc, -1, v175
    s_cbranch_vccz L_sk_311
    s_add_u32 s3, s48, 6144
    buffer_load_dwordx4 v[172:175], v1, s[8:11], s3 offen sc1
L_sk_311:
    v_cmp_eq_u32 vcc, -1, v179
    s_cbranch_vccz L_sk_312
    s_add_u32 s3, s48, 8192
    buffer_load_dwordx4 v[176:179], v1, s[8:11], s3 offen sc1
L_sk_312:
    v_cmp_eq_u32 vcc, -1, v183
    s_cbranch_vccz L_sk_313
    s_add_u32 s3, s48, 10240
    buffer_load_dwordx4 v[180:183], v1, s[8:11], s3 offen sc1
L_sk_313:
    v_cmp_eq_u32 vcc, -1, v187
    s_cbranch_vccz L_sk_314
    s_add_u32 s3, s48, 12288
    buffer_load_dwordx4 v[184:187], v1, s[8:11], s3 offen sc1
L_sk_314:
    v_cmp_eq_u32 vcc, -1, v191
    s_cbranch_vccz L_sk_315
    s_add_u32 s3, s48, 14336
    buffer_load_dwordx4 v[188:191], v1, s[8:11], s3 offen sc1
L_sk_315:
    v_cmp_eq_u32 vcc, -1, v195
    s_cbranch_vccz L_sk_316
    s_add_u32 s3, s48, 16384
    buffer_load_dwordx4 v[192:195], v1, s[8:11], s3 offen sc1
L_sk_316:
    v_cmp_eq_u32 vcc, -1, v199
    s_cbranch_vccz L_sk_317
    s_add_u32 s3, s48, 18432
    buffer_load_dwordx4 v[196:199], v1, s[8:11], s3 offen sc1
L_sk_317:
    v_cmp_eq_u32 vcc, -1, v203
    s_cbranch_vccz L_sk_318
    s_add_u32 s3, s48, 20480
    buffer_load_dwordx4 v[200:203], v1, s[8:11], s3 offen sc1
L_sk_318:
    v_cmp_eq_u32 vcc, -1, v207
    s_cbranch_vccz L_sk_319
    s_add_u32 s3, s48, 22528
    buffer_load_dwordx4 v[204:207], v1, s[8:11], s3 offen sc1
L_sk_319:
    v_cmp_eq_u32 vcc, -1, v211
    s_cbranch_vccz L_sk_320
    s_add_u32 s3, s48, 24576
    buffer_load_dwordx4 v[208:211], v1, s[8:11], s3 offen sc1
L_sk_320:
    v_cmp_eq_u32 vcc, -1, v215
    s_cbranch_vccz L_sk_321
    s_add_u32 s3, s48, 26624
    buffer_load_dwordx4 v[212:215], v1, s[8:11], s3 offen sc1
L_sk_321:
    v_cmp_eq_u32 vcc, -1, v219
    s_cbranch_vccz L_sk_322
    s_add_u32 s3, s48, 28672
    buffer_load_dwordx4 v[216:219], v1, s[8:11], s3 offen sc1
L_sk_322:
    v_cmp_eq_u32 vcc, -1, v223
    s_cbranch_vccz L_sk_323
    s_add_u32 s3, s48, 30720
    buffer_load_dwordx4 v[220:223], v1, s[8:11], s3 offen sc1
L_sk_323:
    s_waitcnt vmcnt(0)
    s_sub_u32 s47, s47, 1
    s_cbranch_scc1 L_gu_76
    v_max_u32 v4, v163, v167
    v_cmp_eq_u32 vcc, -1, v4
    s_cbranch_vccnz L_rl_75
    s_branch L_back_74
L_gu_76:
    s_mov_b32 s47, 0
    s_branch L_back_74
L_slow_77:
    s_waitcnt vmcnt(0)
L_rl_79:
    v_cmp_eq_u32 vcc, -1, v171
    s_cbranch_vccz L_sk_324
    s_add_u32 s3, s48, 4096
    buffer_load_dwordx4 v[168:171], v1, s[8:11], s3 offen sc1
L_sk_324:
    v_cmp_eq_u32 vcc, -1, v175
    s_cbranch_vccz L_sk_325
    s_add_u32 s3, s48, 6144
    buffer_load_dwordx4 v[172:175], v1, s[8:11], s3 offen sc1
L_sk_325:
    v_cmp_eq_u32 vcc, -1, v179
    s_cbranch_vccz L_sk_326
    s_add_u32 s3, s48, 8192
    buffer_load_dwordx4 v[176:179], v1, s[8:11], s3 offen sc1
L_sk_326:
    v_cmp_eq_u32 vcc, -1, v183
    s_cbranch_vccz L_sk_327
    s_add_u32 s3, s48, 10240
    buffer_load_dwordx4 v[180:183], v1, s[8:11], s3 offen sc1
L_sk_327:
    v_cmp_eq_u32 vcc, -1, v187
    s_cbranch_vccz L_sk_328
    s_add_u32 s3, s48, 12288
    buffer_load_dwordx4 v[184:187], v1, s[8:11], s3 offen sc1
L_sk_328:
    v_cmp_eq_u32 vcc, -1, v191
    s_cbranch_vccz L_sk_329
    s_add_u32 s3, s48, 14336
    buffer_load_dwordx4 v[188:191], v1, s[8:11], s3 offen sc1
L_sk_329:
    v_cmp_eq_u32 vcc, -1, v195
    s_cbranch_vccz L_sk_330
    s_add_u32 s3, s48, 16384
    buffer_load_dwordx4 v[192:195], v1, s[8:11], s3 offen sc1
L_sk_330:
    v_cmp_eq_u32 vcc, -1, v199
    s_cbranch_vccz L_sk_331
    s_add_u32 s3, s48, 18432
    buffer_load_dwordx4 v[196:199], v1, s[8:11], s3 offen sc1
L_sk_331:
    v_cmp_eq_u32 vcc, -1, v203
    s_cbranch_vccz L_sk_332
    s_add_u32 s3, s48, 20480
    buffer_load_dwordx4 v[200:203], v1, s[8:11], s3 offen sc1
L_sk_332:
    v_cmp_eq_u32 vcc, -1, v207
    s_cbranch_vccz L_sk_333
    s_add_u32 s3, s48, 22528
    buffer_load_dwordx4 v[204:207], v1, s[8:11], s3 offen sc1
L_sk_333:
    v_cmp_eq_u32 vcc, -1, v211
    s_cbranch_vccz L_sk_334
    s_add_u32 s3, s48, 24576
    buffer_load_dwordx4 v[208:211], v1, s[8:11], s3 offen sc1
L_sk_334:
    v_cmp_eq_u32 vcc, -1, v215
    s_cbranch_vccz L_sk_335
    s_add_u32 s3, s48, 26624
    buffer_load_dwordx4 v[212:215], v1, s[8:11], s3 offen sc1
L_sk_335:
    v_cmp_eq_u32 vcc, -1, v219
    s_cbranch_vccz L_sk_336
    s_add_u32 s3, s48, 28672
    buffer_load_dwordx4 v[216:219], v1, s[8:11], s3 offen sc1
L_sk_336:
    v_cmp_eq_u32 vcc, -1, v223
    s_cbranch_vccz L_sk_337
    s_add_u32 s3, s48, 30720
    buffer_load_dwordx4 v[220:223], v1, s[8:11], s3 offen sc1
L_sk_337:
    s_waitcnt vmcnt(0)
    s_sub_u32 s47, s47, 1
    s_cbranch_scc1 L_gu_80
    v_max_u32 v4, v171, v175
    v_cmp_eq_u32 vcc, -1, v4
    s_cbranch_vccnz L_rl_79
    s_branch L_back_78
L_gu_80:
    s_mov_b32 s47, 0
    s_branch L_back_78
L_slow_81:
    s_waitcnt vmcnt(0)
L_rl_83:
    v_cmp_eq_u32 vcc, -1, v179
    s_cbranch_vccz L_sk_338
    s_add_u32 s3, s48, 8192
    buffer_load_dwordx4 v[176:179], v1, s[8:11], s3 offen sc1
L_sk_338:
    v_cmp_eq_u32 vcc, -1, v183
    s_cbranch_vccz L_sk_339
    s_add_u32 s3, s48, 10240
    buffer_load_dwordx4 v[180:183], v1, s[8:11], s3 offen sc1
L_sk_339:
    v_cmp_eq_u32 vcc, -1, v187
    s_cbranch_vccz L_sk_340
    s_add_u32 s3, s48, 12288
    buffer_load_dwordx4 v[184:187], v1, s[8:11], s3 offen sc1
L_sk_340:
    v_cmp_eq_u32 vcc, -1, v191
    s_cbranch_vccz L_sk_341
    s_add_u32 s3, s48, 14336
    buffer_load_dwordx4 v[188:191], v1, s[8:11], s3 offen sc1
L_sk_341:
    v_cmp_eq_u32 vcc, -1, v195
    s_cbranch_vccz L_sk_342
    s_add_u32 s3, s48, 16384
    buffer_load_dwordx4 v[192:195], v1, s[8:11], s3 offen sc1
L_sk_342:
    v_cmp_eq_u32 vcc, -1, v199
    s_cbranch_vccz L_sk_343
    s_add_u32 s3, s48, 18432
    buffer_load_dwordx4 v[196:199], v1, s[8:11], s3 offen sc1
L_sk_343:
    v_cmp_eq_u32 vcc, -1, v203
    s_cbranch_vccz L_sk_344
    s_add_u32 s3, s48, 20480
    buffer_load_dwordx4 v[200:203], v1, s[8:11], s3 offen sc1
L_sk_344:
    v_cmp_eq_u32 vcc, -1, v207
    s_cbranch_vccz L_sk_345
    s_add_u32 s3, s48, 22528
    buffer_load_dwordx4 v[204:207], v1, s[8:11], s3 offen sc1
L_sk_345:
    v_cmp_eq_u32 vcc, -1, v211
    s_cbranch_vccz L_sk_346
    s_add_u32 s3, s48, 24576
    buffer_load_dwordx4 v[208:211], v1, s[8:11], s3 offen sc1
L_sk_346:
    v_cmp_eq_u32 vcc, -1, v215
    s_cbranch_vccz L_sk_347
    s_add_u32 s3, s48, 26624
    buffer_load_dwordx4 v[212:215], v1, s[8:11], s3 offen sc1
L_sk_347:
    v_cmp_eq_u32 vcc, -1, v219
    s_cbranch_vccz L_sk_348
    s_add_u32 s3, s48, 28672
    buffer_load_dwordx4 v[216:219], v1, s[8:11], s3 offen sc1
L_sk_348:
    v_cmp_eq_u32 vcc, -1, v223
    s_cbranch_vccz L_sk_349
    s_add_u32 s3, s48, 30720
    buffer_load_dwordx4 v[220:223], v1, s[8:11], s3 offen sc1
L_sk_349:
    s_waitcnt vmcnt(0)
    s_sub_u32 s47, s47, 1
    s_cbranch_scc1 L_gu_84
    v_max3_u32 v4, v179, v183, v187
    v_max_u32 v4, v4, v191
    v_cmp_eq_u32 vcc, -1, v4
    s_cbranch_vccnz L_rl_83
    s_branch L_back_82
L_gu_84:
    s_mov_b32 s47, 0
    s_branch L_back_82
L_slow_85:
    s_waitcnt vmcnt(0)
L_rl_87:
    v_cmp_eq_u32 vcc, -1, v195
    s_cbranch_vccz L_sk_350
    s_add_u32 s3, s48, 16384
    buffer_load_dwordx4 v[192:195], v1, s[8:11], s3 offen sc1
L_sk_350:
    v_cmp_eq_u32 vcc, -1, v199
    s_cbranch_vccz L_sk_351
    s_add_u32 s3, s48, 18432
    buffer_load_dwordx4 v[196:199], v1, s[8:11], s3 offen sc1
L_sk_351:
    v_cmp_eq_u32 vcc, -1, v203
    s_cbranch_vccz L_sk_352
    s_add_u32 s3, s48, 20480
    buffer_load_dwordx4 v[200:203], v1, s[8:11], s3 offen sc1
L_sk_352:
    v_cmp_eq_u32 vcc, -1, v207
    s_cbranch_vccz L_sk_353
    s_add_u32 s3, s48, 22528
    buffer_load_dwordx4 v[204:207], v1, s[8:11], s3 offen sc1
L_sk_353:
    v_cmp_eq_u32 vcc, -1, v211
    s_cbranch_vccz L_sk_354
    s_add_u32 s3, s48, 24576
    buffer_load_dwordx4 v[208:211], v1, s[8:11], s3 offen sc1
L_sk_354:
    v_cmp_eq_u32 vcc, -1, v215
    s_cbranch_vccz L_sk_355
    s_add_u32 s3, s48, 26624
    buffer_load_dwordx4 v[212:215], v1, s[8:11], s3 offen sc1
L_sk_355:
    v_cmp_eq_u32 vcc, -1, v219
    s_cbranch_vccz L_sk_356
    s_add_u32 s3, s48, 28672
    buffer_load_dwordx4 v[216:219], v1, s[8:11], s3 offen sc1
L_sk_356:
    v_cmp_eq_u32 vcc, -1, v223
    s_cbranch_vccz L_sk_357
    s_add_u32 s3, s48, 30720
    buffer_load_dwordx4 v[220:223], v1, s[8:11], s3 offen sc1
L_sk_357:
    s_waitcnt vmcnt(0)
    s_sub_u32 s47, s47, 1
    s_cbranch_scc1 L_gu_88
    v_max3_u32 v4, v195, v199, v203
    v_max_u32 v4, v4, v207
    v_cmp_eq_u32 vcc, -1, v4
    s_cbranch_vccnz L_rl_87
    s_branch L_back_86
L_gu_88:
    s_mov_b32 s47, 0
    s_branch L_back_86
L_slow_89:
    s_waitcnt vmcnt(0)
L_rl_91:
    v_cmp_eq_u32 vcc, -1, v211
    s_cbranch_vccz L_sk_358
    s_add_u32 s3, s48, 24576
    buffer_load_dwordx4 v[208:211], v1, s[8:11], s3 offen sc1
L_sk_358:
    v_cmp_eq_u32 vcc, -1, v215
    s_cbranch_vccz L_sk_359
    s_add_u32 s3, s48, 26624
    buffer_load_dwordx4 v[212:215], v1, s[8:11], s3 offen sc1
L_sk_359:
    v_cmp_eq_u32 vcc, -1, v219
    s_cbranch_vccz L_sk_360
    s_add_u32 s3, s48, 28672
    buffer_load_dwordx4 v[216:219], v1, s[8:11], s3 offen sc1
L_sk_360:
    v_cmp_eq_u32 vcc, -1, v223
    s_cbranch_vccz L_sk_361
    s_add_u32 s3, s48, 30720
    buffer_load_dwordx4 v[220:223], v1, s[8:11], s3 offen sc1
L_sk_361:
    s_waitcnt vmcnt(0)
    s_sub_u32 s47, s47, 1
    s_cbranch_scc1 L_gu_92
    v_max3_u32 v4, v211, v215, v219
    v_max_u32 v4, v4, v223
    v_cmp_eq_u32 vcc, -1, v4
    s_cbranch_vccnz L_rl_91
    s_branch L_back_90
L_gu_92:
    s_mov_b32 s47, 0
    s_branch L_back_90
L_wt_93:
    buffer_store_dwordx4 v[8:11], v1, s[8:11], s50 offen offset:0 sc1
    buffer_store_dwordx4 v[12:15], v1, s[8:11], s50 offen offset:1024 sc1
    s_branch L_wb_94
L_wt_95:
    buffer_store_dwordx2 v[16:17], v22, s[8:11], s51 offen sc1
    s_branch L_wb_96
L_slow_97:
    s_waitcnt vmcnt(0)
L_rl_99:
    v_cmp_eq_u32 vcc, -1, v19
    s_cbranch_vccz L_sk_362
    s_add_u32 s3, s50, 0
    buffer_load_dwordx4 v[16:19], v1, s[8:11], s3 offen sc1
L_sk_362:
    v_cmp_eq_u32 vcc, -1, v23
    s_cbranch_vccz L_sk_363
    s_add_u32 s3, s50, 1024
    buffer_load_dwordx4 v[20:23], v1, s[8:11], s3 offen sc1
L_sk_363:
    v_cmp_eq_u32 vcc, -1, v27
    s_cbranch_vccz L_sk_364
    s_add_u32 s3, s50, 2048
    buffer_load_dwordx4 v[24:27], v1, s[8:11], s3 offen sc1
L_sk_364:
    v_cmp_eq_u32 vcc, -1, v31
    s_cbranch_vccz L_sk_365
    s_add_u32 s3, s50, 3072
    buffer_load_dwordx4 v[28:31], v1, s[8:11], s3 offen sc1
L_sk_365:
    v_cmp_eq_u32 vcc, -1, v35
    s_cbranch_vccz L_sk_366
    s_add_u32 s3, s50, 4096
    buffer_load_dwordx4 v[32:35], v1, s[8:11], s3 offen sc1
L_sk_366:
    v_cmp_eq_u32 vcc, -1, v39
    s_cbranch_vccz L_sk_367
    s_add_u32 s3, s50, 5120
    buffer_load_dwordx4 v[36:39], v1, s[8:11], s3 offen sc1
L_sk_367:
    v_cmp_eq_u32 vcc, -1, v43
    s_cbranch_vccz L_sk_368
    s_add_u32 s3, s50, 6144
    buffer_load_dwordx4 v[40:43], v1, s[8:11], s3 offen sc1
L_sk_368:
    v_cmp_eq_u32 vcc, -1, v47
    s_cbranch_vccz L_sk_369
    s_add_u32 s3, s50, 7168
    buffer_load_dwordx4 v[44:47], v1, s[8:11], s3 offen sc1
L_sk_369:
    v_cmp_eq_u32 vcc, -1, v51
    s_cbranch_vccz L_sk_370
    s_add_u32 s3, s50, 8192
    buffer_load_dwordx4 v[48:51], v1, s[8:11], s3 offen sc1
L_sk_370:
    v_cmp_eq_u32 vcc, -1, v55
    s_cbranch_vccz L_sk_371
    s_add_u32 s3, s50, 9216
    buffer_load_dwordx4 v[52:55], v1, s[8:11], s3 offen sc1
L_sk_371:
    v_cmp_eq_u32 vcc, -1, v59
    s_cbranch_vccz L_sk_372
    s_add_u32 s3, s50, 10240
    buffer_load_dwordx4 v[56:59], v1, s[8:11], s3 offen sc1
L_sk_372:
    v_cmp_eq_u32 vcc, -1, v63
    s_cbranch_vccz L_sk_373
    s_add_u32 s3, s50, 11264
    buffer_load_dwordx4 v[60:63], v1, s[8:11], s3 offen sc1
L_sk_373:
    v_cmp_eq_u32 vcc, -1, v177
    s_cbranch_vccz L_sk_374
    s_add_u32 s3, s51, 0
    buffer_load_dwordx2 v[176:177], v255, s[8:11], s3 offen sc1
L_sk_374:
    v_cmp_eq_u32 vcc, -1, v179
    s_cbranch_vccz L_sk_375
    s_add_u32 s3, s51, 256
    buffer_load_dwordx2 v[178:179], v255, s[8:11], s3 offen sc1
L_sk_375:
    v_cmp_eq_u32 vcc, -1, v181
    s_cbranch_vccz L_sk_376
    s_add_u32 s3, s51, 512
    buffer_load_dwordx2 v[180:181], v255, s[8:11], s3 offen sc1
L_sk_376:
    v_cmp_eq_u32 vcc, -1, v183
    s_cbranch_vccz L_sk_377
    s_add_u32 s3, s51, 768
    buffer_load_dwordx2 v[182:183], v255, s[8:11], s3 offen sc1
L_sk_377:
    v_cmp_eq_u32 vcc, -1, v185
    s_cbranch_vccz L_sk_378
    s_add_u32 s3, s51, 1024
    buffer_load_dwordx2 v[184:185], v255, s[8:11], s3 offen sc1
L_sk_378:
    v_cmp_eq_u32 vcc, -1, v187
    s_cbranch_vccz L_sk_379
    s_add_u32 s3, s51, 1280
    buffer_load_dwordx2 v[186:187], v255, s[8:11], s3 offen sc1
L_sk_379:
    v_cmp_eq_u32 vcc, -1, v189
    s_cbranch_vccz L_sk_380
    s_add_u32 s3, s51, 1536
    buffer_load_dwordx2 v[188:189], v255, s[8:11], s3 offen sc1
L_sk_380:
    v_cmp_eq_u32 vcc, -1, v191
    s_cbranch_vccz L_sk_381
    s_add_u32 s3, s51, 1792
    buffer_load_dwordx2 v[190:191], v255, s[8:11], s3 offen sc1
L_sk_381:
    s_waitcnt vmcnt(0)
    s_sub_u32 s47, s47, 1
    s_cbranch_scc1 L_gu_100
    v_max_u32 v4, v19, v23
    v_cmp_eq_u32 vcc, -1, v4
    s_cbranch_vccnz L_rl_99
    s_branch L_back_98
L_gu_100:
    s_mov_b32 s47, 0
    s_branch L_back_98
L_slow_101:
    s_waitcnt vmcnt(0)
L_rl_103:
    v_cmp_eq_u32 vcc, -1, v27
    s_cbranch_vccz L_sk_382
    s_add_u32 s3, s50, 2048
    buffer_load_dwordx4 v[24:27], v1, s[8:11], s3 offen sc1
L_sk_382:
    v_cmp_eq_u32 vcc, -1, v31
    s_cbranch_vccz L_sk_383
    s_add_u32 s3, s50, 3072
    buffer_load_dwordx4 v[28:31], v1, s[8:11], s3 offen sc1
L_sk_383:
    v_cmp_eq_u32 vcc, -1, v35
    s_cbranch_vccz L_sk_384
    s_add_u32 s3, s50, 4096
    buffer_load_dwordx4 v[32:35], v1, s[8:11], s3 offen sc1
L_sk_384:
    v_cmp_eq_u32 vcc, -1, v39
    s_cbranch_vccz L_sk_385
    s_add_u32 s3, s50, 5120
    buffer_load_dwordx4 v[36:39], v1, s[8:11], s3 offen sc1
L_sk_385:
    v_cmp_eq_u32 vcc, -1, v43
    s_cbranch_vccz L_sk_386
    s_add_u32 s3, s50, 6144
    buffer_load_dwordx4 v[40:43], v1, s[8:11], s3 offen sc1
L_sk_386:
    v_cmp_eq_u32 vcc, -1, v47
    s_cbranch_vccz L_sk_387
    s_add_u32 s3, s50, 7168
    buffer_load_dwordx4 v[44:47], v1, s[8:11], s3 offen sc1
L_sk_387:
    v_cmp_eq_u32 vcc, -1, v51
    s_cbranch_vccz L_sk_388
    s_add_u32 s3, s50, 8192
    buffer_load_dwordx4 v[48:51], v1, s[8:11], s3 offen sc1
L_sk_388:
    v_cmp_eq_u32 vcc, -1, v55
    s_cbranch_vccz L_sk_389
    s_add_u32 s3, s50, 9216
    buffer_load_dwordx4 v[52:55], v1, s[8:11], s3 offen sc1
L_sk_389:
    v_cmp_eq_u32 vcc, -1, v59
    s_cbranch_vccz L_sk_390
    s_add_u32 s3, s50, 10240
    buffer_load_dwordx4 v[56:59], v1, s[8:11], s3 offen sc1
L_sk_390:
    v_cmp_eq_u32 vcc, -1, v63
    s_cbranch_vccz L_sk_391
    s_add_u32 s3, s50, 11264
    buffer_load_dwordx4 v[60:63], v1, s[8:11], s3 offen sc1
L_sk_391:
    v_cmp_eq_u32 vcc, -1, v67
    s_cbranch_vccz L_sk_392
    s_add_u32 s3, s50, 12288
    buffer_load_dwordx4 v[64:67], v1, s[8:11], s3 offen sc1
L_sk_392:
    v_cmp_eq_u32 vcc, -1, v71
    s_cbranch_vccz L_sk_393
    s_add_u32 s3, s50, 13312
    buffer_load_dwordx4 v[68:71], v1, s[8:11], s3 offen sc1
L_sk_393:
    v_cmp_eq_u32 vcc, -1, v177
    s_cbranch_vccz L_sk_394
    s_add_u32 s3, s51, 0
    buffer_load_dwordx2 v[176:177], v255, s[8:11], s3 offen sc1
L_sk_394:
    v_cmp_eq_u32 vcc, -1, v179
    s_cbranch_vccz L_sk_395
    s_add_u32 s3, s51, 256
    buffer_load_dwordx2 v[178:179], v255, s[8:11], s3 offen sc1
L_sk_395:
    v_cmp_eq_u32 vcc, -1, v181
    s_cbranch_vccz L_sk_396
    s_add_u32 s3, s51, 512
    buffer_load_dwordx2 v[180:181], v255, s[8:11], s3 offen sc1
L_sk_396:
    v_cmp_eq_u32 vcc, -1, v183
    s_cbranch_vccz L_sk_397
    s_add_u32 s3, s51, 768
    buffer_load_dwordx2 v[182:183], v255, s[8:11], s3 offen sc1
L_sk_397:
    v_cmp_eq_u32 vcc, -1, v185
    s_cbranch_vccz L_sk_398
    s_add_u32 s3, s51, 1024
    buffer_load_dwordx2 v[184:185], v255, s[8:11], s3 offen sc1
L_sk_398:
    v_cmp_eq_u32 vcc, -1, v187
    s_cbranch_vccz L_sk_399
    s_add_u32 s3, s51, 1280
    buffer_load_dwordx2 v[186:187], v255, s[8:11], s3 offen sc1
L_sk_399:
    v_cmp_eq_u32 vcc, -1, v189
    s_cbranch_vccz L_sk_400
    s_add_u32 s3, s51, 1536
    buffer_load_dwordx2 v[188:189], v255, s[8:11], s3 offen sc1
L_sk_400:
    v_cmp_eq_u32 vcc, -1, v191
    s_cbranch_vccz L_sk_401
    s_add_u32 s3, s51, 1792
    buffer_load_dwordx2 v[190:191], v255, s[8:11], s3 offen sc1
L_sk_401:
    s_waitcnt vmcnt(0)
    s_sub_u32 s47, s47, 1
    s_cbranch_scc1 L_gu_104
    v_max_u32 v4, v27, v31
    v_cmp_eq_u32 vcc, -1, v4
    s_cbranch_vccnz L_rl_103
    s_branch L_back_102
L_gu_104:
    s_mov_b32 s47, 0
    s_branch L_back_102
L_slow_105:
    s_waitcnt vmcnt(0)
L_rl_107:
    v_cmp_eq_u32 vcc, -1, v35
    s_cbranch_vccz L_sk_402
    s_add_u32 s3, s50, 4096
    buffer_load_dwordx4 v[32:35], v1, s[8:11], s3 offen sc1
L_sk_402:
    v_cmp_eq_u32 vcc, -1, v39
    s_cbranch_vccz L_sk_403
    s_add_u32 s3, s50, 5120
    buffer_load_dwordx4 v[36:39], v1, s[8:11], s3 offen sc1
L_sk_403:
    v_cmp_eq_u32 vcc, -1, v43
    s_cbranch_vccz L_sk_404
    s_add_u32 s3, s50, 6144
    buffer_load_dwordx4 v[40:43], v1, s[8:11], s3 offen sc1
L_sk_404:
    v_cmp_eq_u32 vcc, -1, v47
    s_cbranch_vccz L_sk_405
    s_add_u32 s3, s50, 7168
    buffer_load_dwordx4 v[44:47], v1, s[8:11], s3 offen sc1
L_sk_405:
    v_cmp_eq_u32 vcc, -1, v51
    s_cbranch_vccz L_sk_406
    s_add_u32 s3, s50, 8192
    buffer_load_dwordx4 v[48:51], v1, s[8:11], s3 offen sc1
L_sk_406:
    v_cmp_eq_u32 vcc, -1, v55
    s_cbranch_vccz L_sk_407
    s_add_u32 s3, s50, 9216
    buffer_load_dwordx4 v[52:55], v1, s[8:11], s3 offen sc1
L_sk_407:
    v_cmp_eq_u32 vcc, -1, v59
    s_cbranch_vccz L_sk_408
    s_add_u32 s3, s50, 10240
    buffer_load_dwordx4 v[56:59], v1, s[8:11], s3 offen sc1
L_sk_408:
    v_cmp_eq_u32 vcc, -1, v63
    s_cbranch_vccz L_sk_409
    s_add_u32 s3, s50, 11264
    buffer_load_dwordx4 v[60:63], v1, s[8:11], s3 offen sc1
L_sk_409:
    v_cmp_eq_u32 vcc, -1, v67
    s_cbranch_vccz L_sk_410
    s_add_u32 s3, s50, 12288
    buffer_load_dwordx4 v[64:67], v1, s[8:11], s3 offen sc1
L_sk_410:
    v_cmp_eq_u32 vcc, -1, v71
    s_cbranch_vccz L_sk_411
    s_add_u32 s3, s50, 13312
    buffer_load_dwordx4 v[68:71], v1, s[8:11], s3 offen sc1
L_sk_411:
    v_cmp_eq_u32 vcc, -1, v75
    s_cbranch_vccz L_sk_412
    s_add_u32 s3, s50, 14336
    buffer_load_dwordx4 v[72:75], v1, s[8:11], s3 offen sc1
L_sk_412:
    v_cmp_eq_u32 vcc, -1, v79
    s_cbranch_vccz L_sk_413
    s_add_u32 s3, s50, 15360
    buffer_load_dwordx4 v[76:79], v1, s[8:11], s3 offen sc1
L_sk_413:
    v_cmp_eq_u32 vcc, -1, v177
    s_cbranch_vccz L_sk_414
    s_add_u32 s3, s51, 0
    buffer_load_dwordx2 v[176:177], v255, s[8:11], s3 offen sc1
L_sk_414:
    v_cmp_eq_u32 vcc, -1, v179
    s_cbranch_vccz L_sk_415
    s_add_u32 s3, s51, 256
    buffer_load_dwordx2 v[178:179], v255, s[8:11], s3 offen sc1
L_sk_415:
    v_cmp_eq_u32 vcc, -1, v181
    s_cbranch_vccz L_sk_416
    s_add_u32 s3, s51, 512
    buffer_load_dwordx2 v[180:181], v255, s[8:11], s3 offen sc1
L_sk_416:
    v_cmp_eq_u32 vcc, -1, v183
    s_cbranch_vccz L_sk_417
    s_add_u32 s3, s51, 768
    buffer_load_dwordx2 v[182:183], v255, s[8:11], s3 offen sc1
L_sk_417:
    v_cmp_eq_u32 vcc, -1, v185
    s_cbranch_vccz L_sk_418
    s_add_u32 s3, s51, 1024
    buffer_load_dwordx2 v[184:185], v255, s[8:11], s3 offen sc1
L_sk_418:
    v_cmp_eq_u32 vcc, -1, v187
    s_cbranch_vccz L_sk_419
    s_add_u32 s3, s51, 1280
    buffer_load_dwordx2 v[186:187], v255, s[8:11], s3 offen sc1
L_sk_419:
    v_cmp_eq_u32 vcc, -1, v189
    s_cbranch_vccz L_sk_420
    s_add_u32 s3, s51, 1536
    buffer_load_dwordx2 v[188:189], v255, s[8:11], s3 offen sc1
L_sk_420:
    v_cmp_eq_u32 vcc, -1, v191
    s_cbranch_vccz L_sk_421
    s_add_u32 s3, s51, 1792
    buffer_load_dwordx2 v[190:191], v255, s[8:11], s3 offen sc1
L_sk_421:
    s_waitcnt vmcnt(0)
    s_sub_u32 s47, s47, 1
    s_cbranch_scc1 L_gu_108
    v_max3_u32 v4, v35, v39, v43
    v_max_u32 v4, v4, v47
    v_cmp_eq_u32 vcc, -1, v4
    s_cbranch_vccnz L_rl_107
    s_branch L_back_106
L_gu_108:
    s_mov_b32 s47, 0
    s_branch L_back_106
L_slow_109:
    s_waitcnt vmcnt(0)
L_rl_111:
    v_cmp_eq_u32 vcc, -1, v51
    s_cbranch_vccz L_sk_422
    s_add_u32 s3, s50, 8192
    buffer_load_dwordx4 v[48:51], v1, s[8:11], s3 offen sc1
L_sk_422:
    v_cmp_eq_u32 vcc, -1, v55
    s_cbranch_vccz L_sk_423
    s_add_u32 s3, s50, 9216
    buffer_load_dwordx4 v[52:55], v1, s[8:11], s3 offen sc1
L_sk_423:
    v_cmp_eq_u32 vcc, -1, v59
    s_cbranch_vccz L_sk_424
    s_add_u32 s3, s50, 10240
    buffer_load_dwordx4 v[56:59], v1, s[8:11], s3 offen sc1
L_sk_424:
    v_cmp_eq_u32 vcc, -1, v63
    s_cbranch_vccz L_sk_425
    s_add_u32 s3, s50, 11264
    buffer_load_dwordx4 v[60:63], v1, s[8:11], s3 offen sc1
L_sk_425:
    v_cmp_eq_u32 vcc, -1, v67
    s_cbranch_vccz L_sk_426
    s_add_u32 s3, s50, 12288
    buffer_load_dwordx4 v[64:67], v1, s[8:11], s3 offen sc1
L_sk_426:
    v_cmp_eq_u32 vcc, -1, v71
    s_cbranch_vccz L_sk_427
    s_add_u32 s3, s50, 13312
    buffer_load_dwordx4 v[68:71], v1, s[8:11], s3 offen sc1
L_sk_427:
    v_cmp_eq_u32 vcc, -1, v75
    s_cbranch_vccz L_sk_428
    s_add_u32 s3, s50, 14336
    buffer_load_dwordx4 v[72:75], v1, s[8:11], s3 offen sc1
L_sk_428:
    v_cmp_eq_u32 vcc, -1, v79
    s_cbranch_vccz L_sk_429
    s_add_u32 s3, s50, 15360
    buffer_load_dwordx4 v[76:79], v1, s[8:11], s3 offen sc1
L_sk_429:
    v_cmp_eq_u32 vcc, -1, v83
    s_cbranch_vccz L_sk_430
    s_add_u32 s3, s50, 16384
    buffer_load_dwordx4 v[80:83], v1, s[8:11], s3 offen sc1
L_sk_430:
    v_cmp_eq_u32 vcc, -1, v87
    s_cbranch_vccz L_sk_431
    s_add_u32 s3, s50, 17408
    buffer_load_dwordx4 v[84:87], v1, s[8:11], s3 offen sc1
L_sk_431:
    v_cmp_eq_u32 vcc, -1, v91
    s_cbranch_vccz L_sk_432
    s_add_u32 s3, s50, 18432
    buffer_load_dwordx4 v[88:91], v1, s[8:11], s3 offen sc1
L_sk_432:
    v_cmp_eq_u32 vcc, -1, v95
    s_cbranch_vccz L_sk_433
    s_add_u32 s3, s50, 19456
    buffer_load_dwordx4 v[92:95], v1, s[8:11], s3 offen sc1
L_sk_433:
    v_cmp_eq_u32 vcc, -1, v177
    s_cbranch_vccz L_sk_434
    s_add_u32 s3, s51, 0
    buffer_load_dwordx2 v[176:177], v255, s[8:11], s3 offen sc1
L_sk_434:
    v_cmp_eq_u32 vcc, -1, v179
    s_cbranch_vccz L_sk_435
    s_add_u32 s3, s51, 256
    buffer_load_dwordx2 v[178:179], v255, s[8:11], s3 offen sc1
L_sk_435:
    v_cmp_eq_u32 vcc, -1, v181
    s_cbranch_vccz L_sk_436
    s_add_u32 s3, s51, 512
    buffer_load_dwordx2 v[180:181], v255, s[8:11], s3 offen sc1
L_sk_436:
    v_cmp_eq_u32 vcc, -1, v183
    s_cbranch_vccz L_sk_437
    s_add_u32 s3, s51, 768
    buffer_load_dwordx2 v[182:183], v255, s[8:11], s3 offen sc1
L_sk_437:
    v_cmp_eq_u32 vcc, -1, v185
    s_cbranch_vccz L_sk_438
    s_add_u32 s3, s51, 1024
    buffer_load_dwordx2 v[184:185], v255, s[8:11], s3 offen sc1
L_sk_438:
    v_cmp_eq_u32 vcc, -1, v187
    s_cbranch_vccz L_sk_439
    s_add_u32 s3, s51, 1280
    buffer_load_dwordx2 v[186:187], v255, s[8:11], s3 offen sc1
L_sk_439:
    v_cmp_eq_u32 vcc, -1, v189
    s_cbranch_vccz L_sk_440
    s_add_u32 s3, s51, 1536
    buffer_load_dwordx2 v[188:189], v255, s[8:11], s3 offen sc1
L_sk_440:
    v_cmp_eq_u32 vcc, -1, v191
    s_cbranch_vccz L_sk_441
    s_add_u32 s3, s51, 1792
    buffer_load_dwordx2 v[190:191], v255, s[8:11], s3 offen sc1
L_sk_441:
    s_waitcnt vmcnt(0)
    s_sub_u32 s47, s47, 1
    s_cbranch_scc1 L_gu_112
    v_max3_u32 v4, v51, v55, v59
    v_max_u32 v4, v4, v63
    v_cmp_eq_u32 vcc, -1, v4
    s_cbranch_vccnz L_rl_111
    s_branch L_back_110
L_gu_112:
    s_mov_b32 s47, 0
    s_branch L_back_110
L_slow_113:
    s_waitcnt vmcnt(0)
L_rl_115:
    v_cmp_eq_u32 vcc, -1, v67
    s_cbranch_vccz L_sk_442
    s_add_u32 s3, s50, 12288
    buffer_load_dwordx4 v[64:67], v1, s[8:11], s3 offen sc1
L_sk_442:
    v_cmp_eq_u32 vcc, -1, v71
    s_cbranch_vccz L_sk_443
    s_add_u32 s3, s50, 13312
    buffer_load_dwordx4 v[68:71], v1, s[8:11], s3 offen sc1
L_sk_443:
    v_cmp_eq_u32 vcc, -1, v75
    s_cbranch_vccz L_sk_444
    s_add_u32 s3, s50, 14336
    buffer_load_dwordx4 v[72:75], v1, s[8:11], s3 offen sc1
L_sk_444:
    v_cmp_eq_u32 vcc, -1, v79
    s_cbranch_vccz L_sk_445
    s_add_u32 s3, s50, 15360
    buffer_load_dwordx4 v[76:79], v1, s[8:11], s3 offen sc1
L_sk_445:
    v_cmp_eq_u32 vcc, -1, v83
    s_cbranch_vccz L_sk_446
    s_add_u32 s3, s50, 16384
    buffer_load_dwordx4 v[80:83], v1, s[8:11], s3 offen sc1
L_sk_446:
    v_cmp_eq_u32 vcc, -1, v87
    s_cbranch_vccz L_sk_447
    s_add_u32 s3, s50, 17408
    buffer_load_dwordx4 v[84:87], v1, s[8:11], s3 offen sc1
L_sk_447:
    v_cmp_eq_u32 vcc, -1, v91
    s_cbranch_vccz L_sk_448
    s_add_u32 s3, s50, 18432
    buffer_load_dwordx4 v[88:91], v1, s[8:11], s3 offen sc1
L_sk_448:
    v_cmp_eq_u32 vcc, -1, v95
    s_cbranch_vccz L_sk_449
    s_add_u32 s3, s50, 19456
    buffer_load_dwordx4 v[92:95], v1, s[8:11], s3 offen sc1
L_sk_449:
    v_cmp_eq_u32 vcc, -1, v99
    s_cbranch_vccz L_sk_450
    s_add_u32 s3, s50, 20480
    buffer_load_dwordx4 v[96:99], v1, s[8:11], s3 offen sc1
L_sk_450:
    v_cmp_eq_u32 vcc, -1, v103
    s_cbranch_vccz L_sk_451
    s_add_u32 s3, s50, 21504
    buffer_load_dwordx4 v[100:103], v1, s[8:11], s3 offen sc1
L_sk_451:
    v_cmp_eq_u32 vcc, -1, v107
    s_cbranch_vccz L_sk_452
    s_add_u32 s3, s50, 22528
    buffer_load_dwordx4 v[104:107], v1, s[8:11], s3 offen sc1
L_sk_452:
    v_cmp_eq_u32 vcc, -1, v111
    s_cbranch_vccz L_sk_453
    s_add_u32 s3, s50, 23552
    buffer_load_dwordx4 v[108:111], v1, s[8:11], s3 offen sc1
L_sk_453:
    v_cmp_eq_u32 vcc, -1, v177
    s_cbranch_vccz L_sk_454
    s_add_u32 s3, s51, 0
    buffer_load_dwordx2 v[176:177], v255, s[8:11], s3 offen sc1
L_sk_454:
    v_cmp_eq_u32 vcc, -1, v179
    s_cbranch_vccz L_sk_455
    s_add_u32 s3, s51, 256
    buffer_load_dwordx2 v[178:179], v255, s[8:11], s3 offen sc1
L_sk_455:
    v_cmp_eq_u32 vcc, -1, v181
    s_cbranch_vccz L_sk_456
    s_add_u32 s3, s51, 512
    buffer_load_dwordx2 v[180:181], v255, s[8:11], s3 offen sc1
L_sk_456:
    v_cmp_eq_u32 vcc, -1, v183
    s_cbranch_vccz L_sk_457
    s_add_u32 s3, s51, 768
    buffer_load_dwordx2 v[182:183], v255, s[8:11], s3 offen sc1
L_sk_457:
    v_cmp_eq_u32 vcc, -1, v185
    s_cbranch_vccz L_sk_458
    s_add_u32 s3, s51, 1024
    buffer_load_dwordx2 v[184:185], v255, s[8:11], s3 offen sc1
L_sk_458:
    v_cmp_eq_u32 vcc, -1, v187
    s_cbranch_vccz L_sk_459
    s_add_u32 s3, s51, 1280
    buffer_load_dwordx2 v[186:187], v255, s[8:11], s3 offen sc1
L_sk_459:
    v_cmp_eq_u32 vcc, -1, v189
    s_cbranch_vccz L_sk_460
    s_add_u32 s3, s51, 1536
    buffer_load_dwordx2 v[188:189], v255, s[8:11], s3 offen sc1
L_sk_460:
    v_cmp_eq_u32 vcc, -1, v191
    s_cbranch_vccz L_sk_461
    s_add_u32 s3, s51, 1792
    buffer_load_dwordx2 v[190:191], v255, s[8:11], s3 offen sc1
L_sk_461:
    s_waitcnt vmcnt(0)
    s_sub_u32 s47, s47, 1
    s_cbranch_scc1 L_gu_116
    v_max3_u32 v4, v67, v71, v75
    v_max_u32 v4, v4, v79
    v_cmp_eq_u32 vcc, -1, v4
    s_cbranch_vccnz L_rl_115
    s_branch L_back_114
L_gu_116:
    s_mov_b32 s47, 0
    s_branch L_back_114
L_slow_117:
    s_waitcnt vmcnt(0)
L_rl_119:
    v_cmp_eq_u32 vcc, -1, v83
    s_cbranch_vccz L_sk_462
    s_add_u32 s3, s50, 16384
    buffer_load_dwordx4 v[80:83], v1, s[8:11], s3 offen sc1
L_sk_462:
    v_cmp_eq_u32 vcc, -1, v87
    s_cbranch_vccz L_sk_463
    s_add_u32 s3, s50, 17408
    buffer_load_dwordx4 v[84:87], v1, s[8:11], s3 offen sc1
L_sk_463:
    v_cmp_eq_u32 vcc, -1, v91
    s_cbranch_vccz L_sk_464
    s_add_u32 s3, s50, 18432
    buffer_load_dwordx4 v[88:91], v1, s[8:11], s3 offen sc1
L_sk_464:
    v_cmp_eq_u32 vcc, -1, v95
    s_cbranch_vccz L_sk_465
    s_add_u32 s3, s50, 19456
    buffer_load_dwordx4 v[92:95], v1, s[8:11], s3 offen sc1
L_sk_465:
    v_cmp_eq_u32 vcc, -1, v99
    s_cbranch_vccz L_sk_466
    s_add_u32 s3, s50, 20480
    buffer_load_dwordx4 v[96:99], v1, s[8:11], s3 offen sc1
L_sk_466:
    v_cmp_eq_u32 vcc, -1, v103
    s_cbranch_vccz L_sk_467
    s_add_u32 s3, s50, 21504
    buffer_load_dwordx4 v[100:103], v1, s[8:11], s3 offen sc1
L_sk_467:
    v_cmp_eq_u32 vcc, -1, v107
    s_cbranch_vccz L_sk_468
    s_add_u32 s3, s50, 22528
    buffer_load_dwordx4 v[104:107], v1, s[8:11], s3 offen sc1
L_sk_468:
    v_cmp_eq_u32 vcc, -1, v111
    s_cbranch_vccz L_sk_469
    s_add_u32 s3, s50, 23552
    buffer_load_dwordx4 v[108:111], v1, s[8:11], s3 offen sc1
L_sk_469:
    v_cmp_eq_u32 vcc, -1, v115
    s_cbranch_vccz L_sk_470
    s_add_u32 s3, s50, 24576
    buffer_load_dwordx4 v[112:115], v1, s[8:11], s3 offen sc1
L_sk_470:
    v_cmp_eq_u32 vcc, -1, v119
    s_cbranch_vccz L_sk_471
    s_add_u32 s3, s50, 25600
    buffer_load_dwordx4 v[116:119], v1, s[8:11], s3 offen sc1
L_sk_471:
    v_cmp_eq_u32 vcc, -1, v123
    s_cbranch_vccz L_sk_472
    s_add_u32 s3, s50, 26624
    buffer_load_dwordx4 v[120:123], v1, s[8:11], s3 offen sc1
L_sk_472:
    v_cmp_eq_u32 vcc, -1, v127
    s_cbranch_vccz L_sk_473
    s_add_u32 s3, s50, 27648
    buffer_load_dwordx4 v[124:127], v1, s[8:11], s3 offen sc1
L_sk_473:
    v_cmp_eq_u32 vcc, -1, v177
    s_cbranch_vccz L_sk_474
    s_add_u32 s3, s51, 0
    buffer_load_dwordx2 v[176:177], v255, s[8:11], s3 offen sc1
L_sk_474:
    v_cmp_eq_u32 vcc, -1, v179
    s_cbranch_vccz L_sk_475
    s_add_u32 s3, s51, 256
    buffer_load_dwordx2 v[178:179], v255, s[8:11], s3 offen sc1
L_sk_475:
    v_cmp_eq_u32 vcc, -1, v181
    s_cbranch_vccz L_sk_476
    s_add_u32 s3, s51, 512
    buffer_load_dwordx2 v[180:181], v255, s[8:11], s3 offen sc1
L_sk_476:
    v_cmp_eq_u32 vcc, -1, v183
    s_cbranch_vccz L_sk_477
    s_add_u32 s3, s51, 768
    buffer_load_dwordx2 v[182:183], v255, s[8:11], s3 offen sc1
L_sk_477:
    v_cmp_eq_u32 vcc, -1, v185
    s_cbranch_vccz L_sk_478
    s_add_u32 s3, s51, 1024
    buffer_load_dwordx2 v[184:185], v255, s[8:11], s3 offen sc1
L_sk_478:
    v_cmp_eq_u32 vcc, -1, v187
    s_cbranch_vccz L_sk_479
    s_add_u32 s3, s51, 1280
    buffer_load_dwordx2 v[186:187], v255, s[8:11], s3 offen sc1
L_sk_479:
    v_cmp_eq_u32 vcc, -1, v189
    s_cbranch_vccz L_sk_480
    s_add_u32 s3, s51, 1536
    buffer_load_dwordx2 v[188:189], v255, s[8:11], s3 offen sc1
L_sk_480:
    v_cmp_eq_u32 vcc, -1, v191
    s_cbranch_vccz L_sk_481
    s_add_u32 s3, s51, 1792
    buffer_load_dwordx2 v[190:191], v255, s[8:11], s3 offen sc1
L_sk_481:
    s_waitcnt vmcnt(0)
    s_sub_u32 s47, s47, 1
    s_cbranch_scc1 L_gu_120
    v_max3_u32 v4, v83, v87, v91
    v_max_u32 v4, v4, v95
    v_cmp_eq_u32 vcc, -1, v4
    s_cbranch_vccnz L_rl_119
    s_branch L_back_118
L_gu_120:
    s_mov_b32 s47, 0
    s_branch L_back_118
L_slow_121:
    s_waitcnt vmcnt(0)
L_rl_123:
    v_cmp_eq_u32 vcc, -1, v99
    s_cbranch_vccz L_sk_482
    s_add_u32 s3, s50, 20480
    buffer_load_dwordx4 v[96:99], v1, s[8:11], s3 offen sc1
L_sk_482:
    v_cmp_eq_u32 vcc, -1, v103
    s_cbranch_vccz L_sk_483
    s_add_u32 s3, s50, 21504
    buffer_load_dwordx4 v[100:103], v1, s[8:11], s3 offen sc1
L_sk_483:
    v_cmp_eq_u32 vcc, -1, v107
    s_cbranch_vccz L_sk_484
    s_add_u32 s3, s50, 22528
    buffer_load_dwordx4 v[104:107], v1, s[8:11], s3 offen sc1
L_sk_484:
    v_cmp_eq_u32 vcc, -1, v111
    s_cbranch_vccz L_sk_485
    s_add_u32 s3, s50, 23552
    buffer_load_dwordx4 v[108:111], v1, s[8:11], s3 offen sc1
L_sk_485:
    v_cmp_eq_u32 vcc, -1, v115
    s_cbranch_vccz L_sk_486
    s_add_u32 s3, s50, 24576
    buffer_load_dwordx4 v[112:115], v1, s[8:11], s3 offen sc1
L_sk_486:
    v_cmp_eq_u32 vcc, -1, v119
    s_cbranch_vccz L_sk_487
    s_add_u32 s3, s50, 25600
    buffer_load_dwordx4 v[116:119], v1, s[8:11], s3 offen sc1
L_sk_487:
    v_cmp_eq_u32 vcc, -1, v123
    s_cbranch_vccz L_sk_488
    s_add_u32 s3, s50, 26624
    buffer_load_dwordx4 v[120:123], v1, s[8:11], s3 offen sc1
L_sk_488:
    v_cmp_eq_u32 vcc, -1, v127
    s_cbranch_vccz L_sk_489
    s_add_u32 s3, s50, 27648
    buffer_load_dwordx4 v[124:127], v1, s[8:11], s3 offen sc1
L_sk_489:
    v_cmp_eq_u32 vcc, -1, v131
    s_cbranch_vccz L_sk_490
    s_add_u32 s3, s50, 28672
    buffer_load_dwordx4 v[128:131], v1, s[8:11], s3 offen sc1
L_sk_490:
    v_cmp_eq_u32 vcc, -1, v177
    s_cbranch_vccz L_sk_491
    s_add_u32 s3, s51, 0
    buffer_load_dwordx2 v[176:177], v255, s[8:11], s3 offen sc1
L_sk_491:
    v_cmp_eq_u32 vcc, -1, v179
    s_cbranch_vccz L_sk_492
    s_add_u32 s3, s51, 256
    buffer_load_dwordx2 v[178:179], v255, s[8:11], s3 offen sc1
L_sk_492:
    v_cmp_eq_u32 vcc, -1, v181
    s_cbranch_vccz L_sk_493
    s_add_u32 s3, s51, 512
    buffer_load_dwordx2 v[180:181], v255, s[8:11], s3 offen sc1
L_sk_493:
    v_cmp_eq_u32 vcc, -1, v183
    s_cbranch_vccz L_sk_494
    s_add_u32 s3, s51, 768
    buffer_load_dwordx2 v[182:183], v255, s[8:11], s3 offen sc1
L_sk_494:
    v_cmp_eq_u32 vcc, -1, v185
    s_cbranch_vccz L_sk_495
    s_add_u32 s3, s51, 1024
    buffer_load_dwordx2 v[184:185], v255, s[8:11], s3 offen sc1
L_sk_495:
    v_cmp_eq_u32 vcc, -1, v187
    s_cbranch_vccz L_sk_496
    s_add_u32 s3, s51, 1280
    buffer_load_dwordx2 v[186:187], v255, s[8:11], s3 offen sc1
L_sk_496:
    v_cmp_eq_u32 vcc, -1, v189
    s_cbranch_vccz L_sk_497
    s_add_u32 s3, s51, 1536
    buffer_load_dwordx2 v[188:189], v255, s[8:11], s3 offen sc1
L_sk_497:
    v_cmp_eq_u32 vcc, -1, v191
    s_cbranch_vccz L_sk_498
    s_add_u32 s3, s51, 1792
    buffer_load_dwordx2 v[190:191], v255, s[8:11], s3 offen sc1
L_sk_498:
    s_waitcnt vmcnt(0)
    s_sub_u32 s47, s47, 1
    s_cbranch_scc1 L_gu_124
    v_max3_u32 v5, v177, v179, v181
    v_max3_u32 v5, v5, v183, v185
    v_max3_u32 v5, v5, v187, v189
    v_max_u32 v5, v5, v191
    v_cmp_eq_u32 vcc, -1, v5
    s_cbranch_vccnz L_rl_123
    s_branch L_back_122
L_gu_124:
    s_mov_b32 s47, 0
    s_branch L_back_122
L_slow_125:
    s_waitcnt vmcnt(0)
L_rl_127:
    v_cmp_eq_u32 vcc, -1, v99
    s_cbranch_vccz L_sk_499
    s_add_u32 s3, s50, 20480
    buffer_load_dwordx4 v[96:99], v1, s[8:11], s3 offen sc1
L_sk_499:
    v_cmp_eq_u32 vcc, -1, v103
    s_cbranch_vccz L_sk_500
    s_add_u32 s3, s50, 21504
    buffer_load_dwordx4 v[100:103], v1, s[8:11], s3 offen sc1
L_sk_500:
    v_cmp_eq_u32 vcc, -1, v107
    s_cbranch_vccz L_sk_501
    s_add_u32 s3, s50, 22528
    buffer_load_dwordx4 v[104:107], v1, s[8:11], s3 offen sc1
L_sk_501:
    v_cmp_eq_u32 vcc, -1, v111
    s_cbranch_vccz L_sk_502
    s_add_u32 s3, s50, 23552
    buffer_load_dwordx4 v[108:111], v1, s[8:11], s3 offen sc1
L_sk_502:
    v_cmp_eq_u32 vcc, -1, v115
    s_cbranch_vccz L_sk_503
    s_add_u32 s3, s50, 24576
    buffer_load_dwordx4 v[112:115], v1, s[8:11], s3 offen sc1
L_sk_503:
    v_cmp_eq_u32 vcc, -1, v119
    s_cbranch_vccz L_sk_504
    s_add_u32 s3, s50, 25600
    buffer_load_dwordx4 v[116:119], v1, s[8:11], s3 offen sc1
L_sk_504:
    v_cmp_eq_u32 vcc, -1, v123
    s_cbranch_vccz L_sk_505
    s_add_u32 s3, s50, 26624
    buffer_load_dwordx4 v[120:123], v1, s[8:11], s3 offen sc1
L_sk_505:
    v_cmp_eq_u32 vcc, -1, v127
    s_cbranch_vccz L_sk_506
    s_add_u32 s3, s50, 27648
    buffer_load_dwordx4 v[124:127], v1, s[8:11], s3 offen sc1
L_sk_506:
    v_cmp_eq_u32 vcc, -1, v131
    s_cbranch_vccz L_sk_507
    s_add_u32 s3, s50, 28672
    buffer_load_dwordx4 v[128:131], v1, s[8:11], s3 offen sc1
L_sk_507:
    v_cmp_eq_u32 vcc, -1, v135
    s_cbranch_vccz L_sk_508
    s_add_u32 s3, s50, 29696
    buffer_load_dwordx4 v[132:135], v1, s[8:11], s3 offen sc1
L_sk_508:
    v_cmp_eq_u32 vcc, -1, v139
    s_cbranch_vccz L_sk_509
    s_add_u32 s3, s50, 30720
    buffer_load_dwordx4 v[136:139], v1, s[8:11], s3 offen sc1
L_sk_509:
    v_cmp_eq_u32 vcc, -1, v143
    s_cbranch_vccz L_sk_510
    s_add_u32 s3, s50, 31744
    buffer_load_dwordx4 v[140:143], v1, s[8:11], s3 offen sc1
L_sk_510:
    s_waitcnt vmcnt(0)
    s_sub_u32 s47, s47, 1
    s_cbranch_scc1 L_gu_128
    v_max3_u32 v4, v99, v103, v107
    v_max_u32 v4, v4, v111
    v_cmp_eq_u32 vcc, -1, v4
    s_cbranch_vccnz L_rl_127
    s_branch L_back_126
L_gu_128:
    s_mov_b32 s47, 0
    s_branch L_back_126
L_slow_129:
    s_waitcnt vmcnt(0)
L_rl_131:
    v_cmp_eq_u32 vcc, -1, v115
    s_cbranch_vccz L_sk_511
    s_add_u32 s3, s50, 24576
    buffer_load_dwordx4 v[112:115], v1, s[8:11], s3 offen sc1
L_sk_511:
    v_cmp_eq_u32 vcc, -1, v119
    s_cbranch_vccz L_sk_512
    s_add_u32 s3, s50, 25600
    buffer_load_dwordx4 v[116:119], v1, s[8:11], s3 offen sc1
L_sk_512:
    v_cmp_eq_u32 vcc, -1, v123
    s_cbranch_vccz L_sk_513
    s_add_u32 s3, s50, 26624
    buffer_load_dwordx4 v[120:123], v1, s[8:11], s3 offen sc1
L_sk_513:
    v_cmp_eq_u32 vcc, -1, v127
    s_cbranch_vccz L_sk_514
    s_add_u32 s3, s50, 27648
    buffer_load_dwordx4 v[124:127], v1, s[8:11], s3 offen sc1
L_sk_514:
    v_cmp_eq_u32 vcc, -1, v131
    s_cbranch_vccz L_sk_515
    s_add_u32 s3, s50, 28672
    buffer_load_dwordx4 v[128:131], v1, s[8:11], s3 offen sc1
L_sk_515:
    v_cmp_eq_u32 vcc, -1, v135
    s_cbranch_vccz L_sk_516
    s_add_u32 s3, s50, 29696
    buffer_load_dwordx4 v[132:135], v1, s[8:11], s3 offen sc1
L_sk_516:
    v_cmp_eq_u32 vcc, -1, v139
    s_cbranch_vccz L_sk_517
    s_add_u32 s3, s50, 30720
    buffer_load_dwordx4 v[136:139], v1, s[8:11], s3 offen sc1
L_sk_517:
    v_cmp_eq_u32 vcc, -1, v143
    s_cbranch_vccz L_sk_518
    s_add_u32 s3, s50, 31744
    buffer_load_dwordx4 v[140:143], v1, s[8:11], s3 offen sc1
L_sk_518:
    s_waitcnt vmcnt(0)
    s_sub_u32 s47, s47, 1
    s_cbranch_scc1 L_gu_132
    v_max3_u32 v4, v115, v119, v123
    v_max_u32 v4, v4, v127
    v_cmp_eq_u32 vcc, -1, v4
    s_cbranch_vccnz L_rl_131
    s_branch L_back_130
L_gu_132:
    s_mov_b32 s47, 0
    s_branch L_back_130
L_slow_133:
    s_waitcnt vmcnt(0)
L_rl_135:
    v_cmp_eq_u32 vcc, -1, v131
    s_cbranch_vccz L_sk_519
    s_add_u32 s3, s50, 28672
    buffer_load_dwordx4 v[128:131], v1, s[8:11], s3 offen sc1
L_sk_519:
    v_cmp_eq_u32 vcc, -1, v135
    s_cbranch_vccz L_sk_520
    s_add_u32 s3, s50, 29696
    buffer_load_dwordx4 v[132:135], v1, s[8:11], s3 offen sc1
L_sk_520:
    v_cmp_eq_u32 vcc, -1, v139
    s_cbranch_vccz L_sk_521
    s_add_u32 s3, s50, 30720
    buffer_load_dwordx4 v[136:139], v1, s[8:11], s3 offen sc1
L_sk_521:
    v_cmp_eq_u32 vcc, -1, v143
    s_cbranch_vccz L_sk_522
    s_add_u32 s3, s50, 31744
    buffer_load_dwordx4 v[140:143], v1, s[8:11], s3 offen sc1
L_sk_522:
    s_waitcnt vmcnt(0)
    s_sub_u32 s47, s47, 1
    s_cbranch_scc1 L_gu_136
    v_max3_u32 v4, v131, v135, v139
    v_max_u32 v4, v4, v143
    v_cmp_eq_u32 vcc, -1, v4
    s_cbranch_vccnz L_rl_135
    s_branch L_back_134
L_gu_136:
    s_mov_b32 s47, 0
    s_branch L_back_134
L_wt_137:
    buffer_store_dwordx4 v[152:155], v1, s[8:11], s53 offen offset:0 sc1
    s_branch L_wb_138
L_wt_139:
    buffer_store_dwordx4 v[168:171], v1, s[8:11], s53 offen offset:1024 sc1
    s_branch L_wb_140
L_wt_141:
    buffer_store_dwordx4 v[184:187], v1, s[8:11], s54 offen offset:0 sc1
    s_branch L_wb_142
L_wt_143:
    buffer_store_dwordx4 v[200:203], v1, s[8:11], s54 offen offset:1024 sc1
    s_branch L_wb_144
L_wt_145:
    buffer_store_dwordx4 v[152:155], v1, s[8:11], s55 offen offset:0 sc1
    s_branch L_wb_146
L_wt_147:
    buffer_store_dwordx4 v[168:171], v1, s[8:11], s55 offen offset:1024 sc1
    s_branch L_wb_148
L_slow_149:
    s_waitcnt vmcnt(0)
L_rl_151:
    v_cmp_eq_u32 vcc, -1, v19
    s_cbranch_vccz L_sk_523
    s_add_u32 s3, s57, 22528
    buffer_load_dwordx4 v[16:19], v1, s[8:11], s3 offen sc1
L_sk_523:
    v_cmp_eq_u32 vcc, -1, v23
    s_cbranch_vccz L_sk_524
    s_add_u32 s3, s57, 24576
    buffer_load_dwordx4 v[20:23], v1, s[8:11], s3 offen sc1
L_sk_524:
    v_cmp_eq_u32 vcc, -1, v27
    s_cbranch_vccz L_sk_525
    s_add_u32 s3, s57, 26624
    buffer_load_dwordx4 v[24:27], v1, s[8:11], s3 offen sc1
L_sk_525:
    v_cmp_eq_u32 vcc, -1, v31
    s_cbranch_vccz L_sk_526
    s_add_u32 s3, s57, 28672
    buffer_load_dwordx4 v[28:31], v1, s[8:11], s3 offen sc1
L_sk_526:
    v_cmp_eq_u32 vcc, -1, v35
    s_cbranch_vccz L_sk_527
    s_add_u32 s3, s57, 30720
    buffer_load_dwordx4 v[32:35], v1, s[8:11], s3 offen sc1
L_sk_527:
    v_cmp_eq_u32 vcc, -1, v39
    s_cbranch_vccz L_sk_528
    s_add_u32 s3, s57, 32768
    buffer_load_dwordx4 v[36:39], v1, s[8:11], s3 offen sc1
L_sk_528:
    v_cmp_eq_u32 vcc, -1, v43
    s_cbranch_vccz L_sk_529
    s_add_u32 s3, s57, 34816
    buffer_load_dwordx4 v[40:43], v1, s[8:11], s3 offen sc1
L_sk_529:
    v_cmp_eq_u32 vcc, -1, v47
    s_cbranch_vccz L_sk_530
    s_add_u32 s3, s57, 36864
    buffer_load_dwordx4 v[44:47], v1, s[8:11], s3 offen sc1
L_sk_530:
    v_cmp_eq_u32 vcc, -1, v51
    s_cbranch_vccz L_sk_531
    s_add_u32 s3, s57, 38912
    buffer_load_dwordx4 v[48:51], v1, s[8:11], s3 offen sc1
L_sk_531:
    s_waitcnt vmcnt(0)
    s_sub_u32 s47, s47, 1
    s_cbranch_scc1 L_gu_152
    v_max3_u32 v4, v19, v23, v27
    v_max_u32 v4, v4, v31
    v_cmp_eq_u32 vcc, -1, v4
    s_cbranch_vccnz L_rl_151
    s_branch L_back_150
L_gu_152:
    s_mov_b32 s47, 0
    s_branch L_back_150
L_slow_153:
    s_waitcnt vmcnt(0)
L_rl_155:
    v_cmp_eq_u32 vcc, -1, v35
    s_cbranch_vccz L_sk_532
    s_add_u32 s3, s57, 30720
    buffer_load_dwordx4 v[32:35], v1, s[8:11], s3 offen sc1
L_sk_532:
    v_cmp_eq_u32 vcc, -1, v39
    s_cbranch_vccz L_sk_533
    s_add_u32 s3, s57, 32768
    buffer_load_dwordx4 v[36:39], v1, s[8:11], s3 offen sc1
L_sk_533:
    v_cmp_eq_u32 vcc, -1, v43
    s_cbranch_vccz L_sk_534
    s_add_u32 s3, s57, 34816
    buffer_load_dwordx4 v[40:43], v1, s[8:11], s3 offen sc1
L_sk_534:
    v_cmp_eq_u32 vcc, -1, v47
    s_cbranch_vccz L_sk_535
    s_add_u32 s3, s57, 36864
    buffer_load_dwordx4 v[44:47], v1, s[8:11], s3 offen sc1
L_sk_535:
    v_cmp_eq_u32 vcc, -1, v51
    s_cbranch_vccz L_sk_536
    s_add_u32 s3, s57, 38912
    buffer_load_dwordx4 v[48:51], v1, s[8:11], s3 offen sc1
L_sk_536:
    v_cmp_eq_u32 vcc, -1, v55
    s_cbranch_vccz L_sk_537
    s_add_u32 s3, s57, 40960
    buffer_load_dwordx4 v[52:55], v1, s[8:11], s3 offen sc1
L_sk_537:
    v_cmp_eq_u32 vcc, -1, v59
    s_cbranch_vccz L_sk_538
    s_add_u32 s3, s57, 43008
    buffer_load_dwordx4 v[56:59], v1, s[8:11], s3 offen sc1
L_sk_538:
    v_cmp_eq_u32 vcc, -1, v63
    s_cbranch_vccz L_sk_539
    s_add_u32 s3, s57, 45056
    buffer_load_dwordx4 v[60:63], v1, s[8:11], s3 offen sc1
L_sk_539:
    v_cmp_eq_u32 vcc, -1, v67
    s_cbranch_vccz L_sk_540
    s_add_u32 s3, s57, 47104
    buffer_load_dwordx4 v[64:67], v1, s[8:11], s3 offen sc1
L_sk_540:
    s_waitcnt vmcnt(0)
    s_sub_u32 s47, s47, 1
    s_cbranch_scc1 L_gu_156
    v_max3_u32 v4, v35, v39, v43
    v_max_u32 v4, v4, v47
    v_cmp_eq_u32 vcc, -1, v4
    s_cbranch_vccnz L_rl_155
    s_branch L_back_154
L_gu_156:
    s_mov_b32 s47, 0
    s_branch L_back_154
L_slow_157:
    s_waitcnt vmcnt(0)
L_rl_159:
    v_cmp_eq_u32 vcc, -1, v51
    s_cbranch_vccz L_sk_541
    s_add_u32 s3, s57, 38912
    buffer_load_dwordx4 v[48:51], v1, s[8:11], s3 offen sc1
L_sk_541:
    v_cmp_eq_u32 vcc, -1, v55
    s_cbranch_vccz L_sk_542
    s_add_u32 s3, s57, 40960
    buffer_load_dwordx4 v[52:55], v1, s[8:11], s3 offen sc1
L_sk_542:
    v_cmp_eq_u32 vcc, -1, v59
    s_cbranch_vccz L_sk_543
    s_add_u32 s3, s57, 43008
    buffer_load_dwordx4 v[56:59], v1, s[8:11], s3 offen sc1
L_sk_543:
    v_cmp_eq_u32 vcc, -1, v63
    s_cbranch_vccz L_sk_544
    s_add_u32 s3, s57, 45056
    buffer_load_dwordx4 v[60:63], v1, s[8:11], s3 offen sc1
L_sk_544:
    v_cmp_eq_u32 vcc, -1, v67
    s_cbranch_vccz L_sk_545
    s_add_u32 s3, s57, 47104
    buffer_load_dwordx4 v[64:67], v1, s[8:11], s3 offen sc1
L_sk_545:
    v_cmp_eq_u32 vcc, -1, v71
    s_cbranch_vccz L_sk_546
    s_add_u32 s3, s57, 49152
    buffer_load_dwordx4 v[68:71], v1, s[8:11], s3 offen sc1
L_sk_546:
    v_cmp_eq_u32 vcc, -1, v75
    s_cbranch_vccz L_sk_547
    s_add_u32 s3, s57, 51200
    buffer_load_dwordx4 v[72:75], v1, s[8:11], s3 offen sc1
L_sk_547:
    v_cmp_eq_u32 vcc, -1, v79
    s_cbranch_vccz L_sk_548
    s_add_u32 s3, s57, 53248
    buffer_load_dwordx4 v[76:79], v1, s[8:11], s3 offen sc1
L_sk_548:
    v_cmp_eq_u32 vcc, -1, v83
    s_cbranch_vccz L_sk_549
    s_add_u32 s3, s57, 55296
    buffer_load_dwordx4 v[80:83], v1, s[8:11], s3 offen sc1
L_sk_549:
    s_waitcnt vmcnt(0)
    s_sub_u32 s47, s47, 1
    s_cbranch_scc1 L_gu_160
    v_max3_u32 v4, v51, v55, v59
    v_max_u32 v4, v4, v63
    v_cmp_eq_u32 vcc, -1, v4
    s_cbranch_vccnz L_rl_159
    s_branch L_back_158
L_gu_160:
    s_mov_b32 s47, 0
    s_branch L_back_158
L_slow_161:
    s_waitcnt vmcnt(0)
L_rl_163:
    v_cmp_eq_u32 vcc, -1, v67
    s_cbranch_vccz L_sk_550
    s_add_u32 s3, s57, 47104
    buffer_load_dwordx4 v[64:67], v1, s[8:11], s3 offen sc1
L_sk_550:
    v_cmp_eq_u32 vcc, -1, v71
    s_cbranch_vccz L_sk_551
    s_add_u32 s3, s57, 49152
    buffer_load_dwordx4 v[68:71], v1, s[8:11], s3 offen sc1
L_sk_551:
    v_cmp_eq_u32 vcc, -1, v75
    s_cbranch_vccz L_sk_552
    s_add_u32 s3, s57, 51200
    buffer_load_dwordx4 v[72:75], v1, s[8:11], s3 offen sc1
L_sk_552:
    v_cmp_eq_u32 vcc, -1, v79
    s_cbranch_vccz L_sk_553
    s_add_u32 s3, s57, 53248
    buffer_load_dwordx4 v[76:79], v1, s[8:11], s3 offen sc1
L_sk_553:
    v_cmp_eq_u32 vcc, -1, v83
    s_cbranch_vccz L_sk_554
    s_add_u32 s3, s57, 55296
    buffer_load_dwordx4 v[80:83], v1, s[8:11], s3 offen sc1
L_sk_554:
    v_cmp_eq_u32 vcc, -1, v87
    s_cbranch_vccz L_sk_555
    s_add_u32 s3, s57, 57344
    buffer_load_dwordx4 v[84:87], v1, s[8:11], s3 offen sc1
L_sk_555:
    v_cmp_eq_u32 vcc, -1, v91
    s_cbranch_vccz L_sk_556
    s_add_u32 s3, s57, 59392
    buffer_load_dwordx4 v[88:91], v1, s[8:11], s3 offen sc1
L_sk_556:
    v_cmp_eq_u32 vcc, -1, v95
    s_cbranch_vccz L_sk_557
    s_add_u32 s3, s57, 61440
    buffer_load_dwordx4 v[92:95], v1, s[8:11], s3 offen sc1
L_sk_557:
    v_cmp_eq_u32 vcc, -1, v99
    s_cbranch_vccz L_sk_558
    s_add_u32 s3, s57, 63488
    buffer_load_dwordx4 v[96:99], v1, s[8:11], s3 offen sc1
L_sk_558:
    s_waitcnt vmcnt(0)
    s_sub_u32 s47, s47, 1
    s_cbranch_scc1 L_gu_164
    v_max3_u32 v4, v67, v71, v75
    v_max_u32 v4, v4, v79
    v_cmp_eq_u32 vcc, -1, v4
    s_cbranch_vccnz L_rl_163
    s_branch L_back_162
L_gu_164:
    s_mov_b32 s47, 0
    s_branch L_back_162
L_slow_165:
    s_waitcnt vmcnt(0)
L_rl_167:
    v_cmp_eq_u32 vcc, -1, v83
    s_cbranch_vccz L_sk_559
    s_add_u32 s3, s57, 55296
    buffer_load_dwordx4 v[80:83], v1, s[8:11], s3 offen sc1
L_sk_559:
    v_cmp_eq_u32 vcc, -1, v87
    s_cbranch_vccz L_sk_560
    s_add_u32 s3, s57, 57344
    buffer_load_dwordx4 v[84:87], v1, s[8:11], s3 offen sc1
L_sk_560:
    v_cmp_eq_u32 vcc, -1, v91
    s_cbranch_vccz L_sk_561
    s_add_u32 s3, s57, 59392
    buffer_load_dwordx4 v[88:91], v1, s[8:11], s3 offen sc1
L_sk_561:
    v_cmp_eq_u32 vcc, -1, v95
    s_cbranch_vccz L_sk_562
    s_add_u32 s3, s57, 61440
    buffer_load_dwordx4 v[92:95], v1, s[8:11], s3 offen sc1
L_sk_562:
    v_cmp_eq_u32 vcc, -1, v99
    s_cbranch_vccz L_sk_563
    s_add_u32 s3, s57, 63488
    buffer_load_dwordx4 v[96:99], v1, s[8:11], s3 offen sc1
L_sk_563:
    v_cmp_eq_u32 vcc, -1, v103
    s_cbranch_vccz L_sk_564
    s_add_u32 s3, s57, 65536
    buffer_load_dwordx4 v[100:103], v1, s[8:11], s3 offen sc1
L_sk_564:
    v_cmp_eq_u32 vcc, -1, v107
    s_cbranch_vccz L_sk_565
    s_add_u32 s3, s57, 67584
    buffer_load_dwordx4 v[104:107], v1, s[8:11], s3 offen sc1
L_sk_565:
    v_cmp_eq_u32 vcc, -1, v111
    s_cbranch_vccz L_sk_566
    s_add_u32 s3, s57, 69632
    buffer_load_dwordx4 v[108:111], v1, s[8:11], s3 offen sc1
L_sk_566:
    v_cmp_eq_u32 vcc, -1, v115
    s_cbranch_vccz L_sk_567
    s_add_u32 s3, s57, 71680
    buffer_load_dwordx4 v[112:115], v1, s[8:11], s3 offen sc1
L_sk_567:
    s_waitcnt vmcnt(0)
    s_sub_u32 s47, s47, 1
    s_cbranch_scc1 L_gu_168
    v_max3_u32 v4, v83, v87, v91
    v_max_u32 v4, v4, v95
    v_cmp_eq_u32 vcc, -1, v4
    s_cbranch_vccnz L_rl_167
    s_branch L_back_166
L_gu_168:
    s_mov_b32 s47, 0
    s_branch L_back_166
L_slow_169:
    s_waitcnt vmcnt(0)
L_rl_171:
    v_cmp_eq_u32 vcc, -1, v99
    s_cbranch_vccz L_sk_568
    s_add_u32 s3, s57, 63488
    buffer_load_dwordx4 v[96:99], v1, s[8:11], s3 offen sc1
L_sk_568:
    v_cmp_eq_u32 vcc, -1, v103
    s_cbranch_vccz L_sk_569
    s_add_u32 s3, s57, 65536
    buffer_load_dwordx4 v[100:103], v1, s[8:11], s3 offen sc1
L_sk_569:
    v_cmp_eq_u32 vcc, -1, v107
    s_cbranch_vccz L_sk_570
    s_add_u32 s3, s57, 67584
    buffer_load_dwordx4 v[104:107], v1, s[8:11], s3 offen sc1
L_sk_570:
    v_cmp_eq_u32 vcc, -1, v111
    s_cbranch_vccz L_sk_571
    s_add_u32 s3, s57, 69632
    buffer_load_dwordx4 v[108:111], v1, s[8:11], s3 offen sc1
L_sk_571:
    v_cmp_eq_u32 vcc, -1, v115
    s_cbranch_vccz L_sk_572
    s_add_u32 s3, s57, 71680
    buffer_load_dwordx4 v[112:115], v1, s[8:11], s3 offen sc1
L_sk_572:
    v_cmp_eq_u32 vcc, -1, v119
    s_cbranch_vccz L_sk_573
    s_add_u32 s3, s57, 73728
    buffer_load_dwordx4 v[116:119], v1, s[8:11], s3 offen sc1
L_sk_573:
    v_cmp_eq_u32 vcc, -1, v123
    s_cbranch_vccz L_sk_574
    s_add_u32 s3, s57, 75776
    buffer_load_dwordx4 v[120:123], v1, s[8:11], s3 offen sc1
L_sk_574:
    v_cmp_eq_u32 vcc, -1, v127
    s_cbranch_vccz L_sk_575
    s_add_u32 s3, s57, 77824
    buffer_load_dwordx4 v[124:127], v1, s[8:11], s3 offen sc1
L_sk_575:
    v_cmp_eq_u32 vcc, -1, v131
    s_cbranch_vccz L_sk_576
    s_add_u32 s3, s57, 79872
    buffer_load_dwordx4 v[128:131], v1, s[8:11], s3 offen sc1
L_sk_576:
    s_waitcnt vmcnt(0)
    s_sub_u32 s47, s47, 1
    s_cbranch_scc1 L_gu_172
    v_max3_u32 v4, v99, v103, v107
    v_max_u32 v4, v4, v111
    v_cmp_eq_u32 vcc, -1, v4
    s_cbranch_vccnz L_rl_171
    s_branch L_back_170
L_gu_172:
    s_mov_b32 s47, 0
    s_branch L_back_170
L_slow_173:
    s_waitcnt vmcnt(0)
L_rl_175:
    v_cmp_eq_u32 vcc, -1, v115
    s_cbranch_vccz L_sk_577
    s_add_u32 s3, s57, 71680
    buffer_load_dwordx4 v[112:115], v1, s[8:11], s3 offen sc1
L_sk_577:
    v_cmp_eq_u32 vcc, -1, v119
    s_cbranch_vccz L_sk_578
    s_add_u32 s3, s57, 73728
    buffer_load_dwordx4 v[116:119], v1, s[8:11], s3 offen sc1
L_sk_578:
    v_cmp_eq_u32 vcc, -1, v123
    s_cbranch_vccz L_sk_579
    s_add_u32 s3, s57, 75776
    buffer_load_dwordx4 v[120:123], v1, s[8:11], s3 offen sc1
L_sk_579:
    v_cmp_eq_u32 vcc, -1, v127
    s_cbranch_vccz L_sk_580
    s_add_u32 s3, s57, 77824
    buffer_load_dwordx4 v[124:127], v1, s[8:11], s3 offen sc1
L_sk_580:
    v_cmp_eq_u32 vcc, -1, v131
    s_cbranch_vccz L_sk_581
    s_add_u32 s3, s57, 79872
    buffer_load_dwordx4 v[128:131], v1, s[8:11], s3 offen sc1
L_sk_581:
    v_cmp_eq_u32 vcc, -1, v135
    s_cbranch_vccz L_sk_582
    s_add_u32 s3, s57, 81920
    buffer_load_dwordx4 v[132:135], v1, s[8:11], s3 offen sc1
L_sk_582:
    v_cmp_eq_u32 vcc, -1, v139
    s_cbranch_vccz L_sk_583
    s_add_u32 s3, s57, 83968
    buffer_load_dwordx4 v[136:139], v1, s[8:11], s3 offen sc1
L_sk_583:
    v_cmp_eq_u32 vcc, -1, v143
    s_cbranch_vccz L_sk_584
    s_add_u32 s3, s57, 86016
    buffer_load_dwordx4 v[140:143], v1, s[8:11], s3 offen sc1
L_sk_584:
    s_waitcnt vmcnt(0)
    s_sub_u32 s47, s47, 1
    s_cbranch_scc1 L_gu_176
    v_max3_u32 v4, v115, v119, v123
    v_max_u32 v4, v4, v127
    v_cmp_eq_u32 vcc, -1, v4
    s_cbranch_vccnz L_rl_175
    s_branch L_back_174
L_gu_176:
    s_mov_b32 s47, 0
    s_branch L_back_174
L_slow_177:
    s_waitcnt vmcnt(0)
L_rl_179:
    v_cmp_eq_u32 vcc, -1, v131
    s_cbranch_vccz L_sk_585
    s_add_u32 s3, s57, 79872
    buffer_load_dwordx4 v[128:131], v1, s[8:11], s3 offen sc1
L_sk_585:
    v_cmp_eq_u32 vcc, -1, v135
    s_cbranch_vccz L_sk_586
    s_add_u32 s3, s57, 81920
    buffer_load_dwordx4 v[132:135], v1, s[8:11], s3 offen sc1
L_sk_586:
    v_cmp_eq_u32 vcc, -1, v139
    s_cbranch_vccz L_sk_587
    s_add_u32 s3, s57, 83968
    buffer_load_dwordx4 v[136:139], v1, s[8:11], s3 offen sc1
L_sk_587:
    v_cmp_eq_u32 vcc, -1, v143
    s_cbranch_vccz L_sk_588
    s_add_u32 s3, s57, 86016
    buffer_load_dwordx4 v[140:143], v1, s[8:11], s3 offen sc1
L_sk_588:
    s_waitcnt vmcnt(0)
    s_sub_u32 s47, s47, 1
    s_cbranch_scc1 L_gu_180
    v_max3_u32 v4, v131, v135, v139
    v_max_u32 v4, v4, v143
    v_cmp_eq_u32 vcc, -1, v4
    s_cbranch_vccnz L_rl_179
    s_branch L_back_178
L_gu_180:
    s_mov_b32 s47, 0
    s_branch L_back_178
L_last:
    s_endpgm
.section .rodata,"a"
.p2align 6
.amdhsa_kernel sequential_preLN__softmax_full_mha__glu_gated_swiglu__prompt_kernel
  .amdhsa_next_free_vgpr 256
  .amdhsa_next_free_sgpr 102
  .amdhsa_accum_offset 256
  .amdhsa_group_segment_fixed_size 0
  .amdhsa_kernarg_size 80
  .amdhsa_user_sgpr_count 2
  .amdhsa_user_sgpr_kernarg_segment_ptr 1
  .amdhsa_system_sgpr_workgroup_id_x 1
.end_amdhsa_kernel
```
